```python
import torch

def _softmax(x, axis=-1):
    return torch.softmax(x, dim=axis)

def _gelu(x):
    return torch.nn.functional.gelu(x, approximate='tanh')

def _silu(x):
    return torch.nn.functional.silu(x)

def _sigmoid(x):
    return torch.sigmoid(x)

def _layernorm(x, axis=-1, eps=1e-05):
    m = x.mean(dim=axis, keepdim=True)
    v = x.var(dim=axis, keepdim=True, unbiased=False)
    return (x - m) / torch.sqrt(v + eps)

def _scatter_add(tgt, idx, src, axis=0):
    return tgt.clone().index_add_(axis, idx, src)

def _segment_sum(src, seg, n):
    out = torch.zeros((n,) + src.shape[1:], dtype=src.dtype)
    return out.index_add_(0, seg, src)

def _pad(x, pw):
    flat = tuple((v for pair in reversed(pw) for v in pair))
    return torch.nn.functional.pad(x, flat)
kernel_name = 'interleave_layers__memory_aug_recurrent_mem_tr__sliding_block__prompt'

def setup_inputs():

    _w = lambda a: (lambda t: t.to(torch.bfloat16) if t.is_floating_point() else t)(torch.as_tensor(a))

    def _A_setup():
        B, S, Dm = (1, 2048, 448)
        H, Dh = (16, 256)
        M, seg = (8, 32)
        seg = min(seg, S)
        S = S // seg * seg
        return {'x': _w((lambda *s: torch.randn(*s, dtype=torch.bfloat16) * 0.05)(B, S, Dm)), 'mem0': _w((lambda *s: torch.randn(*s, dtype=torch.bfloat16) * 0.4)(B, M, Dm)), 'Wq': _w((lambda *s: torch.randn(*s, dtype=torch.bfloat16) * 3.2)(Dm, H, Dh) * Dm ** (-0.5)), 'Wk': _w((lambda *s: torch.randn(*s, dtype=torch.bfloat16) * 3.2)(Dm, H, Dh) * Dm ** (-0.5)), 'Wv': _w((lambda *s: torch.randn(*s, dtype=torch.bfloat16) * 0.4)(Dm, H, Dh) * Dm ** (-0.5)), 'Wo': _w((lambda *s: torch.randn(*s, dtype=torch.bfloat16) * 0.4)(H, Dh, Dm) * (H * Dh) ** (-0.5)), 'seg_len': seg}
    _A_in = _A_setup()

    def _B_setup():
        B, S, D = (1, 2048, 448)
        return {'x': _w((lambda *s: torch.randn(*s, dtype=torch.bfloat16) * 0.05)(B, S, D)), 'wqkv': _w((lambda *s: torch.randn(*s, dtype=torch.bfloat16) * 0.05)(D, 3 * D)), 'wo': _w((lambda *s: torch.randn(*s, dtype=torch.bfloat16) * 0.05)(D, D))}
    _B_in = _B_setup()
    return {'A_x': _A_in['x'], 'A_mem0': _A_in['mem0'], 'A_Wq': _A_in['Wq'], 'A_Wk': _A_in['Wk'], 'A_Wv': _A_in['Wv'], 'A_Wo': _A_in['Wo'], 'A_seg_len': _A_in['seg_len'], 'B_x': _B_in['x'], 'B_wqkv': _B_in['wqkv'], 'B_wo': _B_in['wo']}

def reference(A_x, A_mem0, A_Wq, A_Wk, A_Wv, A_Wo, A_seg_len, B_x, B_wqkv, B_wo):

    def _A_ref(x, mem0, Wq, Wk, Wv, Wo, seg_len):
        B, S, Dm = x.shape
        H, Dh = (Wq.shape[1], Wq.shape[2])
        M = mem0.shape[1]
        scale = Dh ** (-0.5)
        n_seg = S // seg_len
        L = M + seg_len
        idx = torch.arange(L)
        mask = (idx[:, None] < M) | (idx[:, None] >= idx[None, :])
        mem = mem0
        outs = []
        for s in range(n_seg):
            xs = x[:, s * seg_len:(s + 1) * seg_len, :].clone()
            h = torch.concatenate([mem, xs], axis=1)
            q = torch.einsum('btd,dhe->bhte', h, Wq)
            k = torch.einsum('btd,dhe->bhte', h, Wk)
            v = torch.einsum('btd,dhe->bhte', h, Wv)
            scores = torch.einsum('bhqe,bhke->bhqk', q, k) * scale
            scores = torch.where(mask[None, None], scores, -1000000000.0)
            p = _softmax(scores, axis=-1)
            o = torch.einsum('bhqk,bhke->bhqe', p, v)
            o = torch.einsum('bhte,hed->btd', o, Wo)
            mem = o[:, :M, :].clone()
            outs.append(o[:, M:, :])
        return torch.concatenate(outs, axis=1)

    def _B_ref(x, wqkv, wo):
        B, S, D = x.shape
        H = 16
        Dh = D // H
        W = 256
        qkv = (lambda x, *d: x.permute(*d))((x @ wqkv).reshape(B, S, 3, H, Dh), 2, 0, 3, 1, 4)
        q, k, v = (qkv[0], qkv[1], qkv[2])
        scores = torch.einsum('bhqd,bhkd->bhqk', q, k) * Dh ** (-0.5)
        idx = torch.arange(S)
        mask = (idx[:, None] - idx[None, :] >= 0) & (idx[:, None] - idx[None, :] < W)
        scores = torch.where(mask[None, None], scores, -1000000000.0)
        p = _softmax(scores, axis=-1)
        o = torch.einsum('bhqk,bhkd->bhqd', p, v)
        return (lambda x, *d: x.permute(*d))(o, 0, 2, 1, 3).reshape(B, S, D) @ wo
    x = A_x
    x = x + _A_ref(_layernorm(x, axis=-1), A_mem0, A_Wq, A_Wk, A_Wv, A_Wo, A_seg_len)
    x = x + _B_ref(_layernorm(x, axis=-1), B_wqkv, B_wo)
    x = x + _A_ref(_layernorm(x, axis=-1), A_mem0, A_Wq, A_Wk, A_Wv, A_Wo, A_seg_len)
    x = x + _B_ref(_layernorm(x, axis=-1), B_wqkv, B_wo)
    return x
```

```asm
; @launch kernel=prep_kernel grid=(256,1,1) block=(256,1,1) lds=131072
; @launch kernel=interleave_layers__memory_aug_recurrent_mem_tr__sliding_block__prompt_kernel grid=(256,1,1) block=(256,1,1) lds=163840
.amdgcn_target "amdgcn-amd-amdhsa--gfx950"
.text
.globl prep_kernel
.p2align 8
.type prep_kernel,@function
prep_kernel:
s_cmp_ge_u32 s2, 256
s_cbranch_scc1 PREP_END
s_load_dwordx2 s[4:5], s[0:1], 96
s_load_dwordx4 s[52:55], s[0:1], 0
s_load_dwordx4 s[56:59], s[0:1], 16
s_load_dwordx4 s[60:63], s[0:1], 32
s_load_dwordx4 s[64:67], s[0:1], 64
v_lshrrev_b32 v1, 6, v0
s_nop 0
v_readfirstlane_b32 s18, v1
v_and_b32 v16, 63, v0
v_and_b32 v17, 31, v16
v_lshrrev_b32 v18, 5, v16
s_waitcnt lgkmcnt(0)
s_and_b32 s5, s5, 0xffff
s_mov_b32 s6, 268435456
s_mov_b32 s7, 0x20000
s_mov_b32 s28, s64
s_and_b32 s29, s65, 0xffff
s_mov_b32 s30, 1204224
s_mov_b32 s31, 0x20000
s_mov_b32 s32, s66
s_and_b32 s33, s67, 0xffff
s_mov_b32 s34, 401408
s_mov_b32 s35, 0x20000
s_lshl_b32 s36, s2, 2
s_add_u32 s36, s36, s18
v_mul_u32_u24 v240, 21504, v18
v_lshl_add_u32 v240, v17, 1, v240
v_and_b32 v242, 15, v16
v_lshrrev_b32 v243, 4, v16
v_mul_u32_u24 v241, 7168, v243
v_lshl_add_u32 v241, v242, 1, v241
s_add_u32 s37, s36, 0
s_mov_b32 s72, -1
s_cmp_ge_u32 s37, 1736
s_cbranch_scc1 PG_E0
s_cmp_ge_u32 s37, 1344
s_cbranch_scc1 PG_W0
s_mul_hi_u32 s38, s37, 51130564
s_mul_i32 s39, s38, 84
s_sub_u32 s39, s37, s39
s_mul_hi_u32 s40, s39, 153391690
s_mul_i32 s41, s40, 28
s_sub_u32 s41, s39, s41
s_mul_i32 s38, s38, 56
s_mul_i32 s42, s40, 896
s_add_u32 s38, s38, s42
s_mul_i32 s41, s41, 43008
s_add_u32 s38, s38, s41
s_mov_b32 s74, s40
s_add_u32 s39, s38, 0
buffer_load_ushort v224, v240, s[28:31], s39 offen
s_add_u32 s39, s38, 2688
buffer_load_ushort v225, v240, s[28:31], s39 offen
s_add_u32 s39, s38, 5376
buffer_load_ushort v226, v240, s[28:31], s39 offen
s_add_u32 s39, s38, 8064
buffer_load_ushort v227, v240, s[28:31], s39 offen
s_add_u32 s39, s38, 10752
buffer_load_ushort v228, v240, s[28:31], s39 offen
s_add_u32 s39, s38, 13440
buffer_load_ushort v229, v240, s[28:31], s39 offen
s_add_u32 s39, s38, 16128
buffer_load_ushort v230, v240, s[28:31], s39 offen
s_add_u32 s39, s38, 18816
buffer_load_ushort v231, v240, s[28:31], s39 offen
s_lshl_b32 s72, s37, 10
s_add_u32 s72, s72, 12910592
s_branch PG_E0
PG_W0:
s_sub_u32 s37, s37, 1344
s_mul_hi_u32 s38, s37, 306783379
s_mul_i32 s39, s38, 14
s_sub_u32 s39, s37, s39
s_lshl_b32 s38, s38, 5
s_mul_i32 s39, s39, 28672
s_add_u32 s38, s38, s39
s_mov_b32 s74, 7
s_add_u32 s39, s38, 0
buffer_load_ushort v224, v241, s[32:35], s39 offen
s_add_u32 s39, s38, 896
buffer_load_ushort v225, v241, s[32:35], s39 offen
s_add_u32 s39, s38, 1792
buffer_load_ushort v226, v241, s[32:35], s39 offen
s_add_u32 s39, s38, 2688
buffer_load_ushort v227, v241, s[32:35], s39 offen
s_add_u32 s39, s38, 3584
buffer_load_ushort v228, v241, s[32:35], s39 offen
s_add_u32 s39, s38, 4480
buffer_load_ushort v229, v241, s[32:35], s39 offen
s_add_u32 s39, s38, 5376
buffer_load_ushort v230, v241, s[32:35], s39 offen
s_add_u32 s39, s38, 6272
buffer_load_ushort v231, v241, s[32:35], s39 offen
s_lshl_b32 s72, s37, 10
s_add_u32 s72, s72, 14286848
PG_E0:
s_add_u32 s37, s36, 1024
s_mov_b32 s73, -1
s_cmp_ge_u32 s37, 1736
s_cbranch_scc1 PG_E1
s_cmp_ge_u32 s37, 1344
s_cbranch_scc1 PG_W1
s_mul_hi_u32 s38, s37, 51130564
s_mul_i32 s39, s38, 84
s_sub_u32 s39, s37, s39
s_mul_hi_u32 s40, s39, 153391690
s_mul_i32 s41, s40, 28
s_sub_u32 s41, s39, s41
s_mul_i32 s38, s38, 56
s_mul_i32 s42, s40, 896
s_add_u32 s38, s38, s42
s_mul_i32 s41, s41, 43008
s_add_u32 s38, s38, s41
s_mov_b32 s75, s40
s_add_u32 s39, s38, 0
buffer_load_ushort v232, v240, s[28:31], s39 offen
s_add_u32 s39, s38, 2688
buffer_load_ushort v233, v240, s[28:31], s39 offen
s_add_u32 s39, s38, 5376
buffer_load_ushort v234, v240, s[28:31], s39 offen
s_add_u32 s39, s38, 8064
buffer_load_ushort v235, v240, s[28:31], s39 offen
s_add_u32 s39, s38, 10752
buffer_load_ushort v236, v240, s[28:31], s39 offen
s_add_u32 s39, s38, 13440
buffer_load_ushort v237, v240, s[28:31], s39 offen
s_add_u32 s39, s38, 16128
buffer_load_ushort v238, v240, s[28:31], s39 offen
s_add_u32 s39, s38, 18816
buffer_load_ushort v239, v240, s[28:31], s39 offen
s_lshl_b32 s73, s37, 10
s_add_u32 s73, s73, 12910592
s_branch PG_E1
PG_W1:
s_sub_u32 s37, s37, 1344
s_mul_hi_u32 s38, s37, 306783379
s_mul_i32 s39, s38, 14
s_sub_u32 s39, s37, s39
s_lshl_b32 s38, s38, 5
s_mul_i32 s39, s39, 28672
s_add_u32 s38, s38, s39
s_mov_b32 s75, 7
s_add_u32 s39, s38, 0
buffer_load_ushort v232, v241, s[32:35], s39 offen
s_add_u32 s39, s38, 896
buffer_load_ushort v233, v241, s[32:35], s39 offen
s_add_u32 s39, s38, 1792
buffer_load_ushort v234, v241, s[32:35], s39 offen
s_add_u32 s39, s38, 2688
buffer_load_ushort v235, v241, s[32:35], s39 offen
s_add_u32 s39, s38, 3584
buffer_load_ushort v236, v241, s[32:35], s39 offen
s_add_u32 s39, s38, 4480
buffer_load_ushort v237, v241, s[32:35], s39 offen
s_add_u32 s39, s38, 5376
buffer_load_ushort v238, v241, s[32:35], s39 offen
s_add_u32 s39, s38, 6272
buffer_load_ushort v239, v241, s[32:35], s39 offen
s_lshl_b32 s73, s37, 10
s_add_u32 s73, s73, 14286848
PG_E1:
v_lshlrev_b32 v2, 4, v0
v_mov_b32 v4, -1
v_mov_b32 v5, -1
v_mov_b32 v6, -1
v_mov_b32 v7, -1
v_mov_b32 v8, 0
v_mov_b32 v9, 0
v_mov_b32 v10, 0
v_mov_b32 v11, 0
s_cmp_ge_u32 s2, 16
s_cbranch_scc1 PREP_NOZ2
s_lshl_b32 s31, s2, 12
s_add_u32 s43, s31, 157966336
buffer_store_dwordx4 v[8:11], v2, s[4:7], s43 offen
s_cmp_ge_u32 s2, 4
s_cbranch_scc1 PREP_NOZ2
buffer_store_dwordx4 v[8:11], v2, s[4:7], s31 offen
PREP_NOZ2:
s_and_b32 s76, s2, 7
s_lshr_b32 s77, s2, 3
s_cmp_ge_u32 s77, 30
s_cbranch_scc1 PREP_MISC
v_lshrrev_b32 v19, 4, v17
v_lshlrev_b32 v19, 4, v19
v_bfe_u32 v20, v17, 2, 1
v_lshl_add_u32 v19, v20, 3, v19
v_bfe_u32 v20, v17, 3, 1
v_lshl_add_u32 v19, v20, 2, v19
v_and_b32 v20, 3, v17
v_add_u32 v19, v19, v20
s_and_b32 s30, s18, 1
s_mul_i32 s30, s30, 7
s_lshr_b32 s31, s18, 1
s_lshl_b32 s37, s30, 5
v_add_u32 v25, s37, v19
v_lshlrev_b32 v26, 7, v25
v_bfe_u32 v27, v19, 1, 3
v_add_u32 v28, 0, v18
v_xor_b32 v28, v28, v27
v_lshl_add_u32 v21, v28, 4, v26
v_add_u32 v28, 2, v18
v_xor_b32 v28, v28, v27
v_lshl_add_u32 v22, v28, 4, v26
v_add_u32 v28, 4, v18
v_xor_b32 v28, v28, v27
v_lshl_add_u32 v23, v28, 4, v26
v_add_u32 v28, 6, v18
v_xor_b32 v28, v28, v27
v_lshl_add_u32 v24, v28, 4, v26
v_lshrrev_b32 v28, 3, v16
v_lshlrev_b32 v29, 13, v28
v_lshrrev_b32 v28, 4, v16
v_and_b32 v30, 7, v16
v_xor_b32 v31, v30, v28
v_lshl_add_u32 v12, v31, 4, v29
v_add_u32 v28, 4, v28
v_xor_b32 v31, v30, v28
v_lshl_add_u32 v13, v31, 4, v29
s_cmp_ge_u32 s77, 14
s_cbranch_scc1 PREP_B
s_cmp_ge_u32 s77, 7
s_cselect_b32 s35, 1, 0
s_mul_i32 s36, s35, 7
s_sub_u32 s36, s77, s36
s_lshl_b32 s37, s76, 1
s_add_u32 s35, s35, s37
s_lshl_b32 s49, s36, 6
s_lshl_b32 s36, s36, 1
s_add_u32 s36, s36, s31
s_lshl_b32 s46, s35, 9
s_mov_b32 s20, s58
s_and_b32 s21, s59, 0xffff
s_mov_b32 s22, 3670016
s_mov_b32 s23, 0x20000
s_mov_b32 s24, s56
s_and_b32 s25, s57, 0xffff
s_mov_b32 s26, 3670016
s_mov_b32 s27, 0x20000
s_bitcmp1_b32 s18, 0
s_cbranch_scc1 PV14_0a
v_mov_b32 v14, v12
s_branch PV14_0b
PV14_0a:
v_mov_b32 v14, v13
PV14_0b:
v_add_u32 v64, 65536, v21
v_add_u32 v65, 65536, v22
v_add_u32 v66, 65536, v23
v_add_u32 v67, 65536, v24
v_and_b32 v28, 15, v17
v_lshrrev_b32 v29, 4, v17
v_lshrrev_b32 v30, 2, v28
v_lshlrev_b32 v30, 3, v30
v_lshl_add_u32 v30, v29, 2, v30
v_and_b32 v31, 3, v28
v_add_u32 v30, v30, v31
s_lshl_b32 s37, s31, 5
v_add_u32 v30, s37, v30
v_bfe_u32 v31, v30, 1, 3
v_lshlrev_b32 v30, 7, v30
v_add_u32 v30, 57344, v30
v_add_u32 v3, 0, v18
v_xor_b32 v3, v3, v31
v_lshl_add_u32 v68, v3, 4, v30
v_add_u32 v72, 65536, v68
v_add_u32 v3, 2, v18
v_xor_b32 v3, v3, v31
v_lshl_add_u32 v69, v3, 4, v30
v_add_u32 v73, 65536, v69
v_add_u32 v3, 4, v18
v_xor_b32 v3, v3, v31
v_lshl_add_u32 v70, v3, 4, v30
v_add_u32 v74, 65536, v70
v_add_u32 v3, 6, v18
v_xor_b32 v3, v3, v31
v_lshl_add_u32 v71, v3, 4, v30
v_add_u32 v75, 65536, v71
s_mul_i32 s38, s35, 28
s_lshl_b32 s39, s36, 1
s_add_u32 s38, s38, s39
s_mul_i32 s38, s38, 14336
s_lshl_b32 s39, s30, 10
s_add_u32 s38, s38, s39
s_add_u32 s38, s38, 65536
v_mul_u32_u24 v15, 14336, v29
v_lshl_add_u32 v15, v28, 4, v15
v_lshl_add_u32 v15, v18, 8, v15
v_add_u32 v15, s38, v15
s_mov_b32 s34, 1035512379
s_mul_i32 s47, s18, 1024
s_add_u32 m0, s47, 0
s_mul_i32 s48, s18, 65536
s_add_u32 s48, s48, s46
s_add_u32 s48, s48, 0
buffer_load_dwordx4 v14, s[20:23], s48 offen lds
s_mul_i32 s47, s18, 1024
s_add_u32 m0, s47, 4096
s_mul_i32 s48, s18, 65536
s_add_u32 s48, s48, s46
s_add_u32 s48, s48, 262144
buffer_load_dwordx4 v14, s[20:23], s48 offen lds
s_mul_i32 s47, s18, 1024
s_add_u32 m0, s47, 8192
s_mul_i32 s48, s18, 65536
s_add_u32 s48, s48, s46
s_add_u32 s48, s48, 524288
buffer_load_dwordx4 v14, s[20:23], s48 offen lds
s_mul_i32 s47, s18, 1024
s_add_u32 m0, s47, 12288
s_mul_i32 s48, s18, 65536
s_add_u32 s48, s48, s46
s_add_u32 s48, s48, 786432
buffer_load_dwordx4 v14, s[20:23], s48 offen lds
s_mul_i32 s47, s18, 1024
s_add_u32 m0, s47, 16384
s_mul_i32 s48, s18, 65536
s_add_u32 s48, s48, s46
s_add_u32 s48, s48, 1048576
buffer_load_dwordx4 v14, s[20:23], s48 offen lds
s_mul_i32 s47, s18, 1024
s_add_u32 m0, s47, 20480
s_mul_i32 s48, s18, 65536
s_add_u32 s48, s48, s46
s_add_u32 s48, s48, 1310720
buffer_load_dwordx4 v14, s[20:23], s48 offen lds
s_mul_i32 s47, s18, 1024
s_add_u32 m0, s47, 24576
s_mul_i32 s48, s18, 65536
s_add_u32 s48, s48, s46
s_add_u32 s48, s48, 1572864
buffer_load_dwordx4 v14, s[20:23], s48 offen lds
s_mul_i32 s47, s18, 1024
s_add_u32 m0, s47, 28672
s_mul_i32 s48, s18, 65536
s_add_u32 s48, s48, s46
s_add_u32 s48, s48, 1835008
buffer_load_dwordx4 v14, s[20:23], s48 offen lds
s_mul_i32 s47, s18, 1024
s_add_u32 m0, s47, 32768
s_mul_i32 s48, s18, 65536
s_add_u32 s48, s48, s46
s_add_u32 s48, s48, 2097152
buffer_load_dwordx4 v14, s[20:23], s48 offen lds
s_mul_i32 s47, s18, 1024
s_add_u32 m0, s47, 36864
s_mul_i32 s48, s18, 65536
s_add_u32 s48, s48, s46
s_add_u32 s48, s48, 2359296
buffer_load_dwordx4 v14, s[20:23], s48 offen lds
s_mul_i32 s47, s18, 1024
s_add_u32 m0, s47, 40960
s_mul_i32 s48, s18, 65536
s_add_u32 s48, s48, s46
s_add_u32 s48, s48, 2621440
buffer_load_dwordx4 v14, s[20:23], s48 offen lds
s_mul_i32 s47, s18, 1024
s_add_u32 m0, s47, 45056
s_mul_i32 s48, s18, 65536
s_add_u32 s48, s48, s46
s_add_u32 s48, s48, 2883584
buffer_load_dwordx4 v14, s[20:23], s48 offen lds
s_mul_i32 s47, s18, 1024
s_add_u32 m0, s47, 49152
s_mul_i32 s48, s18, 65536
s_add_u32 s48, s48, s46
s_add_u32 s48, s48, 3145728
buffer_load_dwordx4 v14, s[20:23], s48 offen lds
s_mul_i32 s47, s18, 1024
s_add_u32 m0, s47, 53248
s_mul_i32 s48, s18, 65536
s_add_u32 s48, s48, s46
s_add_u32 s48, s48, 3407872
buffer_load_dwordx4 v14, s[20:23], s48 offen lds
s_mul_i32 s47, s18, 1024
s_add_u32 m0, s47, 57344
s_add_u32 s48, s49, 0
s_lshl_b32 s47, s18, 3
s_add_u32 s48, s48, s47
s_lshl_b32 s48, s48, 13
s_add_u32 s48, s48, s46
s_add_u32 s48, s48, 0
buffer_load_dwordx4 v14, s[24:27], s48 offen lds
s_mul_i32 s47, s18, 1024
s_add_u32 m0, s47, 61440
s_add_u32 s48, s49, 32
s_lshl_b32 s47, s18, 3
s_add_u32 s48, s48, s47
s_lshl_b32 s48, s48, 13
s_add_u32 s48, s48, s46
s_add_u32 s48, s48, 0
buffer_load_dwordx4 v14, s[24:27], s48 offen lds
s_mov_b32 s44, s2
FL_2:
s_cmp_ge_u32 s44, 112
s_cbranch_scc1 FE_3
s_lshl_b32 s45, s44, 12
s_add_u32 s45, s45, 33045504
buffer_store_dwordx4 v[4:7], v2, s[4:7], s45 offen
s_add_u32 s44, s44, 256
s_branch FL_2
FE_3:
s_mov_b32 s44, s2
FL_4:
s_cmp_ge_u32 s44, 160
s_cbranch_scc1 FE_5
s_lshl_b32 s45, s44, 12
s_add_u32 s45, s45, 33972224
buffer_store_dwordx4 v[4:7], v2, s[4:7], s45 offen
s_add_u32 s44, s44, 256
s_branch FL_4
FE_5:
s_mov_b32 s44, s2
FL_6:
s_cmp_ge_u32 s44, 640
s_cbranch_scc1 FE_7
s_lshl_b32 s45, s44, 12
s_add_u32 s45, s45, 35282944
buffer_store_dwordx4 v[4:7], v2, s[4:7], s45 offen
s_add_u32 s44, s44, 256
s_branch FL_6
FE_7:
s_mov_b32 s44, s2
FL_8:
s_cmp_ge_u32 s44, 112
s_cbranch_scc1 FE_9
s_lshl_b32 s45, s44, 12
s_add_u32 s45, s45, 33512448
buffer_store_dwordx4 v[4:7], v2, s[4:7], s45 offen
s_add_u32 s44, s44, 256
s_branch FL_8
FE_9:
s_mov_b32 s44, s2
FL_10:
s_cmp_ge_u32 s44, 160
s_cbranch_scc1 FE_11
s_lshl_b32 s45, s44, 12
s_add_u32 s45, s45, 34627584
buffer_store_dwordx4 v[4:7], v2, s[4:7], s45 offen
s_add_u32 s44, s44, 256
s_branch FL_10
FE_11:
s_mov_b32 s44, s2
FL_12:
s_cmp_ge_u32 s44, 640
s_cbranch_scc1 FE_13
s_lshl_b32 s45, s44, 12
s_add_u32 s45, s45, 37904384
buffer_store_dwordx4 v[4:7], v2, s[4:7], s45 offen
s_add_u32 s44, s44, 256
s_branch FL_12
FE_13:
s_mov_b32 s44, s2
FL_14:
s_cmp_ge_u32 s44, 448
s_cbranch_scc1 FE_15
s_lshl_b32 s45, s44, 12
s_add_u32 s45, s45, 23863296
buffer_store_dwordx4 v[4:7], v2, s[4:7], s45 offen
s_add_u32 s44, s44, 256
s_branch FL_14
FE_15:
s_mov_b32 s44, s2
FL_16:
s_cmp_ge_u32 s44, 448
s_cbranch_scc1 FE_17
s_lshl_b32 s45, s44, 12
s_add_u32 s45, s45, 25698304
buffer_store_dwordx4 v[4:7], v2, s[4:7], s45 offen
s_add_u32 s44, s44, 256
s_branch FL_16
FE_17:
s_mov_b32 s44, s2
FL_18:
s_cmp_ge_u32 s44, 448
s_cbranch_scc1 FE_19
s_lshl_b32 s45, s44, 12
s_add_u32 s45, s45, 27533312
buffer_store_dwordx4 v[4:7], v2, s[4:7], s45 offen
s_add_u32 s44, s44, 256
s_branch FL_18
FE_19:
s_mov_b32 s44, s2
FL_20:
s_cmp_ge_u32 s44, 448
s_cbranch_scc1 FE_21
s_lshl_b32 s45, s44, 12
s_add_u32 s45, s45, 29368320
buffer_store_dwordx4 v[4:7], v2, s[4:7], s45 offen
s_add_u32 s44, s44, 256
s_branch FL_20
FE_21:
s_mov_b32 s44, s2
FL_22:
s_cmp_ge_u32 s44, 448
s_cbranch_scc1 FE_23
s_lshl_b32 s45, s44, 12
s_add_u32 s45, s45, 31203328
buffer_store_dwordx4 v[4:7], v2, s[4:7], s45 offen
s_add_u32 s44, s44, 256
s_branch FL_22
FE_23:
s_mov_b32 s44, s2
FL_24:
s_cmp_ge_u32 s44, 8
s_cbranch_scc1 FE_25
s_lshl_b32 s45, s44, 12
s_add_u32 s45, s45, 158031872
buffer_store_dwordx4 v[4:7], v2, s[4:7], s45 offen
s_add_u32 s44, s44, 256
s_branch FL_24
FE_25:
s_mul_i32 s47, s18, 1024
s_add_u32 m0, s47, 65536
s_mul_i32 s48, s18, 65536
s_add_u32 s48, s48, s46
s_add_u32 s48, s48, 128
buffer_load_dwordx4 v14, s[20:23], s48 offen lds
s_mul_i32 s47, s18, 1024
s_add_u32 m0, s47, 69632
s_mul_i32 s48, s18, 65536
s_add_u32 s48, s48, s46
s_add_u32 s48, s48, 262272
buffer_load_dwordx4 v14, s[20:23], s48 offen lds
s_mul_i32 s47, s18, 1024
s_add_u32 m0, s47, 73728
s_mul_i32 s48, s18, 65536
s_add_u32 s48, s48, s46
s_add_u32 s48, s48, 524416
buffer_load_dwordx4 v14, s[20:23], s48 offen lds
s_mul_i32 s47, s18, 1024
s_add_u32 m0, s47, 77824
s_mul_i32 s48, s18, 65536
s_add_u32 s48, s48, s46
s_add_u32 s48, s48, 786560
buffer_load_dwordx4 v14, s[20:23], s48 offen lds
s_mul_i32 s47, s18, 1024
s_add_u32 m0, s47, 81920
s_mul_i32 s48, s18, 65536
s_add_u32 s48, s48, s46
s_add_u32 s48, s48, 1048704
buffer_load_dwordx4 v14, s[20:23], s48 offen lds
s_mul_i32 s47, s18, 1024
s_add_u32 m0, s47, 86016
s_mul_i32 s48, s18, 65536
s_add_u32 s48, s48, s46
s_add_u32 s48, s48, 1310848
buffer_load_dwordx4 v14, s[20:23], s48 offen lds
s_mul_i32 s47, s18, 1024
s_add_u32 m0, s47, 90112
s_mul_i32 s48, s18, 65536
s_add_u32 s48, s48, s46
s_add_u32 s48, s48, 1572992
buffer_load_dwordx4 v14, s[20:23], s48 offen lds
s_mul_i32 s47, s18, 1024
s_add_u32 m0, s47, 94208
s_mul_i32 s48, s18, 65536
s_add_u32 s48, s48, s46
s_add_u32 s48, s48, 1835136
buffer_load_dwordx4 v14, s[20:23], s48 offen lds
s_mul_i32 s47, s18, 1024
s_add_u32 m0, s47, 98304
s_mul_i32 s48, s18, 65536
s_add_u32 s48, s48, s46
s_add_u32 s48, s48, 2097280
buffer_load_dwordx4 v14, s[20:23], s48 offen lds
s_mul_i32 s47, s18, 1024
s_add_u32 m0, s47, 102400
s_mul_i32 s48, s18, 65536
s_add_u32 s48, s48, s46
s_add_u32 s48, s48, 2359424
buffer_load_dwordx4 v14, s[20:23], s48 offen lds
s_mul_i32 s47, s18, 1024
s_add_u32 m0, s47, 106496
s_mul_i32 s48, s18, 65536
s_add_u32 s48, s48, s46
s_add_u32 s48, s48, 2621568
buffer_load_dwordx4 v14, s[20:23], s48 offen lds
s_mul_i32 s47, s18, 1024
s_add_u32 m0, s47, 110592
s_mul_i32 s48, s18, 65536
s_add_u32 s48, s48, s46
s_add_u32 s48, s48, 2883712
buffer_load_dwordx4 v14, s[20:23], s48 offen lds
s_mul_i32 s47, s18, 1024
s_add_u32 m0, s47, 114688
s_mul_i32 s48, s18, 65536
s_add_u32 s48, s48, s46
s_add_u32 s48, s48, 3145856
buffer_load_dwordx4 v14, s[20:23], s48 offen lds
s_mul_i32 s47, s18, 1024
s_add_u32 m0, s47, 118784
s_mul_i32 s48, s18, 65536
s_add_u32 s48, s48, s46
s_add_u32 s48, s48, 3408000
buffer_load_dwordx4 v14, s[20:23], s48 offen lds
s_mul_i32 s47, s18, 1024
s_add_u32 m0, s47, 122880
s_add_u32 s48, s49, 0
s_lshl_b32 s47, s18, 3
s_add_u32 s48, s48, s47
s_lshl_b32 s48, s48, 13
s_add_u32 s48, s48, s46
s_add_u32 s48, s48, 128
buffer_load_dwordx4 v14, s[24:27], s48 offen lds
s_mul_i32 s47, s18, 1024
s_add_u32 m0, s47, 126976
s_add_u32 s48, s49, 32
s_lshl_b32 s47, s18, 3
s_add_u32 s48, s48, s47
s_lshl_b32 s48, s48, 13
s_add_u32 s48, s48, s46
s_add_u32 s48, s48, 128
buffer_load_dwordx4 v14, s[24:27], s48 offen lds
s_waitcnt vmcnt(16)
s_barrier
ds_read_b128 v[80:83], v68
ds_read_b128 v[84:87], v69
ds_read_b128 v[88:91], v70
ds_read_b128 v[92:95], v71
s_waitcnt lgkmcnt(0)
ds_read_b128 v[32:35], v21 offset:0
ds_read_b128 v[36:39], v21 offset:4096
ds_read_b128 v[40:43], v21 offset:8192
ds_read_b128 v[44:47], v21 offset:12288
ds_read_b128 v[48:51], v21 offset:16384
ds_read_b128 v[52:55], v21 offset:20480
s_waitcnt lgkmcnt(5)
v_mfma_f32_32x32x16_bf16 a[0:15], v[32:35], v[80:83], 0
ds_read_b128 v[56:59], v21 offset:24576
s_waitcnt lgkmcnt(5)
v_mfma_f32_32x32x16_bf16 a[16:31], v[36:39], v[80:83], 0
ds_read_b128 v[60:63], v22 offset:0
s_waitcnt lgkmcnt(5)
v_mfma_f32_32x32x16_bf16 a[32:47], v[40:43], v[80:83], 0
ds_read_b128 v[32:35], v22 offset:4096
s_waitcnt lgkmcnt(5)
v_mfma_f32_32x32x16_bf16 a[48:63], v[44:47], v[80:83], 0
ds_read_b128 v[36:39], v22 offset:8192
s_waitcnt lgkmcnt(5)
v_mfma_f32_32x32x16_bf16 a[64:79], v[48:51], v[80:83], 0
ds_read_b128 v[40:43], v22 offset:12288
s_waitcnt lgkmcnt(5)
v_mfma_f32_32x32x16_bf16 a[80:95], v[52:55], v[80:83], 0
ds_read_b128 v[44:47], v22 offset:16384
s_waitcnt lgkmcnt(5)
v_mfma_f32_32x32x16_bf16 a[96:111], v[56:59], v[80:83], 0
ds_read_b128 v[48:51], v22 offset:20480
s_waitcnt lgkmcnt(5)
v_mfma_f32_32x32x16_bf16 a[0:15], v[60:63], v[84:87], a[0:15]
ds_read_b128 v[52:55], v22 offset:24576
s_waitcnt lgkmcnt(5)
v_mfma_f32_32x32x16_bf16 a[16:31], v[32:35], v[84:87], a[16:31]
ds_read_b128 v[56:59], v23 offset:0
s_waitcnt lgkmcnt(5)
v_mfma_f32_32x32x16_bf16 a[32:47], v[36:39], v[84:87], a[32:47]
ds_read_b128 v[60:63], v23 offset:4096
s_waitcnt lgkmcnt(5)
v_mfma_f32_32x32x16_bf16 a[48:63], v[40:43], v[84:87], a[48:63]
ds_read_b128 v[32:35], v23 offset:8192
s_waitcnt lgkmcnt(5)
v_mfma_f32_32x32x16_bf16 a[64:79], v[44:47], v[84:87], a[64:79]
ds_read_b128 v[36:39], v23 offset:12288
s_waitcnt lgkmcnt(5)
v_mfma_f32_32x32x16_bf16 a[80:95], v[48:51], v[84:87], a[80:95]
ds_read_b128 v[40:43], v23 offset:16384
s_waitcnt lgkmcnt(5)
v_mfma_f32_32x32x16_bf16 a[96:111], v[52:55], v[84:87], a[96:111]
ds_read_b128 v[44:47], v23 offset:20480
s_waitcnt lgkmcnt(5)
v_mfma_f32_32x32x16_bf16 a[0:15], v[56:59], v[88:91], a[0:15]
ds_read_b128 v[48:51], v23 offset:24576
s_waitcnt lgkmcnt(5)
v_mfma_f32_32x32x16_bf16 a[16:31], v[60:63], v[88:91], a[16:31]
ds_read_b128 v[52:55], v24 offset:0
s_waitcnt lgkmcnt(5)
v_mfma_f32_32x32x16_bf16 a[32:47], v[32:35], v[88:91], a[32:47]
ds_read_b128 v[56:59], v24 offset:4096
s_waitcnt lgkmcnt(5)
v_mfma_f32_32x32x16_bf16 a[48:63], v[36:39], v[88:91], a[48:63]
ds_read_b128 v[60:63], v24 offset:8192
s_waitcnt lgkmcnt(5)
v_mfma_f32_32x32x16_bf16 a[64:79], v[40:43], v[88:91], a[64:79]
ds_read_b128 v[32:35], v24 offset:12288
s_waitcnt lgkmcnt(5)
v_mfma_f32_32x32x16_bf16 a[80:95], v[44:47], v[88:91], a[80:95]
ds_read_b128 v[36:39], v24 offset:16384
s_waitcnt lgkmcnt(5)
v_mfma_f32_32x32x16_bf16 a[96:111], v[48:51], v[88:91], a[96:111]
ds_read_b128 v[40:43], v24 offset:20480
s_waitcnt lgkmcnt(5)
v_mfma_f32_32x32x16_bf16 a[0:15], v[52:55], v[92:95], a[0:15]
ds_read_b128 v[44:47], v24 offset:24576
s_waitcnt lgkmcnt(5)
v_mfma_f32_32x32x16_bf16 a[16:31], v[56:59], v[92:95], a[16:31]
s_waitcnt lgkmcnt(4)
v_mfma_f32_32x32x16_bf16 a[32:47], v[60:63], v[92:95], a[32:47]
s_waitcnt lgkmcnt(3)
v_mfma_f32_32x32x16_bf16 a[48:63], v[32:35], v[92:95], a[48:63]
s_waitcnt lgkmcnt(2)
v_mfma_f32_32x32x16_bf16 a[64:79], v[36:39], v[92:95], a[64:79]
s_waitcnt lgkmcnt(1)
v_mfma_f32_32x32x16_bf16 a[80:95], v[40:43], v[92:95], a[80:95]
s_waitcnt lgkmcnt(0)
v_mfma_f32_32x32x16_bf16 a[96:111], v[44:47], v[92:95], a[96:111]
s_barrier
s_mul_i32 s47, s18, 1024
s_add_u32 m0, s47, 0
s_mul_i32 s48, s18, 65536
s_add_u32 s48, s48, s46
s_add_u32 s48, s48, 256
buffer_load_dwordx4 v14, s[20:23], s48 offen lds
s_mul_i32 s47, s18, 1024
s_add_u32 m0, s47, 4096
s_mul_i32 s48, s18, 65536
s_add_u32 s48, s48, s46
s_add_u32 s48, s48, 262400
buffer_load_dwordx4 v14, s[20:23], s48 offen lds
s_mul_i32 s47, s18, 1024
s_add_u32 m0, s47, 8192
s_mul_i32 s48, s18, 65536
s_add_u32 s48, s48, s46
s_add_u32 s48, s48, 524544
buffer_load_dwordx4 v14, s[20:23], s48 offen lds
s_mul_i32 s47, s18, 1024
s_add_u32 m0, s47, 12288
s_mul_i32 s48, s18, 65536
s_add_u32 s48, s48, s46
s_add_u32 s48, s48, 786688
buffer_load_dwordx4 v14, s[20:23], s48 offen lds
s_mul_i32 s47, s18, 1024
s_add_u32 m0, s47, 16384
s_mul_i32 s48, s18, 65536
s_add_u32 s48, s48, s46
s_add_u32 s48, s48, 1048832
buffer_load_dwordx4 v14, s[20:23], s48 offen lds
s_mul_i32 s47, s18, 1024
s_add_u32 m0, s47, 20480
s_mul_i32 s48, s18, 65536
s_add_u32 s48, s48, s46
s_add_u32 s48, s48, 1310976
buffer_load_dwordx4 v14, s[20:23], s48 offen lds
s_mul_i32 s47, s18, 1024
s_add_u32 m0, s47, 24576
s_mul_i32 s48, s18, 65536
s_add_u32 s48, s48, s46
s_add_u32 s48, s48, 1573120
buffer_load_dwordx4 v14, s[20:23], s48 offen lds
s_mul_i32 s47, s18, 1024
s_add_u32 m0, s47, 28672
s_mul_i32 s48, s18, 65536
s_add_u32 s48, s48, s46
s_add_u32 s48, s48, 1835264
buffer_load_dwordx4 v14, s[20:23], s48 offen lds
s_mul_i32 s47, s18, 1024
s_add_u32 m0, s47, 32768
s_mul_i32 s48, s18, 65536
s_add_u32 s48, s48, s46
s_add_u32 s48, s48, 2097408
buffer_load_dwordx4 v14, s[20:23], s48 offen lds
s_mul_i32 s47, s18, 1024
s_add_u32 m0, s47, 36864
s_mul_i32 s48, s18, 65536
s_add_u32 s48, s48, s46
s_add_u32 s48, s48, 2359552
buffer_load_dwordx4 v14, s[20:23], s48 offen lds
s_mul_i32 s47, s18, 1024
s_add_u32 m0, s47, 40960
s_mul_i32 s48, s18, 65536
s_add_u32 s48, s48, s46
s_add_u32 s48, s48, 2621696
buffer_load_dwordx4 v14, s[20:23], s48 offen lds
s_mul_i32 s47, s18, 1024
s_add_u32 m0, s47, 45056
s_mul_i32 s48, s18, 65536
s_add_u32 s48, s48, s46
s_add_u32 s48, s48, 2883840
buffer_load_dwordx4 v14, s[20:23], s48 offen lds
s_mul_i32 s47, s18, 1024
s_add_u32 m0, s47, 49152
s_mul_i32 s48, s18, 65536
s_add_u32 s48, s48, s46
s_add_u32 s48, s48, 3145984
buffer_load_dwordx4 v14, s[20:23], s48 offen lds
s_mul_i32 s47, s18, 1024
s_add_u32 m0, s47, 53248
s_mul_i32 s48, s18, 65536
s_add_u32 s48, s48, s46
s_add_u32 s48, s48, 3408128
buffer_load_dwordx4 v14, s[20:23], s48 offen lds
s_mul_i32 s47, s18, 1024
s_add_u32 m0, s47, 57344
s_add_u32 s48, s49, 0
s_lshl_b32 s47, s18, 3
s_add_u32 s48, s48, s47
s_lshl_b32 s48, s48, 13
s_add_u32 s48, s48, s46
s_add_u32 s48, s48, 256
buffer_load_dwordx4 v14, s[24:27], s48 offen lds
s_mul_i32 s47, s18, 1024
s_add_u32 m0, s47, 61440
s_add_u32 s48, s49, 32
s_lshl_b32 s47, s18, 3
s_add_u32 s48, s48, s47
s_lshl_b32 s48, s48, 13
s_add_u32 s48, s48, s46
s_add_u32 s48, s48, 256
buffer_load_dwordx4 v14, s[24:27], s48 offen lds
s_waitcnt vmcnt(16)
s_barrier
ds_read_b128 v[80:83], v72
ds_read_b128 v[84:87], v73
ds_read_b128 v[88:91], v74
ds_read_b128 v[92:95], v75
s_waitcnt lgkmcnt(0)
ds_read_b128 v[32:35], v64 offset:0
ds_read_b128 v[36:39], v64 offset:4096
ds_read_b128 v[40:43], v64 offset:8192
ds_read_b128 v[44:47], v64 offset:12288
ds_read_b128 v[48:51], v64 offset:16384
ds_read_b128 v[52:55], v64 offset:20480
s_waitcnt lgkmcnt(5)
v_mfma_f32_32x32x16_bf16 a[0:15], v[32:35], v[80:83], a[0:15]
ds_read_b128 v[56:59], v64 offset:24576
s_waitcnt lgkmcnt(5)
v_mfma_f32_32x32x16_bf16 a[16:31], v[36:39], v[80:83], a[16:31]
ds_read_b128 v[60:63], v65 offset:0
s_waitcnt lgkmcnt(5)
v_mfma_f32_32x32x16_bf16 a[32:47], v[40:43], v[80:83], a[32:47]
ds_read_b128 v[32:35], v65 offset:4096
s_waitcnt lgkmcnt(5)
v_mfma_f32_32x32x16_bf16 a[48:63], v[44:47], v[80:83], a[48:63]
ds_read_b128 v[36:39], v65 offset:8192
s_waitcnt lgkmcnt(5)
v_mfma_f32_32x32x16_bf16 a[64:79], v[48:51], v[80:83], a[64:79]
ds_read_b128 v[40:43], v65 offset:12288
s_waitcnt lgkmcnt(5)
v_mfma_f32_32x32x16_bf16 a[80:95], v[52:55], v[80:83], a[80:95]
ds_read_b128 v[44:47], v65 offset:16384
s_waitcnt lgkmcnt(5)
v_mfma_f32_32x32x16_bf16 a[96:111], v[56:59], v[80:83], a[96:111]
ds_read_b128 v[48:51], v65 offset:20480
s_waitcnt lgkmcnt(5)
v_mfma_f32_32x32x16_bf16 a[0:15], v[60:63], v[84:87], a[0:15]
ds_read_b128 v[52:55], v65 offset:24576
s_waitcnt lgkmcnt(5)
v_mfma_f32_32x32x16_bf16 a[16:31], v[32:35], v[84:87], a[16:31]
ds_read_b128 v[56:59], v66 offset:0
s_waitcnt lgkmcnt(5)
v_mfma_f32_32x32x16_bf16 a[32:47], v[36:39], v[84:87], a[32:47]
ds_read_b128 v[60:63], v66 offset:4096
s_waitcnt lgkmcnt(5)
v_mfma_f32_32x32x16_bf16 a[48:63], v[40:43], v[84:87], a[48:63]
ds_read_b128 v[32:35], v66 offset:8192
s_waitcnt lgkmcnt(5)
v_mfma_f32_32x32x16_bf16 a[64:79], v[44:47], v[84:87], a[64:79]
ds_read_b128 v[36:39], v66 offset:12288
s_waitcnt lgkmcnt(5)
v_mfma_f32_32x32x16_bf16 a[80:95], v[48:51], v[84:87], a[80:95]
ds_read_b128 v[40:43], v66 offset:16384
s_waitcnt lgkmcnt(5)
v_mfma_f32_32x32x16_bf16 a[96:111], v[52:55], v[84:87], a[96:111]
ds_read_b128 v[44:47], v66 offset:20480
s_waitcnt lgkmcnt(5)
v_mfma_f32_32x32x16_bf16 a[0:15], v[56:59], v[88:91], a[0:15]
ds_read_b128 v[48:51], v66 offset:24576
s_waitcnt lgkmcnt(5)
v_mfma_f32_32x32x16_bf16 a[16:31], v[60:63], v[88:91], a[16:31]
ds_read_b128 v[52:55], v67 offset:0
s_waitcnt lgkmcnt(5)
v_mfma_f32_32x32x16_bf16 a[32:47], v[32:35], v[88:91], a[32:47]
ds_read_b128 v[56:59], v67 offset:4096
s_waitcnt lgkmcnt(5)
v_mfma_f32_32x32x16_bf16 a[48:63], v[36:39], v[88:91], a[48:63]
ds_read_b128 v[60:63], v67 offset:8192
s_waitcnt lgkmcnt(5)
v_mfma_f32_32x32x16_bf16 a[64:79], v[40:43], v[88:91], a[64:79]
ds_read_b128 v[32:35], v67 offset:12288
s_waitcnt lgkmcnt(5)
v_mfma_f32_32x32x16_bf16 a[80:95], v[44:47], v[88:91], a[80:95]
ds_read_b128 v[36:39], v67 offset:16384
s_waitcnt lgkmcnt(5)
v_mfma_f32_32x32x16_bf16 a[96:111], v[48:51], v[88:91], a[96:111]
ds_read_b128 v[40:43], v67 offset:20480
s_waitcnt lgkmcnt(5)
v_mfma_f32_32x32x16_bf16 a[0:15], v[52:55], v[92:95], a[0:15]
ds_read_b128 v[44:47], v67 offset:24576
s_waitcnt lgkmcnt(5)
v_mfma_f32_32x32x16_bf16 a[16:31], v[56:59], v[92:95], a[16:31]
s_waitcnt lgkmcnt(4)
v_mfma_f32_32x32x16_bf16 a[32:47], v[60:63], v[92:95], a[32:47]
s_waitcnt lgkmcnt(3)
v_mfma_f32_32x32x16_bf16 a[48:63], v[32:35], v[92:95], a[48:63]
s_waitcnt lgkmcnt(2)
v_mfma_f32_32x32x16_bf16 a[64:79], v[36:39], v[92:95], a[64:79]
s_waitcnt lgkmcnt(1)
v_mfma_f32_32x32x16_bf16 a[80:95], v[40:43], v[92:95], a[80:95]
s_waitcnt lgkmcnt(0)
v_mfma_f32_32x32x16_bf16 a[96:111], v[44:47], v[92:95], a[96:111]
s_barrier
s_mul_i32 s47, s18, 1024
s_add_u32 m0, s47, 65536
s_mul_i32 s48, s18, 65536
s_add_u32 s48, s48, s46
s_add_u32 s48, s48, 384
buffer_load_dwordx4 v14, s[20:23], s48 offen lds
s_mul_i32 s47, s18, 1024
s_add_u32 m0, s47, 69632
s_mul_i32 s48, s18, 65536
s_add_u32 s48, s48, s46
s_add_u32 s48, s48, 262528
buffer_load_dwordx4 v14, s[20:23], s48 offen lds
s_mul_i32 s47, s18, 1024
s_add_u32 m0, s47, 73728
s_mul_i32 s48, s18, 65536
s_add_u32 s48, s48, s46
s_add_u32 s48, s48, 524672
buffer_load_dwordx4 v14, s[20:23], s48 offen lds
s_mul_i32 s47, s18, 1024
s_add_u32 m0, s47, 77824
s_mul_i32 s48, s18, 65536
s_add_u32 s48, s48, s46
s_add_u32 s48, s48, 786816
buffer_load_dwordx4 v14, s[20:23], s48 offen lds
s_mul_i32 s47, s18, 1024
s_add_u32 m0, s47, 81920
s_mul_i32 s48, s18, 65536
s_add_u32 s48, s48, s46
s_add_u32 s48, s48, 1048960
buffer_load_dwordx4 v14, s[20:23], s48 offen lds
s_mul_i32 s47, s18, 1024
s_add_u32 m0, s47, 86016
s_mul_i32 s48, s18, 65536
s_add_u32 s48, s48, s46
s_add_u32 s48, s48, 1311104
buffer_load_dwordx4 v14, s[20:23], s48 offen lds
s_mul_i32 s47, s18, 1024
s_add_u32 m0, s47, 90112
s_mul_i32 s48, s18, 65536
s_add_u32 s48, s48, s46
s_add_u32 s48, s48, 1573248
buffer_load_dwordx4 v14, s[20:23], s48 offen lds
s_mul_i32 s47, s18, 1024
s_add_u32 m0, s47, 94208
s_mul_i32 s48, s18, 65536
s_add_u32 s48, s48, s46
s_add_u32 s48, s48, 1835392
buffer_load_dwordx4 v14, s[20:23], s48 offen lds
s_mul_i32 s47, s18, 1024
s_add_u32 m0, s47, 98304
s_mul_i32 s48, s18, 65536
s_add_u32 s48, s48, s46
s_add_u32 s48, s48, 2097536
buffer_load_dwordx4 v14, s[20:23], s48 offen lds
s_mul_i32 s47, s18, 1024
s_add_u32 m0, s47, 102400
s_mul_i32 s48, s18, 65536
s_add_u32 s48, s48, s46
s_add_u32 s48, s48, 2359680
buffer_load_dwordx4 v14, s[20:23], s48 offen lds
s_mul_i32 s47, s18, 1024
s_add_u32 m0, s47, 106496
s_mul_i32 s48, s18, 65536
s_add_u32 s48, s48, s46
s_add_u32 s48, s48, 2621824
buffer_load_dwordx4 v14, s[20:23], s48 offen lds
s_mul_i32 s47, s18, 1024
s_add_u32 m0, s47, 110592
s_mul_i32 s48, s18, 65536
s_add_u32 s48, s48, s46
s_add_u32 s48, s48, 2883968
buffer_load_dwordx4 v14, s[20:23], s48 offen lds
s_mul_i32 s47, s18, 1024
s_add_u32 m0, s47, 114688
s_mul_i32 s48, s18, 65536
s_add_u32 s48, s48, s46
s_add_u32 s48, s48, 3146112
buffer_load_dwordx4 v14, s[20:23], s48 offen lds
s_mul_i32 s47, s18, 1024
s_add_u32 m0, s47, 118784
s_mul_i32 s48, s18, 65536
s_add_u32 s48, s48, s46
s_add_u32 s48, s48, 3408256
buffer_load_dwordx4 v14, s[20:23], s48 offen lds
s_mul_i32 s47, s18, 1024
s_add_u32 m0, s47, 122880
s_add_u32 s48, s49, 0
s_lshl_b32 s47, s18, 3
s_add_u32 s48, s48, s47
s_lshl_b32 s48, s48, 13
s_add_u32 s48, s48, s46
s_add_u32 s48, s48, 384
buffer_load_dwordx4 v14, s[24:27], s48 offen lds
s_mul_i32 s47, s18, 1024
s_add_u32 m0, s47, 126976
s_add_u32 s48, s49, 32
s_lshl_b32 s47, s18, 3
s_add_u32 s48, s48, s47
s_lshl_b32 s48, s48, 13
s_add_u32 s48, s48, s46
s_add_u32 s48, s48, 384
buffer_load_dwordx4 v14, s[24:27], s48 offen lds
s_waitcnt vmcnt(16)
s_barrier
ds_read_b128 v[80:83], v68
ds_read_b128 v[84:87], v69
ds_read_b128 v[88:91], v70
ds_read_b128 v[92:95], v71
s_waitcnt lgkmcnt(0)
ds_read_b128 v[32:35], v21 offset:0
ds_read_b128 v[36:39], v21 offset:4096
ds_read_b128 v[40:43], v21 offset:8192
ds_read_b128 v[44:47], v21 offset:12288
ds_read_b128 v[48:51], v21 offset:16384
ds_read_b128 v[52:55], v21 offset:20480
s_waitcnt lgkmcnt(5)
v_mfma_f32_32x32x16_bf16 a[0:15], v[32:35], v[80:83], a[0:15]
ds_read_b128 v[56:59], v21 offset:24576
s_waitcnt lgkmcnt(5)
v_mfma_f32_32x32x16_bf16 a[16:31], v[36:39], v[80:83], a[16:31]
ds_read_b128 v[60:63], v22 offset:0
s_waitcnt lgkmcnt(5)
v_mfma_f32_32x32x16_bf16 a[32:47], v[40:43], v[80:83], a[32:47]
ds_read_b128 v[32:35], v22 offset:4096
s_waitcnt lgkmcnt(5)
v_mfma_f32_32x32x16_bf16 a[48:63], v[44:47], v[80:83], a[48:63]
ds_read_b128 v[36:39], v22 offset:8192
s_waitcnt lgkmcnt(5)
v_mfma_f32_32x32x16_bf16 a[64:79], v[48:51], v[80:83], a[64:79]
ds_read_b128 v[40:43], v22 offset:12288
s_waitcnt lgkmcnt(5)
v_mfma_f32_32x32x16_bf16 a[80:95], v[52:55], v[80:83], a[80:95]
ds_read_b128 v[44:47], v22 offset:16384
s_waitcnt lgkmcnt(5)
v_mfma_f32_32x32x16_bf16 a[96:111], v[56:59], v[80:83], a[96:111]
ds_read_b128 v[48:51], v22 offset:20480
s_waitcnt lgkmcnt(5)
v_mfma_f32_32x32x16_bf16 a[0:15], v[60:63], v[84:87], a[0:15]
ds_read_b128 v[52:55], v22 offset:24576
s_waitcnt lgkmcnt(5)
v_mfma_f32_32x32x16_bf16 a[16:31], v[32:35], v[84:87], a[16:31]
ds_read_b128 v[56:59], v23 offset:0
s_waitcnt lgkmcnt(5)
v_mfma_f32_32x32x16_bf16 a[32:47], v[36:39], v[84:87], a[32:47]
ds_read_b128 v[60:63], v23 offset:4096
s_waitcnt lgkmcnt(5)
v_mfma_f32_32x32x16_bf16 a[48:63], v[40:43], v[84:87], a[48:63]
ds_read_b128 v[32:35], v23 offset:8192
s_waitcnt lgkmcnt(5)
v_mfma_f32_32x32x16_bf16 a[64:79], v[44:47], v[84:87], a[64:79]
ds_read_b128 v[36:39], v23 offset:12288
s_waitcnt lgkmcnt(5)
v_mfma_f32_32x32x16_bf16 a[80:95], v[48:51], v[84:87], a[80:95]
ds_read_b128 v[40:43], v23 offset:16384
s_waitcnt lgkmcnt(5)
v_mfma_f32_32x32x16_bf16 a[96:111], v[52:55], v[84:87], a[96:111]
ds_read_b128 v[44:47], v23 offset:20480
s_waitcnt lgkmcnt(5)
v_mfma_f32_32x32x16_bf16 a[0:15], v[56:59], v[88:91], a[0:15]
ds_read_b128 v[48:51], v23 offset:24576
s_waitcnt lgkmcnt(5)
v_mfma_f32_32x32x16_bf16 a[16:31], v[60:63], v[88:91], a[16:31]
ds_read_b128 v[52:55], v24 offset:0
s_waitcnt lgkmcnt(5)
v_mfma_f32_32x32x16_bf16 a[32:47], v[32:35], v[88:91], a[32:47]
ds_read_b128 v[56:59], v24 offset:4096
s_waitcnt lgkmcnt(5)
v_mfma_f32_32x32x16_bf16 a[48:63], v[36:39], v[88:91], a[48:63]
ds_read_b128 v[60:63], v24 offset:8192
s_waitcnt lgkmcnt(5)
v_mfma_f32_32x32x16_bf16 a[64:79], v[40:43], v[88:91], a[64:79]
ds_read_b128 v[32:35], v24 offset:12288
s_waitcnt lgkmcnt(5)
v_mfma_f32_32x32x16_bf16 a[80:95], v[44:47], v[88:91], a[80:95]
ds_read_b128 v[36:39], v24 offset:16384
s_waitcnt lgkmcnt(5)
v_mfma_f32_32x32x16_bf16 a[96:111], v[48:51], v[88:91], a[96:111]
ds_read_b128 v[40:43], v24 offset:20480
s_waitcnt lgkmcnt(5)
v_mfma_f32_32x32x16_bf16 a[0:15], v[52:55], v[92:95], a[0:15]
ds_read_b128 v[44:47], v24 offset:24576
s_waitcnt lgkmcnt(5)
v_mfma_f32_32x32x16_bf16 a[16:31], v[56:59], v[92:95], a[16:31]
s_waitcnt lgkmcnt(4)
v_mfma_f32_32x32x16_bf16 a[32:47], v[60:63], v[92:95], a[32:47]
s_waitcnt lgkmcnt(3)
v_mfma_f32_32x32x16_bf16 a[48:63], v[32:35], v[92:95], a[48:63]
s_waitcnt lgkmcnt(2)
v_mfma_f32_32x32x16_bf16 a[64:79], v[36:39], v[92:95], a[64:79]
s_waitcnt lgkmcnt(1)
v_mfma_f32_32x32x16_bf16 a[80:95], v[40:43], v[92:95], a[80:95]
s_waitcnt lgkmcnt(0)
v_mfma_f32_32x32x16_bf16 a[96:111], v[44:47], v[92:95], a[96:111]
s_barrier
s_waitcnt vmcnt(0)
s_barrier
ds_read_b128 v[80:83], v72
ds_read_b128 v[84:87], v73
ds_read_b128 v[88:91], v74
ds_read_b128 v[92:95], v75
s_waitcnt lgkmcnt(0)
ds_read_b128 v[32:35], v64 offset:0
ds_read_b128 v[36:39], v64 offset:4096
ds_read_b128 v[40:43], v64 offset:8192
ds_read_b128 v[44:47], v64 offset:12288
ds_read_b128 v[48:51], v64 offset:16384
ds_read_b128 v[52:55], v64 offset:20480
s_waitcnt lgkmcnt(5)
v_mfma_f32_32x32x16_bf16 a[0:15], v[32:35], v[80:83], a[0:15]
ds_read_b128 v[56:59], v64 offset:24576
s_waitcnt lgkmcnt(5)
v_mfma_f32_32x32x16_bf16 a[16:31], v[36:39], v[80:83], a[16:31]
ds_read_b128 v[60:63], v65 offset:0
s_waitcnt lgkmcnt(5)
v_mfma_f32_32x32x16_bf16 a[32:47], v[40:43], v[80:83], a[32:47]
ds_read_b128 v[32:35], v65 offset:4096
s_waitcnt lgkmcnt(5)
v_mfma_f32_32x32x16_bf16 a[48:63], v[44:47], v[80:83], a[48:63]
ds_read_b128 v[36:39], v65 offset:8192
s_waitcnt lgkmcnt(5)
v_mfma_f32_32x32x16_bf16 a[64:79], v[48:51], v[80:83], a[64:79]
ds_read_b128 v[40:43], v65 offset:12288
s_waitcnt lgkmcnt(5)
v_mfma_f32_32x32x16_bf16 a[80:95], v[52:55], v[80:83], a[80:95]
ds_read_b128 v[44:47], v65 offset:16384
s_waitcnt lgkmcnt(5)
v_mfma_f32_32x32x16_bf16 a[96:111], v[56:59], v[80:83], a[96:111]
ds_read_b128 v[48:51], v65 offset:20480
s_waitcnt lgkmcnt(5)
v_mfma_f32_32x32x16_bf16 a[0:15], v[60:63], v[84:87], a[0:15]
ds_read_b128 v[52:55], v65 offset:24576
s_waitcnt lgkmcnt(5)
v_mfma_f32_32x32x16_bf16 a[16:31], v[32:35], v[84:87], a[16:31]
ds_read_b128 v[56:59], v66 offset:0
s_waitcnt lgkmcnt(5)
v_mfma_f32_32x32x16_bf16 a[32:47], v[36:39], v[84:87], a[32:47]
ds_read_b128 v[60:63], v66 offset:4096
s_waitcnt lgkmcnt(5)
v_mfma_f32_32x32x16_bf16 a[48:63], v[40:43], v[84:87], a[48:63]
ds_read_b128 v[32:35], v66 offset:8192
s_waitcnt lgkmcnt(5)
v_mfma_f32_32x32x16_bf16 a[64:79], v[44:47], v[84:87], a[64:79]
ds_read_b128 v[36:39], v66 offset:12288
s_waitcnt lgkmcnt(5)
v_mfma_f32_32x32x16_bf16 a[80:95], v[48:51], v[84:87], a[80:95]
ds_read_b128 v[40:43], v66 offset:16384
s_waitcnt lgkmcnt(5)
v_mfma_f32_32x32x16_bf16 a[96:111], v[52:55], v[84:87], a[96:111]
ds_read_b128 v[44:47], v66 offset:20480
s_waitcnt lgkmcnt(5)
v_mfma_f32_32x32x16_bf16 a[0:15], v[56:59], v[88:91], a[0:15]
ds_read_b128 v[48:51], v66 offset:24576
s_waitcnt lgkmcnt(5)
v_mfma_f32_32x32x16_bf16 a[16:31], v[60:63], v[88:91], a[16:31]
ds_read_b128 v[52:55], v67 offset:0
s_waitcnt lgkmcnt(5)
v_mfma_f32_32x32x16_bf16 a[32:47], v[32:35], v[88:91], a[32:47]
ds_read_b128 v[56:59], v67 offset:4096
s_waitcnt lgkmcnt(5)
v_mfma_f32_32x32x16_bf16 a[48:63], v[36:39], v[88:91], a[48:63]
ds_read_b128 v[60:63], v67 offset:8192
s_waitcnt lgkmcnt(5)
v_mfma_f32_32x32x16_bf16 a[64:79], v[40:43], v[88:91], a[64:79]
ds_read_b128 v[32:35], v67 offset:12288
s_waitcnt lgkmcnt(5)
v_mfma_f32_32x32x16_bf16 a[80:95], v[44:47], v[88:91], a[80:95]
ds_read_b128 v[36:39], v67 offset:16384
s_waitcnt lgkmcnt(5)
v_mfma_f32_32x32x16_bf16 a[96:111], v[48:51], v[88:91], a[96:111]
ds_read_b128 v[40:43], v67 offset:20480
s_waitcnt lgkmcnt(5)
v_mfma_f32_32x32x16_bf16 a[0:15], v[52:55], v[92:95], a[0:15]
ds_read_b128 v[44:47], v67 offset:24576
s_waitcnt lgkmcnt(5)
v_mfma_f32_32x32x16_bf16 a[16:31], v[56:59], v[92:95], a[16:31]
s_waitcnt lgkmcnt(4)
v_mfma_f32_32x32x16_bf16 a[32:47], v[60:63], v[92:95], a[32:47]
s_waitcnt lgkmcnt(3)
v_mfma_f32_32x32x16_bf16 a[48:63], v[32:35], v[92:95], a[48:63]
s_waitcnt lgkmcnt(2)
v_mfma_f32_32x32x16_bf16 a[64:79], v[36:39], v[92:95], a[64:79]
s_waitcnt lgkmcnt(1)
v_mfma_f32_32x32x16_bf16 a[80:95], v[40:43], v[92:95], a[80:95]
s_waitcnt lgkmcnt(0)
v_mfma_f32_32x32x16_bf16 a[96:111], v[44:47], v[92:95], a[96:111]
s_barrier
v_accvgpr_read_b32 v40, a0
v_accvgpr_read_b32 v41, a1
v_accvgpr_read_b32 v42, a2
v_accvgpr_read_b32 v43, a3
v_accvgpr_read_b32 v44, a4
v_accvgpr_read_b32 v45, a5
v_accvgpr_read_b32 v46, a6
v_accvgpr_read_b32 v47, a7
v_mul_f32 v40, s34, v40
v_mul_f32 v41, s34, v41
v_mul_f32 v42, s34, v42
v_mul_f32 v43, s34, v43
v_mul_f32 v44, s34, v44
v_mul_f32 v45, s34, v45
v_mul_f32 v46, s34, v46
v_mul_f32 v47, s34, v47
v_cvt_pk_bf16_f32 v32, v40, v41
v_cvt_pk_bf16_f32 v33, v42, v43
v_cvt_pk_bf16_f32 v34, v44, v45
v_cvt_pk_bf16_f32 v35, v46, v47
s_mov_b32 s33, 0
buffer_store_dwordx4 v[32:35], v15, s[4:7], s33 offen
v_accvgpr_read_b32 v40, a8
v_accvgpr_read_b32 v41, a9
v_accvgpr_read_b32 v42, a10
v_accvgpr_read_b32 v43, a11
v_accvgpr_read_b32 v44, a12
v_accvgpr_read_b32 v45, a13
v_accvgpr_read_b32 v46, a14
v_accvgpr_read_b32 v47, a15
v_mul_f32 v40, s34, v40
v_mul_f32 v41, s34, v41
v_mul_f32 v42, s34, v42
v_mul_f32 v43, s34, v43
v_mul_f32 v44, s34, v44
v_mul_f32 v45, s34, v45
v_mul_f32 v46, s34, v46
v_mul_f32 v47, s34, v47
v_cvt_pk_bf16_f32 v36, v40, v41
v_cvt_pk_bf16_f32 v37, v42, v43
v_cvt_pk_bf16_f32 v38, v44, v45
v_cvt_pk_bf16_f32 v39, v46, v47
s_mov_b32 s33, 512
buffer_store_dwordx4 v[36:39], v15, s[4:7], s33 offen
v_accvgpr_read_b32 v40, a16
v_accvgpr_read_b32 v41, a17
v_accvgpr_read_b32 v42, a18
v_accvgpr_read_b32 v43, a19
v_accvgpr_read_b32 v44, a20
v_accvgpr_read_b32 v45, a21
v_accvgpr_read_b32 v46, a22
v_accvgpr_read_b32 v47, a23
v_mul_f32 v40, s34, v40
v_mul_f32 v41, s34, v41
v_mul_f32 v42, s34, v42
v_mul_f32 v43, s34, v43
v_mul_f32 v44, s34, v44
v_mul_f32 v45, s34, v45
v_mul_f32 v46, s34, v46
v_mul_f32 v47, s34, v47
v_cvt_pk_bf16_f32 v32, v40, v41
v_cvt_pk_bf16_f32 v33, v42, v43
v_cvt_pk_bf16_f32 v34, v44, v45
v_cvt_pk_bf16_f32 v35, v46, v47
s_mov_b32 s33, 1024
buffer_store_dwordx4 v[32:35], v15, s[4:7], s33 offen
v_accvgpr_read_b32 v40, a24
v_accvgpr_read_b32 v41, a25
v_accvgpr_read_b32 v42, a26
v_accvgpr_read_b32 v43, a27
v_accvgpr_read_b32 v44, a28
v_accvgpr_read_b32 v45, a29
v_accvgpr_read_b32 v46, a30
v_accvgpr_read_b32 v47, a31
v_mul_f32 v40, s34, v40
v_mul_f32 v41, s34, v41
v_mul_f32 v42, s34, v42
v_mul_f32 v43, s34, v43
v_mul_f32 v44, s34, v44
v_mul_f32 v45, s34, v45
v_mul_f32 v46, s34, v46
v_mul_f32 v47, s34, v47
v_cvt_pk_bf16_f32 v36, v40, v41
v_cvt_pk_bf16_f32 v37, v42, v43
v_cvt_pk_bf16_f32 v38, v44, v45
v_cvt_pk_bf16_f32 v39, v46, v47
s_mov_b32 s33, 1536
buffer_store_dwordx4 v[36:39], v15, s[4:7], s33 offen
v_accvgpr_read_b32 v40, a32
v_accvgpr_read_b32 v41, a33
v_accvgpr_read_b32 v42, a34
v_accvgpr_read_b32 v43, a35
v_accvgpr_read_b32 v44, a36
v_accvgpr_read_b32 v45, a37
v_accvgpr_read_b32 v46, a38
v_accvgpr_read_b32 v47, a39
v_mul_f32 v40, s34, v40
v_mul_f32 v41, s34, v41
v_mul_f32 v42, s34, v42
v_mul_f32 v43, s34, v43
v_mul_f32 v44, s34, v44
v_mul_f32 v45, s34, v45
v_mul_f32 v46, s34, v46
v_mul_f32 v47, s34, v47
v_cvt_pk_bf16_f32 v32, v40, v41
v_cvt_pk_bf16_f32 v33, v42, v43
v_cvt_pk_bf16_f32 v34, v44, v45
v_cvt_pk_bf16_f32 v35, v46, v47
s_mov_b32 s33, 2048
buffer_store_dwordx4 v[32:35], v15, s[4:7], s33 offen
v_accvgpr_read_b32 v40, a40
v_accvgpr_read_b32 v41, a41
v_accvgpr_read_b32 v42, a42
v_accvgpr_read_b32 v43, a43
v_accvgpr_read_b32 v44, a44
v_accvgpr_read_b32 v45, a45
v_accvgpr_read_b32 v46, a46
v_accvgpr_read_b32 v47, a47
v_mul_f32 v40, s34, v40
v_mul_f32 v41, s34, v41
v_mul_f32 v42, s34, v42
v_mul_f32 v43, s34, v43
v_mul_f32 v44, s34, v44
v_mul_f32 v45, s34, v45
v_mul_f32 v46, s34, v46
v_mul_f32 v47, s34, v47
v_cvt_pk_bf16_f32 v36, v40, v41
v_cvt_pk_bf16_f32 v37, v42, v43
v_cvt_pk_bf16_f32 v38, v44, v45
v_cvt_pk_bf16_f32 v39, v46, v47
s_mov_b32 s33, 2560
buffer_store_dwordx4 v[36:39], v15, s[4:7], s33 offen
v_accvgpr_read_b32 v40, a48
v_accvgpr_read_b32 v41, a49
v_accvgpr_read_b32 v42, a50
v_accvgpr_read_b32 v43, a51
v_accvgpr_read_b32 v44, a52
v_accvgpr_read_b32 v45, a53
v_accvgpr_read_b32 v46, a54
v_accvgpr_read_b32 v47, a55
v_mul_f32 v40, s34, v40
v_mul_f32 v41, s34, v41
v_mul_f32 v42, s34, v42
v_mul_f32 v43, s34, v43
v_mul_f32 v44, s34, v44
v_mul_f32 v45, s34, v45
v_mul_f32 v46, s34, v46
v_mul_f32 v47, s34, v47
v_cvt_pk_bf16_f32 v32, v40, v41
v_cvt_pk_bf16_f32 v33, v42, v43
v_cvt_pk_bf16_f32 v34, v44, v45
v_cvt_pk_bf16_f32 v35, v46, v47
s_mov_b32 s33, 3072
buffer_store_dwordx4 v[32:35], v15, s[4:7], s33 offen
v_accvgpr_read_b32 v40, a56
v_accvgpr_read_b32 v41, a57
v_accvgpr_read_b32 v42, a58
v_accvgpr_read_b32 v43, a59
v_accvgpr_read_b32 v44, a60
v_accvgpr_read_b32 v45, a61
v_accvgpr_read_b32 v46, a62
v_accvgpr_read_b32 v47, a63
v_mul_f32 v40, s34, v40
v_mul_f32 v41, s34, v41
v_mul_f32 v42, s34, v42
v_mul_f32 v43, s34, v43
v_mul_f32 v44, s34, v44
v_mul_f32 v45, s34, v45
v_mul_f32 v46, s34, v46
v_mul_f32 v47, s34, v47
v_cvt_pk_bf16_f32 v36, v40, v41
v_cvt_pk_bf16_f32 v37, v42, v43
v_cvt_pk_bf16_f32 v38, v44, v45
v_cvt_pk_bf16_f32 v39, v46, v47
s_mov_b32 s33, 3584
buffer_store_dwordx4 v[36:39], v15, s[4:7], s33 offen
v_accvgpr_read_b32 v40, a64
v_accvgpr_read_b32 v41, a65
v_accvgpr_read_b32 v42, a66
v_accvgpr_read_b32 v43, a67
v_accvgpr_read_b32 v44, a68
v_accvgpr_read_b32 v45, a69
v_accvgpr_read_b32 v46, a70
v_accvgpr_read_b32 v47, a71
v_mul_f32 v40, s34, v40
v_mul_f32 v41, s34, v41
v_mul_f32 v42, s34, v42
v_mul_f32 v43, s34, v43
v_mul_f32 v44, s34, v44
v_mul_f32 v45, s34, v45
v_mul_f32 v46, s34, v46
v_mul_f32 v47, s34, v47
v_cvt_pk_bf16_f32 v32, v40, v41
v_cvt_pk_bf16_f32 v33, v42, v43
v_cvt_pk_bf16_f32 v34, v44, v45
v_cvt_pk_bf16_f32 v35, v46, v47
s_mov_b32 s33, 4096
buffer_store_dwordx4 v[32:35], v15, s[4:7], s33 offen
v_accvgpr_read_b32 v40, a72
v_accvgpr_read_b32 v41, a73
v_accvgpr_read_b32 v42, a74
v_accvgpr_read_b32 v43, a75
v_accvgpr_read_b32 v44, a76
v_accvgpr_read_b32 v45, a77
v_accvgpr_read_b32 v46, a78
v_accvgpr_read_b32 v47, a79
v_mul_f32 v40, s34, v40
v_mul_f32 v41, s34, v41
v_mul_f32 v42, s34, v42
v_mul_f32 v43, s34, v43
v_mul_f32 v44, s34, v44
v_mul_f32 v45, s34, v45
v_mul_f32 v46, s34, v46
v_mul_f32 v47, s34, v47
v_cvt_pk_bf16_f32 v36, v40, v41
v_cvt_pk_bf16_f32 v37, v42, v43
v_cvt_pk_bf16_f32 v38, v44, v45
v_cvt_pk_bf16_f32 v39, v46, v47
s_mov_b32 s33, 4608
buffer_store_dwordx4 v[36:39], v15, s[4:7], s33 offen
v_accvgpr_read_b32 v40, a80
v_accvgpr_read_b32 v41, a81
v_accvgpr_read_b32 v42, a82
v_accvgpr_read_b32 v43, a83
v_accvgpr_read_b32 v44, a84
v_accvgpr_read_b32 v45, a85
v_accvgpr_read_b32 v46, a86
v_accvgpr_read_b32 v47, a87
v_mul_f32 v40, s34, v40
v_mul_f32 v41, s34, v41
v_mul_f32 v42, s34, v42
v_mul_f32 v43, s34, v43
v_mul_f32 v44, s34, v44
v_mul_f32 v45, s34, v45
v_mul_f32 v46, s34, v46
v_mul_f32 v47, s34, v47
v_cvt_pk_bf16_f32 v32, v40, v41
v_cvt_pk_bf16_f32 v33, v42, v43
v_cvt_pk_bf16_f32 v34, v44, v45
v_cvt_pk_bf16_f32 v35, v46, v47
s_mov_b32 s33, 5120
buffer_store_dwordx4 v[32:35], v15, s[4:7], s33 offen
v_accvgpr_read_b32 v40, a88
v_accvgpr_read_b32 v41, a89
v_accvgpr_read_b32 v42, a90
v_accvgpr_read_b32 v43, a91
v_accvgpr_read_b32 v44, a92
v_accvgpr_read_b32 v45, a93
v_accvgpr_read_b32 v46, a94
v_accvgpr_read_b32 v47, a95
v_mul_f32 v40, s34, v40
v_mul_f32 v41, s34, v41
v_mul_f32 v42, s34, v42
v_mul_f32 v43, s34, v43
v_mul_f32 v44, s34, v44
v_mul_f32 v45, s34, v45
v_mul_f32 v46, s34, v46
v_mul_f32 v47, s34, v47
v_cvt_pk_bf16_f32 v36, v40, v41
v_cvt_pk_bf16_f32 v37, v42, v43
v_cvt_pk_bf16_f32 v38, v44, v45
v_cvt_pk_bf16_f32 v39, v46, v47
s_mov_b32 s33, 5632
buffer_store_dwordx4 v[36:39], v15, s[4:7], s33 offen
v_accvgpr_read_b32 v40, a96
v_accvgpr_read_b32 v41, a97
v_accvgpr_read_b32 v42, a98
v_accvgpr_read_b32 v43, a99
v_accvgpr_read_b32 v44, a100
v_accvgpr_read_b32 v45, a101
v_accvgpr_read_b32 v46, a102
v_accvgpr_read_b32 v47, a103
v_mul_f32 v40, s34, v40
v_mul_f32 v41, s34, v41
v_mul_f32 v42, s34, v42
v_mul_f32 v43, s34, v43
v_mul_f32 v44, s34, v44
v_mul_f32 v45, s34, v45
v_mul_f32 v46, s34, v46
v_mul_f32 v47, s34, v47
v_cvt_pk_bf16_f32 v32, v40, v41
v_cvt_pk_bf16_f32 v33, v42, v43
v_cvt_pk_bf16_f32 v34, v44, v45
v_cvt_pk_bf16_f32 v35, v46, v47
s_mov_b32 s33, 6144
buffer_store_dwordx4 v[32:35], v15, s[4:7], s33 offen
v_accvgpr_read_b32 v40, a104
v_accvgpr_read_b32 v41, a105
v_accvgpr_read_b32 v42, a106
v_accvgpr_read_b32 v43, a107
v_accvgpr_read_b32 v44, a108
v_accvgpr_read_b32 v45, a109
v_accvgpr_read_b32 v46, a110
v_accvgpr_read_b32 v47, a111
v_mul_f32 v40, s34, v40
v_mul_f32 v41, s34, v41
v_mul_f32 v42, s34, v42
v_mul_f32 v43, s34, v43
v_mul_f32 v44, s34, v44
v_mul_f32 v45, s34, v45
v_mul_f32 v46, s34, v46
v_mul_f32 v47, s34, v47
v_cvt_pk_bf16_f32 v36, v40, v41
v_cvt_pk_bf16_f32 v37, v42, v43
v_cvt_pk_bf16_f32 v38, v44, v45
v_cvt_pk_bf16_f32 v39, v46, v47
s_mov_b32 s33, 6656
buffer_store_dwordx4 v[36:39], v15, s[4:7], s33 offen
s_branch PREP_TAIL
PREP_B:
s_sub_u32 s35, s77, 14
s_and_b32 s49, s35, 7
s_lshr_b32 s35, s35, 3
s_lshl_b32 s37, s76, 1
s_add_u32 s35, s35, s37
s_lshl_b32 s36, s49, 1
s_add_u32 s36, s36, s31
s_lshl_b32 s46, s35, 9
s_mov_b32 s20, s60
s_and_b32 s21, s61, 0xffff
s_mov_b32 s22, 3670016
s_mov_b32 s23, 0x20000
s_mov_b32 s24, s62
s_and_b32 s25, s63, 0xffff
s_mov_b32 s26, 3670016
s_mov_b32 s27, 0x20000
s_bitcmp1_b32 s18, 0
s_cbranch_scc1 PV14_25a
v_mov_b32 v14, v12
s_branch PV14_25b
PV14_25a:
v_mov_b32 v14, v13
PV14_25b:
v_add_u32 v64, 65536, v21
v_add_u32 v65, 65536, v22
v_add_u32 v66, 65536, v23
v_add_u32 v67, 65536, v24
v_lshrrev_b32 v28, 3, v16
v_mul_u32_u24 v3, 896, v28
v_and_b32 v28, 7, v16
v_lshl_add_u32 v3, v28, 4, v3
s_mul_i32 s50, s35, 229376
s_mul_i32 s51, s49, 112
s_add_u32 s50, s50, s51
v_lshrrev_b32 v28, 4, v16
v_and_b32 v29, 1, v28
v_lshrrev_b32 v28, 1, v28
v_bfe_u32 v30, v16, 2, 2
v_lshl_add_u32 v30, v28, 3, v30
v_lshlrev_b32 v30, 7, v30
v_and_b32 v31, 3, v16
v_lshlrev_b32 v31, 3, v31
v_lshl_add_u32 v31, v29, 5, v31
v_add_u32 v30, v30, v31
s_mul_i32 s37, s31, 56
s_add_u32 s37, s37, 57344
v_add_u32 v68, s37, v30
v_add_u32 v72, 65536, v68
s_mul_i32 s38, s35, 28
v_add_u32 v28, s38, v17
v_lshrrev_b32 v29, 4, v28
v_and_b32 v28, 15, v28
s_mul_i32 s38, s36, 28
s_add_u32 s38, s38, 448
s_mul_i32 s38, s38, 14336
s_lshl_b32 s39, s30, 10
s_add_u32 s38, s38, s39
s_add_u32 s38, s38, 65536
v_mul_u32_u24 v15, 14336, v29
v_lshl_add_u32 v15, v28, 4, v15
v_lshl_add_u32 v15, v18, 8, v15
v_add_u32 v15, s38, v15
s_mul_i32 s47, s18, 1024
s_add_u32 m0, s47, 0
s_mul_i32 s48, s18, 65536
s_add_u32 s48, s48, s46
s_add_u32 s48, s48, 0
buffer_load_dwordx4 v14, s[20:23], s48 offen lds
s_mul_i32 s47, s18, 1024
s_add_u32 m0, s47, 4096
s_mul_i32 s48, s18, 65536
s_add_u32 s48, s48, s46
s_add_u32 s48, s48, 262144
buffer_load_dwordx4 v14, s[20:23], s48 offen lds
s_mul_i32 s47, s18, 1024
s_add_u32 m0, s47, 8192
s_mul_i32 s48, s18, 65536
s_add_u32 s48, s48, s46
s_add_u32 s48, s48, 524288
buffer_load_dwordx4 v14, s[20:23], s48 offen lds
s_mul_i32 s47, s18, 1024
s_add_u32 m0, s47, 12288
s_mul_i32 s48, s18, 65536
s_add_u32 s48, s48, s46
s_add_u32 s48, s48, 786432
buffer_load_dwordx4 v14, s[20:23], s48 offen lds
s_mul_i32 s47, s18, 1024
s_add_u32 m0, s47, 16384
s_mul_i32 s48, s18, 65536
s_add_u32 s48, s48, s46
s_add_u32 s48, s48, 1048576
buffer_load_dwordx4 v14, s[20:23], s48 offen lds
s_mul_i32 s47, s18, 1024
s_add_u32 m0, s47, 20480
s_mul_i32 s48, s18, 65536
s_add_u32 s48, s48, s46
s_add_u32 s48, s48, 1310720
buffer_load_dwordx4 v14, s[20:23], s48 offen lds
s_mul_i32 s47, s18, 1024
s_add_u32 m0, s47, 24576
s_mul_i32 s48, s18, 65536
s_add_u32 s48, s48, s46
s_add_u32 s48, s48, 1572864
buffer_load_dwordx4 v14, s[20:23], s48 offen lds
s_mul_i32 s47, s18, 1024
s_add_u32 m0, s47, 28672
s_mul_i32 s48, s18, 65536
s_add_u32 s48, s48, s46
s_add_u32 s48, s48, 1835008
buffer_load_dwordx4 v14, s[20:23], s48 offen lds
s_mul_i32 s47, s18, 1024
s_add_u32 m0, s47, 32768
s_mul_i32 s48, s18, 65536
s_add_u32 s48, s48, s46
s_add_u32 s48, s48, 2097152
buffer_load_dwordx4 v14, s[20:23], s48 offen lds
s_mul_i32 s47, s18, 1024
s_add_u32 m0, s47, 36864
s_mul_i32 s48, s18, 65536
s_add_u32 s48, s48, s46
s_add_u32 s48, s48, 2359296
buffer_load_dwordx4 v14, s[20:23], s48 offen lds
s_mul_i32 s47, s18, 1024
s_add_u32 m0, s47, 40960
s_mul_i32 s48, s18, 65536
s_add_u32 s48, s48, s46
s_add_u32 s48, s48, 2621440
buffer_load_dwordx4 v14, s[20:23], s48 offen lds
s_mul_i32 s47, s18, 1024
s_add_u32 m0, s47, 45056
s_mul_i32 s48, s18, 65536
s_add_u32 s48, s48, s46
s_add_u32 s48, s48, 2883584
buffer_load_dwordx4 v14, s[20:23], s48 offen lds
s_mul_i32 s47, s18, 1024
s_add_u32 m0, s47, 49152
s_mul_i32 s48, s18, 65536
s_add_u32 s48, s48, s46
s_add_u32 s48, s48, 3145728
buffer_load_dwordx4 v14, s[20:23], s48 offen lds
s_mul_i32 s47, s18, 1024
s_add_u32 m0, s47, 53248
s_mul_i32 s48, s18, 65536
s_add_u32 s48, s48, s46
s_add_u32 s48, s48, 3407872
buffer_load_dwordx4 v14, s[20:23], s48 offen lds
s_mul_i32 s47, s18, 1024
s_add_u32 m0, s47, 57344
s_lshl_b32 s47, s18, 3
s_add_u32 s47, s47, 0
s_mul_i32 s47, s47, 896
s_add_u32 s48, s47, s50
buffer_load_dwordx4 v3, s[24:27], s48 offen lds
s_mul_i32 s47, s18, 1024
s_add_u32 m0, s47, 61440
s_lshl_b32 s47, s18, 3
s_add_u32 s47, s47, 32
s_mul_i32 s47, s47, 896
s_add_u32 s48, s47, s50
buffer_load_dwordx4 v3, s[24:27], s48 offen lds
s_mov_b32 s44, s2
FL_27:
s_cmp_ge_u32 s44, 112
s_cbranch_scc1 FE_28
s_lshl_b32 s45, s44, 12
s_add_u32 s45, s45, 33045504
buffer_store_dwordx4 v[4:7], v2, s[4:7], s45 offen
s_add_u32 s44, s44, 256
s_branch FL_27
FE_28:
s_mov_b32 s44, s2
FL_29:
s_cmp_ge_u32 s44, 160
s_cbranch_scc1 FE_30
s_lshl_b32 s45, s44, 12
s_add_u32 s45, s45, 33972224
buffer_store_dwordx4 v[4:7], v2, s[4:7], s45 offen
s_add_u32 s44, s44, 256
s_branch FL_29
FE_30:
s_mov_b32 s44, s2
FL_31:
s_cmp_ge_u32 s44, 640
s_cbranch_scc1 FE_32
s_lshl_b32 s45, s44, 12
s_add_u32 s45, s45, 35282944
buffer_store_dwordx4 v[4:7], v2, s[4:7], s45 offen
s_add_u32 s44, s44, 256
s_branch FL_31
FE_32:
s_mov_b32 s44, s2
FL_33:
s_cmp_ge_u32 s44, 112
s_cbranch_scc1 FE_34
s_lshl_b32 s45, s44, 12
s_add_u32 s45, s45, 33512448
buffer_store_dwordx4 v[4:7], v2, s[4:7], s45 offen
s_add_u32 s44, s44, 256
s_branch FL_33
FE_34:
s_mov_b32 s44, s2
FL_35:
s_cmp_ge_u32 s44, 160
s_cbranch_scc1 FE_36
s_lshl_b32 s45, s44, 12
s_add_u32 s45, s45, 34627584
buffer_store_dwordx4 v[4:7], v2, s[4:7], s45 offen
s_add_u32 s44, s44, 256
s_branch FL_35
FE_36:
s_mov_b32 s44, s2
FL_37:
s_cmp_ge_u32 s44, 640
s_cbranch_scc1 FE_38
s_lshl_b32 s45, s44, 12
s_add_u32 s45, s45, 37904384
buffer_store_dwordx4 v[4:7], v2, s[4:7], s45 offen
s_add_u32 s44, s44, 256
s_branch FL_37
FE_38:
s_mov_b32 s44, s2
FL_39:
s_cmp_ge_u32 s44, 448
s_cbranch_scc1 FE_40
s_lshl_b32 s45, s44, 12
s_add_u32 s45, s45, 23863296
buffer_store_dwordx4 v[4:7], v2, s[4:7], s45 offen
s_add_u32 s44, s44, 256
s_branch FL_39
FE_40:
s_mov_b32 s44, s2
FL_41:
s_cmp_ge_u32 s44, 448
s_cbranch_scc1 FE_42
s_lshl_b32 s45, s44, 12
s_add_u32 s45, s45, 25698304
buffer_store_dwordx4 v[4:7], v2, s[4:7], s45 offen
s_add_u32 s44, s44, 256
s_branch FL_41
FE_42:
s_mov_b32 s44, s2
FL_43:
s_cmp_ge_u32 s44, 448
s_cbranch_scc1 FE_44
s_lshl_b32 s45, s44, 12
s_add_u32 s45, s45, 27533312
buffer_store_dwordx4 v[4:7], v2, s[4:7], s45 offen
s_add_u32 s44, s44, 256
s_branch FL_43
FE_44:
s_mov_b32 s44, s2
FL_45:
s_cmp_ge_u32 s44, 448
s_cbranch_scc1 FE_46
s_lshl_b32 s45, s44, 12
s_add_u32 s45, s45, 29368320
buffer_store_dwordx4 v[4:7], v2, s[4:7], s45 offen
s_add_u32 s44, s44, 256
s_branch FL_45
FE_46:
s_mov_b32 s44, s2
FL_47:
s_cmp_ge_u32 s44, 448
s_cbranch_scc1 FE_48
s_lshl_b32 s45, s44, 12
s_add_u32 s45, s45, 31203328
buffer_store_dwordx4 v[4:7], v2, s[4:7], s45 offen
s_add_u32 s44, s44, 256
s_branch FL_47
FE_48:
s_mov_b32 s44, s2
FL_49:
s_cmp_ge_u32 s44, 8
s_cbranch_scc1 FE_50
s_lshl_b32 s45, s44, 12
s_add_u32 s45, s45, 158031872
buffer_store_dwordx4 v[4:7], v2, s[4:7], s45 offen
s_add_u32 s44, s44, 256
s_branch FL_49
FE_50:
s_mul_i32 s47, s18, 1024
s_add_u32 m0, s47, 65536
s_mul_i32 s48, s18, 65536
s_add_u32 s48, s48, s46
s_add_u32 s48, s48, 128
buffer_load_dwordx4 v14, s[20:23], s48 offen lds
s_mul_i32 s47, s18, 1024
s_add_u32 m0, s47, 69632
s_mul_i32 s48, s18, 65536
s_add_u32 s48, s48, s46
s_add_u32 s48, s48, 262272
buffer_load_dwordx4 v14, s[20:23], s48 offen lds
s_mul_i32 s47, s18, 1024
s_add_u32 m0, s47, 73728
s_mul_i32 s48, s18, 65536
s_add_u32 s48, s48, s46
s_add_u32 s48, s48, 524416
buffer_load_dwordx4 v14, s[20:23], s48 offen lds
s_mul_i32 s47, s18, 1024
s_add_u32 m0, s47, 77824
s_mul_i32 s48, s18, 65536
s_add_u32 s48, s48, s46
s_add_u32 s48, s48, 786560
buffer_load_dwordx4 v14, s[20:23], s48 offen lds
s_mul_i32 s47, s18, 1024
s_add_u32 m0, s47, 81920
s_mul_i32 s48, s18, 65536
s_add_u32 s48, s48, s46
s_add_u32 s48, s48, 1048704
buffer_load_dwordx4 v14, s[20:23], s48 offen lds
s_mul_i32 s47, s18, 1024
s_add_u32 m0, s47, 86016
s_mul_i32 s48, s18, 65536
s_add_u32 s48, s48, s46
s_add_u32 s48, s48, 1310848
buffer_load_dwordx4 v14, s[20:23], s48 offen lds
s_mul_i32 s47, s18, 1024
s_add_u32 m0, s47, 90112
s_mul_i32 s48, s18, 65536
s_add_u32 s48, s48, s46
s_add_u32 s48, s48, 1572992
buffer_load_dwordx4 v14, s[20:23], s48 offen lds
s_mul_i32 s47, s18, 1024
s_add_u32 m0, s47, 94208
s_mul_i32 s48, s18, 65536
s_add_u32 s48, s48, s46
s_add_u32 s48, s48, 1835136
buffer_load_dwordx4 v14, s[20:23], s48 offen lds
s_mul_i32 s47, s18, 1024
s_add_u32 m0, s47, 98304
s_mul_i32 s48, s18, 65536
s_add_u32 s48, s48, s46
s_add_u32 s48, s48, 2097280
buffer_load_dwordx4 v14, s[20:23], s48 offen lds
s_mul_i32 s47, s18, 1024
s_add_u32 m0, s47, 102400
s_mul_i32 s48, s18, 65536
s_add_u32 s48, s48, s46
s_add_u32 s48, s48, 2359424
buffer_load_dwordx4 v14, s[20:23], s48 offen lds
s_mul_i32 s47, s18, 1024
s_add_u32 m0, s47, 106496
s_mul_i32 s48, s18, 65536
s_add_u32 s48, s48, s46
s_add_u32 s48, s48, 2621568
buffer_load_dwordx4 v14, s[20:23], s48 offen lds
s_mul_i32 s47, s18, 1024
s_add_u32 m0, s47, 110592
s_mul_i32 s48, s18, 65536
s_add_u32 s48, s48, s46
s_add_u32 s48, s48, 2883712
buffer_load_dwordx4 v14, s[20:23], s48 offen lds
s_mul_i32 s47, s18, 1024
s_add_u32 m0, s47, 114688
s_mul_i32 s48, s18, 65536
s_add_u32 s48, s48, s46
s_add_u32 s48, s48, 3145856
buffer_load_dwordx4 v14, s[20:23], s48 offen lds
s_mul_i32 s47, s18, 1024
s_add_u32 m0, s47, 118784
s_mul_i32 s48, s18, 65536
s_add_u32 s48, s48, s46
s_add_u32 s48, s48, 3408000
buffer_load_dwordx4 v14, s[20:23], s48 offen lds
s_mul_i32 s47, s18, 1024
s_add_u32 m0, s47, 122880
s_lshl_b32 s47, s18, 3
s_add_u32 s47, s47, 64
s_mul_i32 s47, s47, 896
s_add_u32 s48, s47, s50
buffer_load_dwordx4 v3, s[24:27], s48 offen lds
s_mul_i32 s47, s18, 1024
s_add_u32 m0, s47, 126976
s_lshl_b32 s47, s18, 3
s_add_u32 s47, s47, 96
s_mul_i32 s47, s47, 896
s_add_u32 s48, s47, s50
buffer_load_dwordx4 v3, s[24:27], s48 offen lds
s_waitcnt vmcnt(16)
s_barrier
ds_read_b64_tr_b16 v[80:81], v68 offset:0
ds_read_b64_tr_b16 v[82:83], v68 offset:512
ds_read_b64_tr_b16 v[84:85], v68 offset:2048
ds_read_b64_tr_b16 v[86:87], v68 offset:2560
ds_read_b64_tr_b16 v[88:89], v68 offset:4096
ds_read_b64_tr_b16 v[90:91], v68 offset:4608
ds_read_b64_tr_b16 v[92:93], v68 offset:6144
ds_read_b64_tr_b16 v[94:95], v68 offset:6656
s_waitcnt lgkmcnt(0)
ds_read_b128 v[32:35], v21 offset:0
ds_read_b128 v[36:39], v21 offset:4096
ds_read_b128 v[40:43], v21 offset:8192
ds_read_b128 v[44:47], v21 offset:12288
ds_read_b128 v[48:51], v21 offset:16384
ds_read_b128 v[52:55], v21 offset:20480
s_waitcnt lgkmcnt(5)
v_mfma_f32_32x32x16_bf16 a[0:15], v[32:35], v[80:83], 0
ds_read_b128 v[56:59], v21 offset:24576
s_waitcnt lgkmcnt(5)
v_mfma_f32_32x32x16_bf16 a[16:31], v[36:39], v[80:83], 0
ds_read_b128 v[60:63], v22 offset:0
s_waitcnt lgkmcnt(5)
v_mfma_f32_32x32x16_bf16 a[32:47], v[40:43], v[80:83], 0
ds_read_b128 v[32:35], v22 offset:4096
s_waitcnt lgkmcnt(5)
v_mfma_f32_32x32x16_bf16 a[48:63], v[44:47], v[80:83], 0
ds_read_b128 v[36:39], v22 offset:8192
s_waitcnt lgkmcnt(5)
v_mfma_f32_32x32x16_bf16 a[64:79], v[48:51], v[80:83], 0
ds_read_b128 v[40:43], v22 offset:12288
s_waitcnt lgkmcnt(5)
v_mfma_f32_32x32x16_bf16 a[80:95], v[52:55], v[80:83], 0
ds_read_b128 v[44:47], v22 offset:16384
s_waitcnt lgkmcnt(5)
v_mfma_f32_32x32x16_bf16 a[96:111], v[56:59], v[80:83], 0
ds_read_b128 v[48:51], v22 offset:20480
s_waitcnt lgkmcnt(5)
v_mfma_f32_32x32x16_bf16 a[0:15], v[60:63], v[84:87], a[0:15]
ds_read_b128 v[52:55], v22 offset:24576
s_waitcnt lgkmcnt(5)
v_mfma_f32_32x32x16_bf16 a[16:31], v[32:35], v[84:87], a[16:31]
ds_read_b128 v[56:59], v23 offset:0
s_waitcnt lgkmcnt(5)
v_mfma_f32_32x32x16_bf16 a[32:47], v[36:39], v[84:87], a[32:47]
ds_read_b128 v[60:63], v23 offset:4096
s_waitcnt lgkmcnt(5)
v_mfma_f32_32x32x16_bf16 a[48:63], v[40:43], v[84:87], a[48:63]
ds_read_b128 v[32:35], v23 offset:8192
s_waitcnt lgkmcnt(5)
v_mfma_f32_32x32x16_bf16 a[64:79], v[44:47], v[84:87], a[64:79]
ds_read_b128 v[36:39], v23 offset:12288
s_waitcnt lgkmcnt(5)
v_mfma_f32_32x32x16_bf16 a[80:95], v[48:51], v[84:87], a[80:95]
ds_read_b128 v[40:43], v23 offset:16384
s_waitcnt lgkmcnt(5)
v_mfma_f32_32x32x16_bf16 a[96:111], v[52:55], v[84:87], a[96:111]
ds_read_b128 v[44:47], v23 offset:20480
s_waitcnt lgkmcnt(5)
v_mfma_f32_32x32x16_bf16 a[0:15], v[56:59], v[88:91], a[0:15]
ds_read_b128 v[48:51], v23 offset:24576
s_waitcnt lgkmcnt(5)
v_mfma_f32_32x32x16_bf16 a[16:31], v[60:63], v[88:91], a[16:31]
ds_read_b128 v[52:55], v24 offset:0
s_waitcnt lgkmcnt(5)
v_mfma_f32_32x32x16_bf16 a[32:47], v[32:35], v[88:91], a[32:47]
ds_read_b128 v[56:59], v24 offset:4096
s_waitcnt lgkmcnt(5)
v_mfma_f32_32x32x16_bf16 a[48:63], v[36:39], v[88:91], a[48:63]
ds_read_b128 v[60:63], v24 offset:8192
s_waitcnt lgkmcnt(5)
v_mfma_f32_32x32x16_bf16 a[64:79], v[40:43], v[88:91], a[64:79]
ds_read_b128 v[32:35], v24 offset:12288
s_waitcnt lgkmcnt(5)
v_mfma_f32_32x32x16_bf16 a[80:95], v[44:47], v[88:91], a[80:95]
ds_read_b128 v[36:39], v24 offset:16384
s_waitcnt lgkmcnt(5)
v_mfma_f32_32x32x16_bf16 a[96:111], v[48:51], v[88:91], a[96:111]
ds_read_b128 v[40:43], v24 offset:20480
s_waitcnt lgkmcnt(5)
v_mfma_f32_32x32x16_bf16 a[0:15], v[52:55], v[92:95], a[0:15]
ds_read_b128 v[44:47], v24 offset:24576
s_waitcnt lgkmcnt(5)
v_mfma_f32_32x32x16_bf16 a[16:31], v[56:59], v[92:95], a[16:31]
s_waitcnt lgkmcnt(4)
v_mfma_f32_32x32x16_bf16 a[32:47], v[60:63], v[92:95], a[32:47]
s_waitcnt lgkmcnt(3)
v_mfma_f32_32x32x16_bf16 a[48:63], v[32:35], v[92:95], a[48:63]
s_waitcnt lgkmcnt(2)
v_mfma_f32_32x32x16_bf16 a[64:79], v[36:39], v[92:95], a[64:79]
s_waitcnt lgkmcnt(1)
v_mfma_f32_32x32x16_bf16 a[80:95], v[40:43], v[92:95], a[80:95]
s_waitcnt lgkmcnt(0)
v_mfma_f32_32x32x16_bf16 a[96:111], v[44:47], v[92:95], a[96:111]
s_barrier
s_mul_i32 s47, s18, 1024
s_add_u32 m0, s47, 0
s_mul_i32 s48, s18, 65536
s_add_u32 s48, s48, s46
s_add_u32 s48, s48, 256
buffer_load_dwordx4 v14, s[20:23], s48 offen lds
s_mul_i32 s47, s18, 1024
s_add_u32 m0, s47, 4096
s_mul_i32 s48, s18, 65536
s_add_u32 s48, s48, s46
s_add_u32 s48, s48, 262400
buffer_load_dwordx4 v14, s[20:23], s48 offen lds
s_mul_i32 s47, s18, 1024
s_add_u32 m0, s47, 8192
s_mul_i32 s48, s18, 65536
s_add_u32 s48, s48, s46
s_add_u32 s48, s48, 524544
buffer_load_dwordx4 v14, s[20:23], s48 offen lds
s_mul_i32 s47, s18, 1024
s_add_u32 m0, s47, 12288
s_mul_i32 s48, s18, 65536
s_add_u32 s48, s48, s46
s_add_u32 s48, s48, 786688
buffer_load_dwordx4 v14, s[20:23], s48 offen lds
s_mul_i32 s47, s18, 1024
s_add_u32 m0, s47, 16384
s_mul_i32 s48, s18, 65536
s_add_u32 s48, s48, s46
s_add_u32 s48, s48, 1048832
buffer_load_dwordx4 v14, s[20:23], s48 offen lds
s_mul_i32 s47, s18, 1024
s_add_u32 m0, s47, 20480
s_mul_i32 s48, s18, 65536
s_add_u32 s48, s48, s46
s_add_u32 s48, s48, 1310976
buffer_load_dwordx4 v14, s[20:23], s48 offen lds
s_mul_i32 s47, s18, 1024
s_add_u32 m0, s47, 24576
s_mul_i32 s48, s18, 65536
s_add_u32 s48, s48, s46
s_add_u32 s48, s48, 1573120
buffer_load_dwordx4 v14, s[20:23], s48 offen lds
s_mul_i32 s47, s18, 1024
s_add_u32 m0, s47, 28672
s_mul_i32 s48, s18, 65536
s_add_u32 s48, s48, s46
s_add_u32 s48, s48, 1835264
buffer_load_dwordx4 v14, s[20:23], s48 offen lds
s_mul_i32 s47, s18, 1024
s_add_u32 m0, s47, 32768
s_mul_i32 s48, s18, 65536
s_add_u32 s48, s48, s46
s_add_u32 s48, s48, 2097408
buffer_load_dwordx4 v14, s[20:23], s48 offen lds
s_mul_i32 s47, s18, 1024
s_add_u32 m0, s47, 36864
s_mul_i32 s48, s18, 65536
s_add_u32 s48, s48, s46
s_add_u32 s48, s48, 2359552
buffer_load_dwordx4 v14, s[20:23], s48 offen lds
s_mul_i32 s47, s18, 1024
s_add_u32 m0, s47, 40960
s_mul_i32 s48, s18, 65536
s_add_u32 s48, s48, s46
s_add_u32 s48, s48, 2621696
buffer_load_dwordx4 v14, s[20:23], s48 offen lds
s_mul_i32 s47, s18, 1024
s_add_u32 m0, s47, 45056
s_mul_i32 s48, s18, 65536
s_add_u32 s48, s48, s46
s_add_u32 s48, s48, 2883840
buffer_load_dwordx4 v14, s[20:23], s48 offen lds
s_mul_i32 s47, s18, 1024
s_add_u32 m0, s47, 49152
s_mul_i32 s48, s18, 65536
s_add_u32 s48, s48, s46
s_add_u32 s48, s48, 3145984
buffer_load_dwordx4 v14, s[20:23], s48 offen lds
s_mul_i32 s47, s18, 1024
s_add_u32 m0, s47, 53248
s_mul_i32 s48, s18, 65536
s_add_u32 s48, s48, s46
s_add_u32 s48, s48, 3408128
buffer_load_dwordx4 v14, s[20:23], s48 offen lds
s_mul_i32 s47, s18, 1024
s_add_u32 m0, s47, 57344
s_lshl_b32 s47, s18, 3
s_add_u32 s47, s47, 128
s_mul_i32 s47, s47, 896
s_add_u32 s48, s47, s50
buffer_load_dwordx4 v3, s[24:27], s48 offen lds
s_mul_i32 s47, s18, 1024
s_add_u32 m0, s47, 61440
s_lshl_b32 s47, s18, 3
s_add_u32 s47, s47, 160
s_mul_i32 s47, s47, 896
s_add_u32 s48, s47, s50
buffer_load_dwordx4 v3, s[24:27], s48 offen lds
s_waitcnt vmcnt(16)
s_barrier
ds_read_b64_tr_b16 v[80:81], v72 offset:0
ds_read_b64_tr_b16 v[82:83], v72 offset:512
ds_read_b64_tr_b16 v[84:85], v72 offset:2048
ds_read_b64_tr_b16 v[86:87], v72 offset:2560
ds_read_b64_tr_b16 v[88:89], v72 offset:4096
ds_read_b64_tr_b16 v[90:91], v72 offset:4608
ds_read_b64_tr_b16 v[92:93], v72 offset:6144
ds_read_b64_tr_b16 v[94:95], v72 offset:6656
s_waitcnt lgkmcnt(0)
ds_read_b128 v[32:35], v64 offset:0
ds_read_b128 v[36:39], v64 offset:4096
ds_read_b128 v[40:43], v64 offset:8192
ds_read_b128 v[44:47], v64 offset:12288
ds_read_b128 v[48:51], v64 offset:16384
ds_read_b128 v[52:55], v64 offset:20480
s_waitcnt lgkmcnt(5)
v_mfma_f32_32x32x16_bf16 a[0:15], v[32:35], v[80:83], a[0:15]
ds_read_b128 v[56:59], v64 offset:24576
s_waitcnt lgkmcnt(5)
v_mfma_f32_32x32x16_bf16 a[16:31], v[36:39], v[80:83], a[16:31]
ds_read_b128 v[60:63], v65 offset:0
s_waitcnt lgkmcnt(5)
v_mfma_f32_32x32x16_bf16 a[32:47], v[40:43], v[80:83], a[32:47]
ds_read_b128 v[32:35], v65 offset:4096
s_waitcnt lgkmcnt(5)
v_mfma_f32_32x32x16_bf16 a[48:63], v[44:47], v[80:83], a[48:63]
ds_read_b128 v[36:39], v65 offset:8192
s_waitcnt lgkmcnt(5)
v_mfma_f32_32x32x16_bf16 a[64:79], v[48:51], v[80:83], a[64:79]
ds_read_b128 v[40:43], v65 offset:12288
s_waitcnt lgkmcnt(5)
v_mfma_f32_32x32x16_bf16 a[80:95], v[52:55], v[80:83], a[80:95]
ds_read_b128 v[44:47], v65 offset:16384
s_waitcnt lgkmcnt(5)
v_mfma_f32_32x32x16_bf16 a[96:111], v[56:59], v[80:83], a[96:111]
ds_read_b128 v[48:51], v65 offset:20480
s_waitcnt lgkmcnt(5)
v_mfma_f32_32x32x16_bf16 a[0:15], v[60:63], v[84:87], a[0:15]
ds_read_b128 v[52:55], v65 offset:24576
s_waitcnt lgkmcnt(5)
v_mfma_f32_32x32x16_bf16 a[16:31], v[32:35], v[84:87], a[16:31]
ds_read_b128 v[56:59], v66 offset:0
s_waitcnt lgkmcnt(5)
v_mfma_f32_32x32x16_bf16 a[32:47], v[36:39], v[84:87], a[32:47]
ds_read_b128 v[60:63], v66 offset:4096
s_waitcnt lgkmcnt(5)
v_mfma_f32_32x32x16_bf16 a[48:63], v[40:43], v[84:87], a[48:63]
ds_read_b128 v[32:35], v66 offset:8192
s_waitcnt lgkmcnt(5)
v_mfma_f32_32x32x16_bf16 a[64:79], v[44:47], v[84:87], a[64:79]
ds_read_b128 v[36:39], v66 offset:12288
s_waitcnt lgkmcnt(5)
v_mfma_f32_32x32x16_bf16 a[80:95], v[48:51], v[84:87], a[80:95]
ds_read_b128 v[40:43], v66 offset:16384
s_waitcnt lgkmcnt(5)
v_mfma_f32_32x32x16_bf16 a[96:111], v[52:55], v[84:87], a[96:111]
ds_read_b128 v[44:47], v66 offset:20480
s_waitcnt lgkmcnt(5)
v_mfma_f32_32x32x16_bf16 a[0:15], v[56:59], v[88:91], a[0:15]
ds_read_b128 v[48:51], v66 offset:24576
s_waitcnt lgkmcnt(5)
v_mfma_f32_32x32x16_bf16 a[16:31], v[60:63], v[88:91], a[16:31]
ds_read_b128 v[52:55], v67 offset:0
s_waitcnt lgkmcnt(5)
v_mfma_f32_32x32x16_bf16 a[32:47], v[32:35], v[88:91], a[32:47]
ds_read_b128 v[56:59], v67 offset:4096
s_waitcnt lgkmcnt(5)
v_mfma_f32_32x32x16_bf16 a[48:63], v[36:39], v[88:91], a[48:63]
ds_read_b128 v[60:63], v67 offset:8192
s_waitcnt lgkmcnt(5)
v_mfma_f32_32x32x16_bf16 a[64:79], v[40:43], v[88:91], a[64:79]
ds_read_b128 v[32:35], v67 offset:12288
s_waitcnt lgkmcnt(5)
v_mfma_f32_32x32x16_bf16 a[80:95], v[44:47], v[88:91], a[80:95]
ds_read_b128 v[36:39], v67 offset:16384
s_waitcnt lgkmcnt(5)
v_mfma_f32_32x32x16_bf16 a[96:111], v[48:51], v[88:91], a[96:111]
ds_read_b128 v[40:43], v67 offset:20480
s_waitcnt lgkmcnt(5)
v_mfma_f32_32x32x16_bf16 a[0:15], v[52:55], v[92:95], a[0:15]
ds_read_b128 v[44:47], v67 offset:24576
s_waitcnt lgkmcnt(5)
v_mfma_f32_32x32x16_bf16 a[16:31], v[56:59], v[92:95], a[16:31]
s_waitcnt lgkmcnt(4)
v_mfma_f32_32x32x16_bf16 a[32:47], v[60:63], v[92:95], a[32:47]
s_waitcnt lgkmcnt(3)
v_mfma_f32_32x32x16_bf16 a[48:63], v[32:35], v[92:95], a[48:63]
s_waitcnt lgkmcnt(2)
v_mfma_f32_32x32x16_bf16 a[64:79], v[36:39], v[92:95], a[64:79]
s_waitcnt lgkmcnt(1)
v_mfma_f32_32x32x16_bf16 a[80:95], v[40:43], v[92:95], a[80:95]
s_waitcnt lgkmcnt(0)
v_mfma_f32_32x32x16_bf16 a[96:111], v[44:47], v[92:95], a[96:111]
s_barrier
s_mul_i32 s47, s18, 1024
s_add_u32 m0, s47, 65536
s_mul_i32 s48, s18, 65536
s_add_u32 s48, s48, s46
s_add_u32 s48, s48, 384
buffer_load_dwordx4 v14, s[20:23], s48 offen lds
s_mul_i32 s47, s18, 1024
s_add_u32 m0, s47, 69632
s_mul_i32 s48, s18, 65536
s_add_u32 s48, s48, s46
s_add_u32 s48, s48, 262528
buffer_load_dwordx4 v14, s[20:23], s48 offen lds
s_mul_i32 s47, s18, 1024
s_add_u32 m0, s47, 73728
s_mul_i32 s48, s18, 65536
s_add_u32 s48, s48, s46
s_add_u32 s48, s48, 524672
buffer_load_dwordx4 v14, s[20:23], s48 offen lds
s_mul_i32 s47, s18, 1024
s_add_u32 m0, s47, 77824
s_mul_i32 s48, s18, 65536
s_add_u32 s48, s48, s46
s_add_u32 s48, s48, 786816
buffer_load_dwordx4 v14, s[20:23], s48 offen lds
s_mul_i32 s47, s18, 1024
s_add_u32 m0, s47, 81920
s_mul_i32 s48, s18, 65536
s_add_u32 s48, s48, s46
s_add_u32 s48, s48, 1048960
buffer_load_dwordx4 v14, s[20:23], s48 offen lds
s_mul_i32 s47, s18, 1024
s_add_u32 m0, s47, 86016
s_mul_i32 s48, s18, 65536
s_add_u32 s48, s48, s46
s_add_u32 s48, s48, 1311104
buffer_load_dwordx4 v14, s[20:23], s48 offen lds
s_mul_i32 s47, s18, 1024
s_add_u32 m0, s47, 90112
s_mul_i32 s48, s18, 65536
s_add_u32 s48, s48, s46
s_add_u32 s48, s48, 1573248
buffer_load_dwordx4 v14, s[20:23], s48 offen lds
s_mul_i32 s47, s18, 1024
s_add_u32 m0, s47, 94208
s_mul_i32 s48, s18, 65536
s_add_u32 s48, s48, s46
s_add_u32 s48, s48, 1835392
buffer_load_dwordx4 v14, s[20:23], s48 offen lds
s_mul_i32 s47, s18, 1024
s_add_u32 m0, s47, 98304
s_mul_i32 s48, s18, 65536
s_add_u32 s48, s48, s46
s_add_u32 s48, s48, 2097536
buffer_load_dwordx4 v14, s[20:23], s48 offen lds
s_mul_i32 s47, s18, 1024
s_add_u32 m0, s47, 102400
s_mul_i32 s48, s18, 65536
s_add_u32 s48, s48, s46
s_add_u32 s48, s48, 2359680
buffer_load_dwordx4 v14, s[20:23], s48 offen lds
s_mul_i32 s47, s18, 1024
s_add_u32 m0, s47, 106496
s_mul_i32 s48, s18, 65536
s_add_u32 s48, s48, s46
s_add_u32 s48, s48, 2621824
buffer_load_dwordx4 v14, s[20:23], s48 offen lds
s_mul_i32 s47, s18, 1024
s_add_u32 m0, s47, 110592
s_mul_i32 s48, s18, 65536
s_add_u32 s48, s48, s46
s_add_u32 s48, s48, 2883968
buffer_load_dwordx4 v14, s[20:23], s48 offen lds
s_mul_i32 s47, s18, 1024
s_add_u32 m0, s47, 114688
s_mul_i32 s48, s18, 65536
s_add_u32 s48, s48, s46
s_add_u32 s48, s48, 3146112
buffer_load_dwordx4 v14, s[20:23], s48 offen lds
s_mul_i32 s47, s18, 1024
s_add_u32 m0, s47, 118784
s_mul_i32 s48, s18, 65536
s_add_u32 s48, s48, s46
s_add_u32 s48, s48, 3408256
buffer_load_dwordx4 v14, s[20:23], s48 offen lds
s_mul_i32 s47, s18, 1024
s_add_u32 m0, s47, 122880
s_lshl_b32 s47, s18, 3
s_add_u32 s47, s47, 192
s_mul_i32 s47, s47, 896
s_add_u32 s48, s47, s50
buffer_load_dwordx4 v3, s[24:27], s48 offen lds
s_mul_i32 s47, s18, 1024
s_add_u32 m0, s47, 126976
s_lshl_b32 s47, s18, 3
s_add_u32 s47, s47, 224
s_mul_i32 s47, s47, 896
s_add_u32 s48, s47, s50
buffer_load_dwordx4 v3, s[24:27], s48 offen lds
s_waitcnt vmcnt(16)
s_barrier
ds_read_b64_tr_b16 v[80:81], v68 offset:0
ds_read_b64_tr_b16 v[82:83], v68 offset:512
ds_read_b64_tr_b16 v[84:85], v68 offset:2048
ds_read_b64_tr_b16 v[86:87], v68 offset:2560
ds_read_b64_tr_b16 v[88:89], v68 offset:4096
ds_read_b64_tr_b16 v[90:91], v68 offset:4608
ds_read_b64_tr_b16 v[92:93], v68 offset:6144
ds_read_b64_tr_b16 v[94:95], v68 offset:6656
s_waitcnt lgkmcnt(0)
ds_read_b128 v[32:35], v21 offset:0
ds_read_b128 v[36:39], v21 offset:4096
ds_read_b128 v[40:43], v21 offset:8192
ds_read_b128 v[44:47], v21 offset:12288
ds_read_b128 v[48:51], v21 offset:16384
ds_read_b128 v[52:55], v21 offset:20480
s_waitcnt lgkmcnt(5)
v_mfma_f32_32x32x16_bf16 a[0:15], v[32:35], v[80:83], a[0:15]
ds_read_b128 v[56:59], v21 offset:24576
s_waitcnt lgkmcnt(5)
v_mfma_f32_32x32x16_bf16 a[16:31], v[36:39], v[80:83], a[16:31]
ds_read_b128 v[60:63], v22 offset:0
s_waitcnt lgkmcnt(5)
v_mfma_f32_32x32x16_bf16 a[32:47], v[40:43], v[80:83], a[32:47]
ds_read_b128 v[32:35], v22 offset:4096
s_waitcnt lgkmcnt(5)
v_mfma_f32_32x32x16_bf16 a[48:63], v[44:47], v[80:83], a[48:63]
ds_read_b128 v[36:39], v22 offset:8192
s_waitcnt lgkmcnt(5)
v_mfma_f32_32x32x16_bf16 a[64:79], v[48:51], v[80:83], a[64:79]
ds_read_b128 v[40:43], v22 offset:12288
s_waitcnt lgkmcnt(5)
v_mfma_f32_32x32x16_bf16 a[80:95], v[52:55], v[80:83], a[80:95]
ds_read_b128 v[44:47], v22 offset:16384
s_waitcnt lgkmcnt(5)
v_mfma_f32_32x32x16_bf16 a[96:111], v[56:59], v[80:83], a[96:111]
ds_read_b128 v[48:51], v22 offset:20480
s_waitcnt lgkmcnt(5)
v_mfma_f32_32x32x16_bf16 a[0:15], v[60:63], v[84:87], a[0:15]
ds_read_b128 v[52:55], v22 offset:24576
s_waitcnt lgkmcnt(5)
v_mfma_f32_32x32x16_bf16 a[16:31], v[32:35], v[84:87], a[16:31]
ds_read_b128 v[56:59], v23 offset:0
s_waitcnt lgkmcnt(5)
v_mfma_f32_32x32x16_bf16 a[32:47], v[36:39], v[84:87], a[32:47]
ds_read_b128 v[60:63], v23 offset:4096
s_waitcnt lgkmcnt(5)
v_mfma_f32_32x32x16_bf16 a[48:63], v[40:43], v[84:87], a[48:63]
ds_read_b128 v[32:35], v23 offset:8192
s_waitcnt lgkmcnt(5)
v_mfma_f32_32x32x16_bf16 a[64:79], v[44:47], v[84:87], a[64:79]
ds_read_b128 v[36:39], v23 offset:12288
s_waitcnt lgkmcnt(5)
v_mfma_f32_32x32x16_bf16 a[80:95], v[48:51], v[84:87], a[80:95]
ds_read_b128 v[40:43], v23 offset:16384
s_waitcnt lgkmcnt(5)
v_mfma_f32_32x32x16_bf16 a[96:111], v[52:55], v[84:87], a[96:111]
ds_read_b128 v[44:47], v23 offset:20480
s_waitcnt lgkmcnt(5)
v_mfma_f32_32x32x16_bf16 a[0:15], v[56:59], v[88:91], a[0:15]
ds_read_b128 v[48:51], v23 offset:24576
s_waitcnt lgkmcnt(5)
v_mfma_f32_32x32x16_bf16 a[16:31], v[60:63], v[88:91], a[16:31]
ds_read_b128 v[52:55], v24 offset:0
s_waitcnt lgkmcnt(5)
v_mfma_f32_32x32x16_bf16 a[32:47], v[32:35], v[88:91], a[32:47]
ds_read_b128 v[56:59], v24 offset:4096
s_waitcnt lgkmcnt(5)
v_mfma_f32_32x32x16_bf16 a[48:63], v[36:39], v[88:91], a[48:63]
ds_read_b128 v[60:63], v24 offset:8192
s_waitcnt lgkmcnt(5)
v_mfma_f32_32x32x16_bf16 a[64:79], v[40:43], v[88:91], a[64:79]
ds_read_b128 v[32:35], v24 offset:12288
s_waitcnt lgkmcnt(5)
v_mfma_f32_32x32x16_bf16 a[80:95], v[44:47], v[88:91], a[80:95]
ds_read_b128 v[36:39], v24 offset:16384
s_waitcnt lgkmcnt(5)
v_mfma_f32_32x32x16_bf16 a[96:111], v[48:51], v[88:91], a[96:111]
ds_read_b128 v[40:43], v24 offset:20480
s_waitcnt lgkmcnt(5)
v_mfma_f32_32x32x16_bf16 a[0:15], v[52:55], v[92:95], a[0:15]
ds_read_b128 v[44:47], v24 offset:24576
s_waitcnt lgkmcnt(5)
v_mfma_f32_32x32x16_bf16 a[16:31], v[56:59], v[92:95], a[16:31]
s_waitcnt lgkmcnt(4)
v_mfma_f32_32x32x16_bf16 a[32:47], v[60:63], v[92:95], a[32:47]
s_waitcnt lgkmcnt(3)
v_mfma_f32_32x32x16_bf16 a[48:63], v[32:35], v[92:95], a[48:63]
s_waitcnt lgkmcnt(2)
v_mfma_f32_32x32x16_bf16 a[64:79], v[36:39], v[92:95], a[64:79]
s_waitcnt lgkmcnt(1)
v_mfma_f32_32x32x16_bf16 a[80:95], v[40:43], v[92:95], a[80:95]
s_waitcnt lgkmcnt(0)
v_mfma_f32_32x32x16_bf16 a[96:111], v[44:47], v[92:95], a[96:111]
s_barrier
s_waitcnt vmcnt(0)
s_barrier
ds_read_b64_tr_b16 v[80:81], v72 offset:0
ds_read_b64_tr_b16 v[82:83], v72 offset:512
ds_read_b64_tr_b16 v[84:85], v72 offset:2048
ds_read_b64_tr_b16 v[86:87], v72 offset:2560
ds_read_b64_tr_b16 v[88:89], v72 offset:4096
ds_read_b64_tr_b16 v[90:91], v72 offset:4608
ds_read_b64_tr_b16 v[92:93], v72 offset:6144
ds_read_b64_tr_b16 v[94:95], v72 offset:6656
s_waitcnt lgkmcnt(0)
ds_read_b128 v[32:35], v64 offset:0
ds_read_b128 v[36:39], v64 offset:4096
ds_read_b128 v[40:43], v64 offset:8192
ds_read_b128 v[44:47], v64 offset:12288
ds_read_b128 v[48:51], v64 offset:16384
ds_read_b128 v[52:55], v64 offset:20480
s_waitcnt lgkmcnt(5)
v_mfma_f32_32x32x16_bf16 a[0:15], v[32:35], v[80:83], a[0:15]
ds_read_b128 v[56:59], v64 offset:24576
s_waitcnt lgkmcnt(5)
v_mfma_f32_32x32x16_bf16 a[16:31], v[36:39], v[80:83], a[16:31]
ds_read_b128 v[60:63], v65 offset:0
s_waitcnt lgkmcnt(5)
v_mfma_f32_32x32x16_bf16 a[32:47], v[40:43], v[80:83], a[32:47]
ds_read_b128 v[32:35], v65 offset:4096
s_waitcnt lgkmcnt(5)
v_mfma_f32_32x32x16_bf16 a[48:63], v[44:47], v[80:83], a[48:63]
ds_read_b128 v[36:39], v65 offset:8192
s_waitcnt lgkmcnt(5)
v_mfma_f32_32x32x16_bf16 a[64:79], v[48:51], v[80:83], a[64:79]
ds_read_b128 v[40:43], v65 offset:12288
s_waitcnt lgkmcnt(5)
v_mfma_f32_32x32x16_bf16 a[80:95], v[52:55], v[80:83], a[80:95]
ds_read_b128 v[44:47], v65 offset:16384
s_waitcnt lgkmcnt(5)
v_mfma_f32_32x32x16_bf16 a[96:111], v[56:59], v[80:83], a[96:111]
ds_read_b128 v[48:51], v65 offset:20480
s_waitcnt lgkmcnt(5)
v_mfma_f32_32x32x16_bf16 a[0:15], v[60:63], v[84:87], a[0:15]
ds_read_b128 v[52:55], v65 offset:24576
s_waitcnt lgkmcnt(5)
v_mfma_f32_32x32x16_bf16 a[16:31], v[32:35], v[84:87], a[16:31]
ds_read_b128 v[56:59], v66 offset:0
s_waitcnt lgkmcnt(5)
v_mfma_f32_32x32x16_bf16 a[32:47], v[36:39], v[84:87], a[32:47]
ds_read_b128 v[60:63], v66 offset:4096
s_waitcnt lgkmcnt(5)
v_mfma_f32_32x32x16_bf16 a[48:63], v[40:43], v[84:87], a[48:63]
ds_read_b128 v[32:35], v66 offset:8192
s_waitcnt lgkmcnt(5)
v_mfma_f32_32x32x16_bf16 a[64:79], v[44:47], v[84:87], a[64:79]
ds_read_b128 v[36:39], v66 offset:12288
s_waitcnt lgkmcnt(5)
v_mfma_f32_32x32x16_bf16 a[80:95], v[48:51], v[84:87], a[80:95]
ds_read_b128 v[40:43], v66 offset:16384
s_waitcnt lgkmcnt(5)
v_mfma_f32_32x32x16_bf16 a[96:111], v[52:55], v[84:87], a[96:111]
ds_read_b128 v[44:47], v66 offset:20480
s_waitcnt lgkmcnt(5)
v_mfma_f32_32x32x16_bf16 a[0:15], v[56:59], v[88:91], a[0:15]
ds_read_b128 v[48:51], v66 offset:24576
s_waitcnt lgkmcnt(5)
v_mfma_f32_32x32x16_bf16 a[16:31], v[60:63], v[88:91], a[16:31]
ds_read_b128 v[52:55], v67 offset:0
s_waitcnt lgkmcnt(5)
v_mfma_f32_32x32x16_bf16 a[32:47], v[32:35], v[88:91], a[32:47]
ds_read_b128 v[56:59], v67 offset:4096
s_waitcnt lgkmcnt(5)
v_mfma_f32_32x32x16_bf16 a[48:63], v[36:39], v[88:91], a[48:63]
ds_read_b128 v[60:63], v67 offset:8192
s_waitcnt lgkmcnt(5)
v_mfma_f32_32x32x16_bf16 a[64:79], v[40:43], v[88:91], a[64:79]
ds_read_b128 v[32:35], v67 offset:12288
s_waitcnt lgkmcnt(5)
v_mfma_f32_32x32x16_bf16 a[80:95], v[44:47], v[88:91], a[80:95]
ds_read_b128 v[36:39], v67 offset:16384
s_waitcnt lgkmcnt(5)
v_mfma_f32_32x32x16_bf16 a[96:111], v[48:51], v[88:91], a[96:111]
ds_read_b128 v[40:43], v67 offset:20480
s_waitcnt lgkmcnt(5)
v_mfma_f32_32x32x16_bf16 a[0:15], v[52:55], v[92:95], a[0:15]
ds_read_b128 v[44:47], v67 offset:24576
s_waitcnt lgkmcnt(5)
v_mfma_f32_32x32x16_bf16 a[16:31], v[56:59], v[92:95], a[16:31]
s_waitcnt lgkmcnt(4)
v_mfma_f32_32x32x16_bf16 a[32:47], v[60:63], v[92:95], a[32:47]
s_waitcnt lgkmcnt(3)
v_mfma_f32_32x32x16_bf16 a[48:63], v[32:35], v[92:95], a[48:63]
s_waitcnt lgkmcnt(2)
v_mfma_f32_32x32x16_bf16 a[64:79], v[36:39], v[92:95], a[64:79]
s_waitcnt lgkmcnt(1)
v_mfma_f32_32x32x16_bf16 a[80:95], v[40:43], v[92:95], a[80:95]
s_waitcnt lgkmcnt(0)
v_mfma_f32_32x32x16_bf16 a[96:111], v[44:47], v[92:95], a[96:111]
s_barrier
v_cmp_gt_u32 vcc, 28, v17
s_nop 0
s_and_saveexec_b64 s[40:41], vcc
v_accvgpr_read_b32 v40, a0
v_accvgpr_read_b32 v41, a1
v_accvgpr_read_b32 v42, a2
v_accvgpr_read_b32 v43, a3
v_accvgpr_read_b32 v44, a4
v_accvgpr_read_b32 v45, a5
v_accvgpr_read_b32 v46, a6
v_accvgpr_read_b32 v47, a7
v_cvt_pk_bf16_f32 v32, v40, v41
v_cvt_pk_bf16_f32 v33, v42, v43
v_cvt_pk_bf16_f32 v34, v44, v45
v_cvt_pk_bf16_f32 v35, v46, v47
s_mov_b32 s33, 0
buffer_store_dwordx4 v[32:35], v15, s[4:7], s33 offen
v_accvgpr_read_b32 v40, a8
v_accvgpr_read_b32 v41, a9
v_accvgpr_read_b32 v42, a10
v_accvgpr_read_b32 v43, a11
v_accvgpr_read_b32 v44, a12
v_accvgpr_read_b32 v45, a13
v_accvgpr_read_b32 v46, a14
v_accvgpr_read_b32 v47, a15
v_cvt_pk_bf16_f32 v36, v40, v41
v_cvt_pk_bf16_f32 v37, v42, v43
v_cvt_pk_bf16_f32 v38, v44, v45
v_cvt_pk_bf16_f32 v39, v46, v47
s_mov_b32 s33, 512
buffer_store_dwordx4 v[36:39], v15, s[4:7], s33 offen
v_accvgpr_read_b32 v40, a16
v_accvgpr_read_b32 v41, a17
v_accvgpr_read_b32 v42, a18
v_accvgpr_read_b32 v43, a19
v_accvgpr_read_b32 v44, a20
v_accvgpr_read_b32 v45, a21
v_accvgpr_read_b32 v46, a22
v_accvgpr_read_b32 v47, a23
v_cvt_pk_bf16_f32 v32, v40, v41
v_cvt_pk_bf16_f32 v33, v42, v43
v_cvt_pk_bf16_f32 v34, v44, v45
v_cvt_pk_bf16_f32 v35, v46, v47
s_mov_b32 s33, 1024
buffer_store_dwordx4 v[32:35], v15, s[4:7], s33 offen
v_accvgpr_read_b32 v40, a24
v_accvgpr_read_b32 v41, a25
v_accvgpr_read_b32 v42, a26
v_accvgpr_read_b32 v43, a27
v_accvgpr_read_b32 v44, a28
v_accvgpr_read_b32 v45, a29
v_accvgpr_read_b32 v46, a30
v_accvgpr_read_b32 v47, a31
v_cvt_pk_bf16_f32 v36, v40, v41
v_cvt_pk_bf16_f32 v37, v42, v43
v_cvt_pk_bf16_f32 v38, v44, v45
v_cvt_pk_bf16_f32 v39, v46, v47
s_mov_b32 s33, 1536
buffer_store_dwordx4 v[36:39], v15, s[4:7], s33 offen
v_accvgpr_read_b32 v40, a32
v_accvgpr_read_b32 v41, a33
v_accvgpr_read_b32 v42, a34
v_accvgpr_read_b32 v43, a35
v_accvgpr_read_b32 v44, a36
v_accvgpr_read_b32 v45, a37
v_accvgpr_read_b32 v46, a38
v_accvgpr_read_b32 v47, a39
v_cvt_pk_bf16_f32 v32, v40, v41
v_cvt_pk_bf16_f32 v33, v42, v43
v_cvt_pk_bf16_f32 v34, v44, v45
v_cvt_pk_bf16_f32 v35, v46, v47
s_mov_b32 s33, 2048
buffer_store_dwordx4 v[32:35], v15, s[4:7], s33 offen
v_accvgpr_read_b32 v40, a40
v_accvgpr_read_b32 v41, a41
v_accvgpr_read_b32 v42, a42
v_accvgpr_read_b32 v43, a43
v_accvgpr_read_b32 v44, a44
v_accvgpr_read_b32 v45, a45
v_accvgpr_read_b32 v46, a46
v_accvgpr_read_b32 v47, a47
v_cvt_pk_bf16_f32 v36, v40, v41
v_cvt_pk_bf16_f32 v37, v42, v43
v_cvt_pk_bf16_f32 v38, v44, v45
v_cvt_pk_bf16_f32 v39, v46, v47
s_mov_b32 s33, 2560
buffer_store_dwordx4 v[36:39], v15, s[4:7], s33 offen
v_accvgpr_read_b32 v40, a48
v_accvgpr_read_b32 v41, a49
v_accvgpr_read_b32 v42, a50
v_accvgpr_read_b32 v43, a51
v_accvgpr_read_b32 v44, a52
v_accvgpr_read_b32 v45, a53
v_accvgpr_read_b32 v46, a54
v_accvgpr_read_b32 v47, a55
v_cvt_pk_bf16_f32 v32, v40, v41
v_cvt_pk_bf16_f32 v33, v42, v43
v_cvt_pk_bf16_f32 v34, v44, v45
v_cvt_pk_bf16_f32 v35, v46, v47
s_mov_b32 s33, 3072
buffer_store_dwordx4 v[32:35], v15, s[4:7], s33 offen
v_accvgpr_read_b32 v40, a56
v_accvgpr_read_b32 v41, a57
v_accvgpr_read_b32 v42, a58
v_accvgpr_read_b32 v43, a59
v_accvgpr_read_b32 v44, a60
v_accvgpr_read_b32 v45, a61
v_accvgpr_read_b32 v46, a62
v_accvgpr_read_b32 v47, a63
v_cvt_pk_bf16_f32 v36, v40, v41
v_cvt_pk_bf16_f32 v37, v42, v43
v_cvt_pk_bf16_f32 v38, v44, v45
v_cvt_pk_bf16_f32 v39, v46, v47
s_mov_b32 s33, 3584
buffer_store_dwordx4 v[36:39], v15, s[4:7], s33 offen
v_accvgpr_read_b32 v40, a64
v_accvgpr_read_b32 v41, a65
v_accvgpr_read_b32 v42, a66
v_accvgpr_read_b32 v43, a67
v_accvgpr_read_b32 v44, a68
v_accvgpr_read_b32 v45, a69
v_accvgpr_read_b32 v46, a70
v_accvgpr_read_b32 v47, a71
v_cvt_pk_bf16_f32 v32, v40, v41
v_cvt_pk_bf16_f32 v33, v42, v43
v_cvt_pk_bf16_f32 v34, v44, v45
v_cvt_pk_bf16_f32 v35, v46, v47
s_mov_b32 s33, 4096
buffer_store_dwordx4 v[32:35], v15, s[4:7], s33 offen
v_accvgpr_read_b32 v40, a72
v_accvgpr_read_b32 v41, a73
v_accvgpr_read_b32 v42, a74
v_accvgpr_read_b32 v43, a75
v_accvgpr_read_b32 v44, a76
v_accvgpr_read_b32 v45, a77
v_accvgpr_read_b32 v46, a78
v_accvgpr_read_b32 v47, a79
v_cvt_pk_bf16_f32 v36, v40, v41
v_cvt_pk_bf16_f32 v37, v42, v43
v_cvt_pk_bf16_f32 v38, v44, v45
v_cvt_pk_bf16_f32 v39, v46, v47
s_mov_b32 s33, 4608
buffer_store_dwordx4 v[36:39], v15, s[4:7], s33 offen
v_accvgpr_read_b32 v40, a80
v_accvgpr_read_b32 v41, a81
v_accvgpr_read_b32 v42, a82
v_accvgpr_read_b32 v43, a83
v_accvgpr_read_b32 v44, a84
v_accvgpr_read_b32 v45, a85
v_accvgpr_read_b32 v46, a86
v_accvgpr_read_b32 v47, a87
v_cvt_pk_bf16_f32 v32, v40, v41
v_cvt_pk_bf16_f32 v33, v42, v43
v_cvt_pk_bf16_f32 v34, v44, v45
v_cvt_pk_bf16_f32 v35, v46, v47
s_mov_b32 s33, 5120
buffer_store_dwordx4 v[32:35], v15, s[4:7], s33 offen
v_accvgpr_read_b32 v40, a88
v_accvgpr_read_b32 v41, a89
v_accvgpr_read_b32 v42, a90
v_accvgpr_read_b32 v43, a91
v_accvgpr_read_b32 v44, a92
v_accvgpr_read_b32 v45, a93
v_accvgpr_read_b32 v46, a94
v_accvgpr_read_b32 v47, a95
v_cvt_pk_bf16_f32 v36, v40, v41
v_cvt_pk_bf16_f32 v37, v42, v43
v_cvt_pk_bf16_f32 v38, v44, v45
v_cvt_pk_bf16_f32 v39, v46, v47
s_mov_b32 s33, 5632
buffer_store_dwordx4 v[36:39], v15, s[4:7], s33 offen
v_accvgpr_read_b32 v40, a96
v_accvgpr_read_b32 v41, a97
v_accvgpr_read_b32 v42, a98
v_accvgpr_read_b32 v43, a99
v_accvgpr_read_b32 v44, a100
v_accvgpr_read_b32 v45, a101
v_accvgpr_read_b32 v46, a102
v_accvgpr_read_b32 v47, a103
v_cvt_pk_bf16_f32 v32, v40, v41
v_cvt_pk_bf16_f32 v33, v42, v43
v_cvt_pk_bf16_f32 v34, v44, v45
v_cvt_pk_bf16_f32 v35, v46, v47
s_mov_b32 s33, 6144
buffer_store_dwordx4 v[32:35], v15, s[4:7], s33 offen
v_accvgpr_read_b32 v40, a104
v_accvgpr_read_b32 v41, a105
v_accvgpr_read_b32 v42, a106
v_accvgpr_read_b32 v43, a107
v_accvgpr_read_b32 v44, a108
v_accvgpr_read_b32 v45, a109
v_accvgpr_read_b32 v46, a110
v_accvgpr_read_b32 v47, a111
v_cvt_pk_bf16_f32 v36, v40, v41
v_cvt_pk_bf16_f32 v37, v42, v43
v_cvt_pk_bf16_f32 v38, v44, v45
v_cvt_pk_bf16_f32 v39, v46, v47
s_mov_b32 s33, 6656
buffer_store_dwordx4 v[36:39], v15, s[4:7], s33 offen
s_mov_b64 exec, s[40:41]
s_branch PREP_TAIL
PREP_MISC:
s_sub_u32 s35, s77, 30
s_lshl_b32 s35, s35, 3
s_add_u32 s35, s35, s76
s_mov_b32 s20, s52
s_and_b32 s21, s53, 0xffff
s_mov_b32 s22, 1835008
s_mov_b32 s23, 0x20000
s_mov_b32 s24, s54
s_and_b32 s25, s55, 0xffff
s_mov_b32 s26, 7168
s_mov_b32 s27, 0x20000
v_and_b32 v23, 31, v0
v_lshrrev_b32 v24, 5, v0
v_mul_u32_u24 v25, 896, v23
v_lshl_add_u32 v25, v24, 4, v25
v_lshlrev_b32 v26, 9, v24
v_lshl_add_u32 v26, v23, 4, v26
v_lshlrev_b32 v27, 3, v23
s_lshl_b32 s33, s18, 8
v_add_u32 v28, s33, v27
s_lshl_b32 s30, s35, 2
s_add_u32 s33, s30, 0
s_mul_i32 s33, s33, 28672
buffer_load_dwordx4 v[32:35], v25, s[20:23], s33 offen offset:0
buffer_load_dwordx4 v[36:39], v25, s[20:23], s33 offen offset:128
buffer_load_dwordx4 v[40:43], v25, s[20:23], s33 offen offset:256
buffer_load_dwordx4 v[44:47], v25, s[20:23], s33 offen offset:384
buffer_load_dwordx4 v[48:51], v25, s[20:23], s33 offen offset:512
buffer_load_dwordx4 v[52:55], v25, s[20:23], s33 offen offset:640
buffer_load_dwordx4 v[56:59], v25, s[20:23], s33 offen offset:768
s_add_u32 s33, s30, 1
s_mul_i32 s33, s33, 28672
buffer_load_dwordx4 v[60:63], v25, s[20:23], s33 offen offset:0
buffer_load_dwordx4 v[64:67], v25, s[20:23], s33 offen offset:128
buffer_load_dwordx4 v[68:71], v25, s[20:23], s33 offen offset:256
buffer_load_dwordx4 v[72:75], v25, s[20:23], s33 offen offset:384
buffer_load_dwordx4 v[76:79], v25, s[20:23], s33 offen offset:512
buffer_load_dwordx4 v[80:83], v25, s[20:23], s33 offen offset:640
buffer_load_dwordx4 v[84:87], v25, s[20:23], s33 offen offset:768
s_add_u32 s33, s30, 2
s_mul_i32 s33, s33, 28672
buffer_load_dwordx4 v[88:91], v25, s[20:23], s33 offen offset:0
buffer_load_dwordx4 v[92:95], v25, s[20:23], s33 offen offset:128
buffer_load_dwordx4 v[96:99], v25, s[20:23], s33 offen offset:256
buffer_load_dwordx4 v[100:103], v25, s[20:23], s33 offen offset:384
buffer_load_dwordx4 v[104:107], v25, s[20:23], s33 offen offset:512
buffer_load_dwordx4 v[108:111], v25, s[20:23], s33 offen offset:640
buffer_load_dwordx4 v[112:115], v25, s[20:23], s33 offen offset:768
s_add_u32 s33, s30, 3
s_mul_i32 s33, s33, 28672
buffer_load_dwordx4 v[116:119], v25, s[20:23], s33 offen offset:0
buffer_load_dwordx4 v[120:123], v25, s[20:23], s33 offen offset:128
buffer_load_dwordx4 v[124:127], v25, s[20:23], s33 offen offset:256
buffer_load_dwordx4 v[128:131], v25, s[20:23], s33 offen offset:384
buffer_load_dwordx4 v[132:135], v25, s[20:23], s33 offen offset:512
buffer_load_dwordx4 v[136:139], v25, s[20:23], s33 offen offset:640
buffer_load_dwordx4 v[140:143], v25, s[20:23], s33 offen offset:768
s_mov_b32 s44, s2
FL_51:
s_cmp_ge_u32 s44, 112
s_cbranch_scc1 FE_52
s_lshl_b32 s45, s44, 12
s_add_u32 s45, s45, 33045504
buffer_store_dwordx4 v[4:7], v2, s[4:7], s45 offen
s_add_u32 s44, s44, 256
s_branch FL_51
FE_52:
s_mov_b32 s44, s2
FL_53:
s_cmp_ge_u32 s44, 160
s_cbranch_scc1 FE_54
s_lshl_b32 s45, s44, 12
s_add_u32 s45, s45, 33972224
buffer_store_dwordx4 v[4:7], v2, s[4:7], s45 offen
s_add_u32 s44, s44, 256
s_branch FL_53
FE_54:
s_mov_b32 s44, s2
FL_55:
s_cmp_ge_u32 s44, 640
s_cbranch_scc1 FE_56
s_lshl_b32 s45, s44, 12
s_add_u32 s45, s45, 35282944
buffer_store_dwordx4 v[4:7], v2, s[4:7], s45 offen
s_add_u32 s44, s44, 256
s_branch FL_55
FE_56:
s_mov_b32 s44, s2
FL_57:
s_cmp_ge_u32 s44, 112
s_cbranch_scc1 FE_58
s_lshl_b32 s45, s44, 12
s_add_u32 s45, s45, 33512448
buffer_store_dwordx4 v[4:7], v2, s[4:7], s45 offen
s_add_u32 s44, s44, 256
s_branch FL_57
FE_58:
s_mov_b32 s44, s2
FL_59:
s_cmp_ge_u32 s44, 160
s_cbranch_scc1 FE_60
s_lshl_b32 s45, s44, 12
s_add_u32 s45, s45, 34627584
buffer_store_dwordx4 v[4:7], v2, s[4:7], s45 offen
s_add_u32 s44, s44, 256
s_branch FL_59
FE_60:
s_mov_b32 s44, s2
FL_61:
s_cmp_ge_u32 s44, 640
s_cbranch_scc1 FE_62
s_lshl_b32 s45, s44, 12
s_add_u32 s45, s45, 37904384
buffer_store_dwordx4 v[4:7], v2, s[4:7], s45 offen
s_add_u32 s44, s44, 256
s_branch FL_61
FE_62:
s_mov_b32 s44, s2
FL_63:
s_cmp_ge_u32 s44, 448
s_cbranch_scc1 FE_64
s_lshl_b32 s45, s44, 12
s_add_u32 s45, s45, 23863296
buffer_store_dwordx4 v[4:7], v2, s[4:7], s45 offen
s_add_u32 s44, s44, 256
s_branch FL_63
FE_64:
s_mov_b32 s44, s2
FL_65:
s_cmp_ge_u32 s44, 448
s_cbranch_scc1 FE_66
s_lshl_b32 s45, s44, 12
s_add_u32 s45, s45, 25698304
buffer_store_dwordx4 v[4:7], v2, s[4:7], s45 offen
s_add_u32 s44, s44, 256
s_branch FL_65
FE_66:
s_mov_b32 s44, s2
FL_67:
s_cmp_ge_u32 s44, 448
s_cbranch_scc1 FE_68
s_lshl_b32 s45, s44, 12
s_add_u32 s45, s45, 27533312
buffer_store_dwordx4 v[4:7], v2, s[4:7], s45 offen
s_add_u32 s44, s44, 256
s_branch FL_67
FE_68:
s_mov_b32 s44, s2
FL_69:
s_cmp_ge_u32 s44, 448
s_cbranch_scc1 FE_70
s_lshl_b32 s45, s44, 12
s_add_u32 s45, s45, 29368320
buffer_store_dwordx4 v[4:7], v2, s[4:7], s45 offen
s_add_u32 s44, s44, 256
s_branch FL_69
FE_70:
s_mov_b32 s44, s2
FL_71:
s_cmp_ge_u32 s44, 448
s_cbranch_scc1 FE_72
s_lshl_b32 s45, s44, 12
s_add_u32 s45, s45, 31203328
buffer_store_dwordx4 v[4:7], v2, s[4:7], s45 offen
s_add_u32 s44, s44, 256
s_branch FL_71
FE_72:
s_mov_b32 s44, s2
FL_73:
s_cmp_ge_u32 s44, 8
s_cbranch_scc1 FE_74
s_lshl_b32 s45, s44, 12
s_add_u32 s45, s45, 158031872
buffer_store_dwordx4 v[4:7], v2, s[4:7], s45 offen
s_add_u32 s44, s44, 256
s_branch FL_73
FE_74:
s_cmp_lg_u32 s35, 0
s_cbranch_scc1 PREP_LN
s_mov_b32 s31, 0
PREP_M:
v_add_u32 v3, s31, v0
v_and_b32 v12, 7, v3
v_lshrrev_b32 v13, 3, v3
v_lshrrev_b32 v14, 1, v13
v_lshlrev_b32 v14, 5, v14
v_and_b32 v15, 1, v13
v_lshl_add_u32 v14, v15, 2, v14
v_mul_u32_u24 v15, 896, v12
v_add_u32 v14, v14, v15
buffer_load_dword v20, v14, s[24:27], 0 offen
buffer_load_dword v21, v14, s[24:27], 0 offen offset:8
buffer_load_dword v22, v14, s[24:27], 0 offen offset:16
buffer_load_dword v29, v14, s[24:27], 0 offen offset:24
v_lshlrev_b32 v15, 4, v3
v_cmp_gt_u32 vcc, 448, v3
s_waitcnt vmcnt(0)
v_mov_b32 v144, v20
v_mov_b32 v145, v21
v_mov_b32 v146, v22
v_mov_b32 v147, v29
s_and_saveexec_b64 s[40:41], vcc
s_cbranch_execz PREP_M2
s_mov_b32 s33, 33038336
buffer_store_dwordx4 v[144:147], v15, s[4:7], s33 offen
s_mov_b32 s33, 33505280
buffer_store_dwordx4 v[144:147], v15, s[4:7], s33 offen
PREP_M2:
s_mov_b64 exec, s[40:41]
s_waitcnt vmcnt(0)
s_add_u32 s31, s31, 256
s_cmp_lt_u32 s31, 512
s_cbranch_scc1 PREP_M
PREP_LN:
s_waitcnt vmcnt(0)
s_add_u32 s33, s30, 0
s_mul_i32 s36, s33, 28672
s_add_u32 s37, s36, 22028288
s_add_u32 s38, s36, 14688256
s_add_u32 s33, s37, 0
buffer_store_dwordx4 v[32:35], v26, s[4:7], s33 offen
s_add_u32 s33, s37, 4096
buffer_store_dwordx4 v[36:39], v26, s[4:7], s33 offen
s_add_u32 s33, s37, 8192
buffer_store_dwordx4 v[40:43], v26, s[4:7], s33 offen
s_add_u32 s33, s37, 12288
buffer_store_dwordx4 v[44:47], v26, s[4:7], s33 offen
s_add_u32 s33, s37, 16384
buffer_store_dwordx4 v[48:51], v26, s[4:7], s33 offen
s_add_u32 s33, s37, 20480
buffer_store_dwordx4 v[52:55], v26, s[4:7], s33 offen
s_add_u32 s33, s37, 24576
buffer_store_dwordx4 v[56:59], v26, s[4:7], s33 offen
v_lshlrev_b32 v152, 16, v32
v_and_b32 v153, 0xffff0000, v32
v_lshlrev_b32 v154, 16, v33
v_and_b32 v155, 0xffff0000, v33
v_lshlrev_b32 v156, 16, v34
v_and_b32 v157, 0xffff0000, v34
v_lshlrev_b32 v158, 16, v35
v_and_b32 v159, 0xffff0000, v35
v_lshlrev_b32 v160, 16, v36
v_and_b32 v161, 0xffff0000, v36
v_lshlrev_b32 v162, 16, v37
v_and_b32 v163, 0xffff0000, v37
v_lshlrev_b32 v164, 16, v38
v_and_b32 v165, 0xffff0000, v38
v_lshlrev_b32 v166, 16, v39
v_and_b32 v167, 0xffff0000, v39
v_lshlrev_b32 v168, 16, v40
v_and_b32 v169, 0xffff0000, v40
v_lshlrev_b32 v170, 16, v41
v_and_b32 v171, 0xffff0000, v41
v_lshlrev_b32 v172, 16, v42
v_and_b32 v173, 0xffff0000, v42
v_lshlrev_b32 v174, 16, v43
v_and_b32 v175, 0xffff0000, v43
v_lshlrev_b32 v176, 16, v44
v_and_b32 v177, 0xffff0000, v44
v_lshlrev_b32 v178, 16, v45
v_and_b32 v179, 0xffff0000, v45
v_lshlrev_b32 v180, 16, v46
v_and_b32 v181, 0xffff0000, v46
v_lshlrev_b32 v182, 16, v47
v_and_b32 v183, 0xffff0000, v47
v_lshlrev_b32 v184, 16, v48
v_and_b32 v185, 0xffff0000, v48
v_lshlrev_b32 v186, 16, v49
v_and_b32 v187, 0xffff0000, v49
v_lshlrev_b32 v188, 16, v50
v_and_b32 v189, 0xffff0000, v50
v_lshlrev_b32 v190, 16, v51
v_and_b32 v191, 0xffff0000, v51
v_lshlrev_b32 v192, 16, v52
v_and_b32 v193, 0xffff0000, v52
v_lshlrev_b32 v194, 16, v53
v_and_b32 v195, 0xffff0000, v53
v_lshlrev_b32 v196, 16, v54
v_and_b32 v197, 0xffff0000, v54
v_lshlrev_b32 v198, 16, v55
v_and_b32 v199, 0xffff0000, v55
v_lshlrev_b32 v200, 16, v56
v_and_b32 v201, 0xffff0000, v56
v_lshlrev_b32 v202, 16, v57
v_and_b32 v203, 0xffff0000, v57
v_lshlrev_b32 v204, 16, v58
v_and_b32 v205, 0xffff0000, v58
v_lshlrev_b32 v206, 16, v59
v_and_b32 v207, 0xffff0000, v59
v_pk_add_f32 v[208:209], v[152:153], v[154:155]
v_pk_mul_f32 v[210:211], v[152:153], v[152:153]
v_pk_fma_f32 v[210:211], v[154:155], v[154:155], v[210:211]
v_pk_add_f32 v[208:209], v[208:209], v[156:157]
v_pk_fma_f32 v[210:211], v[156:157], v[156:157], v[210:211]
v_pk_add_f32 v[208:209], v[208:209], v[158:159]
v_pk_fma_f32 v[210:211], v[158:159], v[158:159], v[210:211]
v_pk_add_f32 v[208:209], v[208:209], v[160:161]
v_pk_fma_f32 v[210:211], v[160:161], v[160:161], v[210:211]
v_pk_add_f32 v[208:209], v[208:209], v[162:163]
v_pk_fma_f32 v[210:211], v[162:163], v[162:163], v[210:211]
v_pk_add_f32 v[208:209], v[208:209], v[164:165]
v_pk_fma_f32 v[210:211], v[164:165], v[164:165], v[210:211]
v_pk_add_f32 v[208:209], v[208:209], v[166:167]
v_pk_fma_f32 v[210:211], v[166:167], v[166:167], v[210:211]
v_pk_add_f32 v[208:209], v[208:209], v[168:169]
v_pk_fma_f32 v[210:211], v[168:169], v[168:169], v[210:211]
v_pk_add_f32 v[208:209], v[208:209], v[170:171]
v_pk_fma_f32 v[210:211], v[170:171], v[170:171], v[210:211]
v_pk_add_f32 v[208:209], v[208:209], v[172:173]
v_pk_fma_f32 v[210:211], v[172:173], v[172:173], v[210:211]
v_pk_add_f32 v[208:209], v[208:209], v[174:175]
v_pk_fma_f32 v[210:211], v[174:175], v[174:175], v[210:211]
v_pk_add_f32 v[208:209], v[208:209], v[176:177]
v_pk_fma_f32 v[210:211], v[176:177], v[176:177], v[210:211]
v_pk_add_f32 v[208:209], v[208:209], v[178:179]
v_pk_fma_f32 v[210:211], v[178:179], v[178:179], v[210:211]
v_pk_add_f32 v[208:209], v[208:209], v[180:181]
v_pk_fma_f32 v[210:211], v[180:181], v[180:181], v[210:211]
v_pk_add_f32 v[208:209], v[208:209], v[182:183]
v_pk_fma_f32 v[210:211], v[182:183], v[182:183], v[210:211]
v_pk_add_f32 v[208:209], v[208:209], v[184:185]
v_pk_fma_f32 v[210:211], v[184:185], v[184:185], v[210:211]
v_pk_add_f32 v[208:209], v[208:209], v[186:187]
v_pk_fma_f32 v[210:211], v[186:187], v[186:187], v[210:211]
v_pk_add_f32 v[208:209], v[208:209], v[188:189]
v_pk_fma_f32 v[210:211], v[188:189], v[188:189], v[210:211]
v_pk_add_f32 v[208:209], v[208:209], v[190:191]
v_pk_fma_f32 v[210:211], v[190:191], v[190:191], v[210:211]
v_pk_add_f32 v[208:209], v[208:209], v[192:193]
v_pk_fma_f32 v[210:211], v[192:193], v[192:193], v[210:211]
v_pk_add_f32 v[208:209], v[208:209], v[194:195]
v_pk_fma_f32 v[210:211], v[194:195], v[194:195], v[210:211]
v_pk_add_f32 v[208:209], v[208:209], v[196:197]
v_pk_fma_f32 v[210:211], v[196:197], v[196:197], v[210:211]
v_pk_add_f32 v[208:209], v[208:209], v[198:199]
v_pk_fma_f32 v[210:211], v[198:199], v[198:199], v[210:211]
v_pk_add_f32 v[208:209], v[208:209], v[200:201]
v_pk_fma_f32 v[210:211], v[200:201], v[200:201], v[210:211]
v_pk_add_f32 v[208:209], v[208:209], v[202:203]
v_pk_fma_f32 v[210:211], v[202:203], v[202:203], v[210:211]
v_pk_add_f32 v[208:209], v[208:209], v[204:205]
v_pk_fma_f32 v[210:211], v[204:205], v[204:205], v[210:211]
v_pk_add_f32 v[208:209], v[208:209], v[206:207]
v_pk_fma_f32 v[210:211], v[206:207], v[206:207], v[210:211]
v_add_f32 v208, v208, v209
v_add_f32 v209, v210, v211
v_mov_b32 v210, v208
v_mov_b32 v211, v209
s_nop 0
v_permlane32_swap_b32 v208, v210
v_permlane32_swap_b32 v209, v211
v_add_f32 v208, v208, v210
v_add_f32 v209, v209, v211
ds_write_b64 v28, v[208:209]
s_waitcnt lgkmcnt(0)
s_barrier
ds_read_b64 v[208:209], v27
ds_read_b64 v[210:211], v27 offset:256
ds_read_b64 v[212:213], v27 offset:512
ds_read_b64 v[214:215], v27 offset:768
s_waitcnt lgkmcnt(0)
v_pk_add_f32 v[208:209], v[208:209], v[210:211]
v_pk_add_f32 v[212:213], v[212:213], v[214:215]
v_pk_add_f32 v[208:209], v[208:209], v[212:213]
v_mul_f32 v208, 0x3b124925, v208
v_mul_f32 v209, 0x3b124925, v209
v_fma_f32 v209, -v208, v208, v209
v_max_f32 v209, 0, v209
v_add_f32 v209, 0x3727c5ac, v209
v_rsq_f32 v209, v209
s_nop 0
v_mul_f32 v208, v208, v209
v_mov_b32 v210, v209
v_mov_b32 v211, v208
v_pk_fma_f32 v[152:153], v[152:153], v[210:211], v[210:211] op_sel:[0,0,1] op_sel_hi:[1,0,1] neg_lo:[0,0,1] neg_hi:[0,0,1]
v_pk_fma_f32 v[154:155], v[154:155], v[210:211], v[210:211] op_sel:[0,0,1] op_sel_hi:[1,0,1] neg_lo:[0,0,1] neg_hi:[0,0,1]
v_pk_fma_f32 v[156:157], v[156:157], v[210:211], v[210:211] op_sel:[0,0,1] op_sel_hi:[1,0,1] neg_lo:[0,0,1] neg_hi:[0,0,1]
v_pk_fma_f32 v[158:159], v[158:159], v[210:211], v[210:211] op_sel:[0,0,1] op_sel_hi:[1,0,1] neg_lo:[0,0,1] neg_hi:[0,0,1]
v_pk_fma_f32 v[160:161], v[160:161], v[210:211], v[210:211] op_sel:[0,0,1] op_sel_hi:[1,0,1] neg_lo:[0,0,1] neg_hi:[0,0,1]
v_pk_fma_f32 v[162:163], v[162:163], v[210:211], v[210:211] op_sel:[0,0,1] op_sel_hi:[1,0,1] neg_lo:[0,0,1] neg_hi:[0,0,1]
v_pk_fma_f32 v[164:165], v[164:165], v[210:211], v[210:211] op_sel:[0,0,1] op_sel_hi:[1,0,1] neg_lo:[0,0,1] neg_hi:[0,0,1]
v_pk_fma_f32 v[166:167], v[166:167], v[210:211], v[210:211] op_sel:[0,0,1] op_sel_hi:[1,0,1] neg_lo:[0,0,1] neg_hi:[0,0,1]
v_pk_fma_f32 v[168:169], v[168:169], v[210:211], v[210:211] op_sel:[0,0,1] op_sel_hi:[1,0,1] neg_lo:[0,0,1] neg_hi:[0,0,1]
v_pk_fma_f32 v[170:171], v[170:171], v[210:211], v[210:211] op_sel:[0,0,1] op_sel_hi:[1,0,1] neg_lo:[0,0,1] neg_hi:[0,0,1]
v_pk_fma_f32 v[172:173], v[172:173], v[210:211], v[210:211] op_sel:[0,0,1] op_sel_hi:[1,0,1] neg_lo:[0,0,1] neg_hi:[0,0,1]
v_pk_fma_f32 v[174:175], v[174:175], v[210:211], v[210:211] op_sel:[0,0,1] op_sel_hi:[1,0,1] neg_lo:[0,0,1] neg_hi:[0,0,1]
v_pk_fma_f32 v[176:177], v[176:177], v[210:211], v[210:211] op_sel:[0,0,1] op_sel_hi:[1,0,1] neg_lo:[0,0,1] neg_hi:[0,0,1]
v_pk_fma_f32 v[178:179], v[178:179], v[210:211], v[210:211] op_sel:[0,0,1] op_sel_hi:[1,0,1] neg_lo:[0,0,1] neg_hi:[0,0,1]
v_pk_fma_f32 v[180:181], v[180:181], v[210:211], v[210:211] op_sel:[0,0,1] op_sel_hi:[1,0,1] neg_lo:[0,0,1] neg_hi:[0,0,1]
v_pk_fma_f32 v[182:183], v[182:183], v[210:211], v[210:211] op_sel:[0,0,1] op_sel_hi:[1,0,1] neg_lo:[0,0,1] neg_hi:[0,0,1]
v_pk_fma_f32 v[184:185], v[184:185], v[210:211], v[210:211] op_sel:[0,0,1] op_sel_hi:[1,0,1] neg_lo:[0,0,1] neg_hi:[0,0,1]
v_pk_fma_f32 v[186:187], v[186:187], v[210:211], v[210:211] op_sel:[0,0,1] op_sel_hi:[1,0,1] neg_lo:[0,0,1] neg_hi:[0,0,1]
v_pk_fma_f32 v[188:189], v[188:189], v[210:211], v[210:211] op_sel:[0,0,1] op_sel_hi:[1,0,1] neg_lo:[0,0,1] neg_hi:[0,0,1]
v_pk_fma_f32 v[190:191], v[190:191], v[210:211], v[210:211] op_sel:[0,0,1] op_sel_hi:[1,0,1] neg_lo:[0,0,1] neg_hi:[0,0,1]
v_pk_fma_f32 v[192:193], v[192:193], v[210:211], v[210:211] op_sel:[0,0,1] op_sel_hi:[1,0,1] neg_lo:[0,0,1] neg_hi:[0,0,1]
v_pk_fma_f32 v[194:195], v[194:195], v[210:211], v[210:211] op_sel:[0,0,1] op_sel_hi:[1,0,1] neg_lo:[0,0,1] neg_hi:[0,0,1]
v_pk_fma_f32 v[196:197], v[196:197], v[210:211], v[210:211] op_sel:[0,0,1] op_sel_hi:[1,0,1] neg_lo:[0,0,1] neg_hi:[0,0,1]
v_pk_fma_f32 v[198:199], v[198:199], v[210:211], v[210:211] op_sel:[0,0,1] op_sel_hi:[1,0,1] neg_lo:[0,0,1] neg_hi:[0,0,1]
v_pk_fma_f32 v[200:201], v[200:201], v[210:211], v[210:211] op_sel:[0,0,1] op_sel_hi:[1,0,1] neg_lo:[0,0,1] neg_hi:[0,0,1]
v_pk_fma_f32 v[202:203], v[202:203], v[210:211], v[210:211] op_sel:[0,0,1] op_sel_hi:[1,0,1] neg_lo:[0,0,1] neg_hi:[0,0,1]
v_pk_fma_f32 v[204:205], v[204:205], v[210:211], v[210:211] op_sel:[0,0,1] op_sel_hi:[1,0,1] neg_lo:[0,0,1] neg_hi:[0,0,1]
v_pk_fma_f32 v[206:207], v[206:207], v[210:211], v[210:211] op_sel:[0,0,1] op_sel_hi:[1,0,1] neg_lo:[0,0,1] neg_hi:[0,0,1]
v_cvt_pk_bf16_f32 v32, v152, v153
v_cvt_pk_bf16_f32 v33, v154, v155
v_cvt_pk_bf16_f32 v34, v156, v157
v_cvt_pk_bf16_f32 v35, v158, v159
v_cvt_pk_bf16_f32 v36, v160, v161
v_cvt_pk_bf16_f32 v37, v162, v163
v_cvt_pk_bf16_f32 v38, v164, v165
v_cvt_pk_bf16_f32 v39, v166, v167
v_cvt_pk_bf16_f32 v40, v168, v169
v_cvt_pk_bf16_f32 v41, v170, v171
v_cvt_pk_bf16_f32 v42, v172, v173
v_cvt_pk_bf16_f32 v43, v174, v175
v_cvt_pk_bf16_f32 v44, v176, v177
v_cvt_pk_bf16_f32 v45, v178, v179
v_cvt_pk_bf16_f32 v46, v180, v181
v_cvt_pk_bf16_f32 v47, v182, v183
v_cvt_pk_bf16_f32 v48, v184, v185
v_cvt_pk_bf16_f32 v49, v186, v187
v_cvt_pk_bf16_f32 v50, v188, v189
v_cvt_pk_bf16_f32 v51, v190, v191
v_cvt_pk_bf16_f32 v52, v192, v193
v_cvt_pk_bf16_f32 v53, v194, v195
v_cvt_pk_bf16_f32 v54, v196, v197
v_cvt_pk_bf16_f32 v55, v198, v199
v_cvt_pk_bf16_f32 v56, v200, v201
v_cvt_pk_bf16_f32 v57, v202, v203
v_cvt_pk_bf16_f32 v58, v204, v205
v_cvt_pk_bf16_f32 v59, v206, v207
s_add_u32 s33, s38, 0
buffer_store_dwordx4 v[32:35], v26, s[4:7], s33 offen
s_add_u32 s33, s38, 4096
buffer_store_dwordx4 v[36:39], v26, s[4:7], s33 offen
s_add_u32 s33, s38, 8192
buffer_store_dwordx4 v[40:43], v26, s[4:7], s33 offen
s_add_u32 s33, s38, 12288
buffer_store_dwordx4 v[44:47], v26, s[4:7], s33 offen
s_add_u32 s33, s38, 16384
buffer_store_dwordx4 v[48:51], v26, s[4:7], s33 offen
s_add_u32 s33, s38, 20480
buffer_store_dwordx4 v[52:55], v26, s[4:7], s33 offen
s_add_u32 s33, s38, 24576
buffer_store_dwordx4 v[56:59], v26, s[4:7], s33 offen
s_barrier
s_add_u32 s33, s30, 1
s_mul_i32 s36, s33, 28672
s_add_u32 s37, s36, 22028288
s_add_u32 s38, s36, 14688256
s_add_u32 s33, s37, 0
buffer_store_dwordx4 v[60:63], v26, s[4:7], s33 offen
s_add_u32 s33, s37, 4096
buffer_store_dwordx4 v[64:67], v26, s[4:7], s33 offen
s_add_u32 s33, s37, 8192
buffer_store_dwordx4 v[68:71], v26, s[4:7], s33 offen
s_add_u32 s33, s37, 12288
buffer_store_dwordx4 v[72:75], v26, s[4:7], s33 offen
s_add_u32 s33, s37, 16384
buffer_store_dwordx4 v[76:79], v26, s[4:7], s33 offen
s_add_u32 s33, s37, 20480
buffer_store_dwordx4 v[80:83], v26, s[4:7], s33 offen
s_add_u32 s33, s37, 24576
buffer_store_dwordx4 v[84:87], v26, s[4:7], s33 offen
v_lshlrev_b32 v152, 16, v60
v_and_b32 v153, 0xffff0000, v60
v_lshlrev_b32 v154, 16, v61
v_and_b32 v155, 0xffff0000, v61
v_lshlrev_b32 v156, 16, v62
v_and_b32 v157, 0xffff0000, v62
v_lshlrev_b32 v158, 16, v63
v_and_b32 v159, 0xffff0000, v63
v_lshlrev_b32 v160, 16, v64
v_and_b32 v161, 0xffff0000, v64
v_lshlrev_b32 v162, 16, v65
v_and_b32 v163, 0xffff0000, v65
v_lshlrev_b32 v164, 16, v66
v_and_b32 v165, 0xffff0000, v66
v_lshlrev_b32 v166, 16, v67
v_and_b32 v167, 0xffff0000, v67
v_lshlrev_b32 v168, 16, v68
v_and_b32 v169, 0xffff0000, v68
v_lshlrev_b32 v170, 16, v69
v_and_b32 v171, 0xffff0000, v69
v_lshlrev_b32 v172, 16, v70
v_and_b32 v173, 0xffff0000, v70
v_lshlrev_b32 v174, 16, v71
v_and_b32 v175, 0xffff0000, v71
v_lshlrev_b32 v176, 16, v72
v_and_b32 v177, 0xffff0000, v72
v_lshlrev_b32 v178, 16, v73
v_and_b32 v179, 0xffff0000, v73
v_lshlrev_b32 v180, 16, v74
v_and_b32 v181, 0xffff0000, v74
v_lshlrev_b32 v182, 16, v75
v_and_b32 v183, 0xffff0000, v75
v_lshlrev_b32 v184, 16, v76
v_and_b32 v185, 0xffff0000, v76
v_lshlrev_b32 v186, 16, v77
v_and_b32 v187, 0xffff0000, v77
v_lshlrev_b32 v188, 16, v78
v_and_b32 v189, 0xffff0000, v78
v_lshlrev_b32 v190, 16, v79
v_and_b32 v191, 0xffff0000, v79
v_lshlrev_b32 v192, 16, v80
v_and_b32 v193, 0xffff0000, v80
v_lshlrev_b32 v194, 16, v81
v_and_b32 v195, 0xffff0000, v81
v_lshlrev_b32 v196, 16, v82
v_and_b32 v197, 0xffff0000, v82
v_lshlrev_b32 v198, 16, v83
v_and_b32 v199, 0xffff0000, v83
v_lshlrev_b32 v200, 16, v84
v_and_b32 v201, 0xffff0000, v84
v_lshlrev_b32 v202, 16, v85
v_and_b32 v203, 0xffff0000, v85
v_lshlrev_b32 v204, 16, v86
v_and_b32 v205, 0xffff0000, v86
v_lshlrev_b32 v206, 16, v87
v_and_b32 v207, 0xffff0000, v87
v_pk_add_f32 v[208:209], v[152:153], v[154:155]
v_pk_mul_f32 v[210:211], v[152:153], v[152:153]
v_pk_fma_f32 v[210:211], v[154:155], v[154:155], v[210:211]
v_pk_add_f32 v[208:209], v[208:209], v[156:157]
v_pk_fma_f32 v[210:211], v[156:157], v[156:157], v[210:211]
v_pk_add_f32 v[208:209], v[208:209], v[158:159]
v_pk_fma_f32 v[210:211], v[158:159], v[158:159], v[210:211]
v_pk_add_f32 v[208:209], v[208:209], v[160:161]
v_pk_fma_f32 v[210:211], v[160:161], v[160:161], v[210:211]
v_pk_add_f32 v[208:209], v[208:209], v[162:163]
v_pk_fma_f32 v[210:211], v[162:163], v[162:163], v[210:211]
v_pk_add_f32 v[208:209], v[208:209], v[164:165]
v_pk_fma_f32 v[210:211], v[164:165], v[164:165], v[210:211]
v_pk_add_f32 v[208:209], v[208:209], v[166:167]
v_pk_fma_f32 v[210:211], v[166:167], v[166:167], v[210:211]
v_pk_add_f32 v[208:209], v[208:209], v[168:169]
v_pk_fma_f32 v[210:211], v[168:169], v[168:169], v[210:211]
v_pk_add_f32 v[208:209], v[208:209], v[170:171]
v_pk_fma_f32 v[210:211], v[170:171], v[170:171], v[210:211]
v_pk_add_f32 v[208:209], v[208:209], v[172:173]
v_pk_fma_f32 v[210:211], v[172:173], v[172:173], v[210:211]
v_pk_add_f32 v[208:209], v[208:209], v[174:175]
v_pk_fma_f32 v[210:211], v[174:175], v[174:175], v[210:211]
v_pk_add_f32 v[208:209], v[208:209], v[176:177]
v_pk_fma_f32 v[210:211], v[176:177], v[176:177], v[210:211]
v_pk_add_f32 v[208:209], v[208:209], v[178:179]
v_pk_fma_f32 v[210:211], v[178:179], v[178:179], v[210:211]
v_pk_add_f32 v[208:209], v[208:209], v[180:181]
v_pk_fma_f32 v[210:211], v[180:181], v[180:181], v[210:211]
v_pk_add_f32 v[208:209], v[208:209], v[182:183]
v_pk_fma_f32 v[210:211], v[182:183], v[182:183], v[210:211]
v_pk_add_f32 v[208:209], v[208:209], v[184:185]
v_pk_fma_f32 v[210:211], v[184:185], v[184:185], v[210:211]
v_pk_add_f32 v[208:209], v[208:209], v[186:187]
v_pk_fma_f32 v[210:211], v[186:187], v[186:187], v[210:211]
v_pk_add_f32 v[208:209], v[208:209], v[188:189]
v_pk_fma_f32 v[210:211], v[188:189], v[188:189], v[210:211]
v_pk_add_f32 v[208:209], v[208:209], v[190:191]
v_pk_fma_f32 v[210:211], v[190:191], v[190:191], v[210:211]
v_pk_add_f32 v[208:209], v[208:209], v[192:193]
v_pk_fma_f32 v[210:211], v[192:193], v[192:193], v[210:211]
v_pk_add_f32 v[208:209], v[208:209], v[194:195]
v_pk_fma_f32 v[210:211], v[194:195], v[194:195], v[210:211]
v_pk_add_f32 v[208:209], v[208:209], v[196:197]
v_pk_fma_f32 v[210:211], v[196:197], v[196:197], v[210:211]
v_pk_add_f32 v[208:209], v[208:209], v[198:199]
v_pk_fma_f32 v[210:211], v[198:199], v[198:199], v[210:211]
v_pk_add_f32 v[208:209], v[208:209], v[200:201]
v_pk_fma_f32 v[210:211], v[200:201], v[200:201], v[210:211]
v_pk_add_f32 v[208:209], v[208:209], v[202:203]
v_pk_fma_f32 v[210:211], v[202:203], v[202:203], v[210:211]
v_pk_add_f32 v[208:209], v[208:209], v[204:205]
v_pk_fma_f32 v[210:211], v[204:205], v[204:205], v[210:211]
v_pk_add_f32 v[208:209], v[208:209], v[206:207]
v_pk_fma_f32 v[210:211], v[206:207], v[206:207], v[210:211]
v_add_f32 v208, v208, v209
v_add_f32 v209, v210, v211
v_mov_b32 v210, v208
v_mov_b32 v211, v209
s_nop 0
v_permlane32_swap_b32 v208, v210
v_permlane32_swap_b32 v209, v211
v_add_f32 v208, v208, v210
v_add_f32 v209, v209, v211
ds_write_b64 v28, v[208:209]
s_waitcnt lgkmcnt(0)
s_barrier
ds_read_b64 v[208:209], v27
ds_read_b64 v[210:211], v27 offset:256
ds_read_b64 v[212:213], v27 offset:512
ds_read_b64 v[214:215], v27 offset:768
s_waitcnt lgkmcnt(0)
v_pk_add_f32 v[208:209], v[208:209], v[210:211]
v_pk_add_f32 v[212:213], v[212:213], v[214:215]
v_pk_add_f32 v[208:209], v[208:209], v[212:213]
v_mul_f32 v208, 0x3b124925, v208
v_mul_f32 v209, 0x3b124925, v209
v_fma_f32 v209, -v208, v208, v209
v_max_f32 v209, 0, v209
v_add_f32 v209, 0x3727c5ac, v209
v_rsq_f32 v209, v209
s_nop 0
v_mul_f32 v208, v208, v209
v_mov_b32 v210, v209
v_mov_b32 v211, v208
v_pk_fma_f32 v[152:153], v[152:153], v[210:211], v[210:211] op_sel:[0,0,1] op_sel_hi:[1,0,1] neg_lo:[0,0,1] neg_hi:[0,0,1]
v_pk_fma_f32 v[154:155], v[154:155], v[210:211], v[210:211] op_sel:[0,0,1] op_sel_hi:[1,0,1] neg_lo:[0,0,1] neg_hi:[0,0,1]
v_pk_fma_f32 v[156:157], v[156:157], v[210:211], v[210:211] op_sel:[0,0,1] op_sel_hi:[1,0,1] neg_lo:[0,0,1] neg_hi:[0,0,1]
v_pk_fma_f32 v[158:159], v[158:159], v[210:211], v[210:211] op_sel:[0,0,1] op_sel_hi:[1,0,1] neg_lo:[0,0,1] neg_hi:[0,0,1]
v_pk_fma_f32 v[160:161], v[160:161], v[210:211], v[210:211] op_sel:[0,0,1] op_sel_hi:[1,0,1] neg_lo:[0,0,1] neg_hi:[0,0,1]
v_pk_fma_f32 v[162:163], v[162:163], v[210:211], v[210:211] op_sel:[0,0,1] op_sel_hi:[1,0,1] neg_lo:[0,0,1] neg_hi:[0,0,1]
v_pk_fma_f32 v[164:165], v[164:165], v[210:211], v[210:211] op_sel:[0,0,1] op_sel_hi:[1,0,1] neg_lo:[0,0,1] neg_hi:[0,0,1]
v_pk_fma_f32 v[166:167], v[166:167], v[210:211], v[210:211] op_sel:[0,0,1] op_sel_hi:[1,0,1] neg_lo:[0,0,1] neg_hi:[0,0,1]
v_pk_fma_f32 v[168:169], v[168:169], v[210:211], v[210:211] op_sel:[0,0,1] op_sel_hi:[1,0,1] neg_lo:[0,0,1] neg_hi:[0,0,1]
v_pk_fma_f32 v[170:171], v[170:171], v[210:211], v[210:211] op_sel:[0,0,1] op_sel_hi:[1,0,1] neg_lo:[0,0,1] neg_hi:[0,0,1]
v_pk_fma_f32 v[172:173], v[172:173], v[210:211], v[210:211] op_sel:[0,0,1] op_sel_hi:[1,0,1] neg_lo:[0,0,1] neg_hi:[0,0,1]
v_pk_fma_f32 v[174:175], v[174:175], v[210:211], v[210:211] op_sel:[0,0,1] op_sel_hi:[1,0,1] neg_lo:[0,0,1] neg_hi:[0,0,1]
v_pk_fma_f32 v[176:177], v[176:177], v[210:211], v[210:211] op_sel:[0,0,1] op_sel_hi:[1,0,1] neg_lo:[0,0,1] neg_hi:[0,0,1]
v_pk_fma_f32 v[178:179], v[178:179], v[210:211], v[210:211] op_sel:[0,0,1] op_sel_hi:[1,0,1] neg_lo:[0,0,1] neg_hi:[0,0,1]
v_pk_fma_f32 v[180:181], v[180:181], v[210:211], v[210:211] op_sel:[0,0,1] op_sel_hi:[1,0,1] neg_lo:[0,0,1] neg_hi:[0,0,1]
v_pk_fma_f32 v[182:183], v[182:183], v[210:211], v[210:211] op_sel:[0,0,1] op_sel_hi:[1,0,1] neg_lo:[0,0,1] neg_hi:[0,0,1]
v_pk_fma_f32 v[184:185], v[184:185], v[210:211], v[210:211] op_sel:[0,0,1] op_sel_hi:[1,0,1] neg_lo:[0,0,1] neg_hi:[0,0,1]
v_pk_fma_f32 v[186:187], v[186:187], v[210:211], v[210:211] op_sel:[0,0,1] op_sel_hi:[1,0,1] neg_lo:[0,0,1] neg_hi:[0,0,1]
v_pk_fma_f32 v[188:189], v[188:189], v[210:211], v[210:211] op_sel:[0,0,1] op_sel_hi:[1,0,1] neg_lo:[0,0,1] neg_hi:[0,0,1]
v_pk_fma_f32 v[190:191], v[190:191], v[210:211], v[210:211] op_sel:[0,0,1] op_sel_hi:[1,0,1] neg_lo:[0,0,1] neg_hi:[0,0,1]
v_pk_fma_f32 v[192:193], v[192:193], v[210:211], v[210:211] op_sel:[0,0,1] op_sel_hi:[1,0,1] neg_lo:[0,0,1] neg_hi:[0,0,1]
v_pk_fma_f32 v[194:195], v[194:195], v[210:211], v[210:211] op_sel:[0,0,1] op_sel_hi:[1,0,1] neg_lo:[0,0,1] neg_hi:[0,0,1]
v_pk_fma_f32 v[196:197], v[196:197], v[210:211], v[210:211] op_sel:[0,0,1] op_sel_hi:[1,0,1] neg_lo:[0,0,1] neg_hi:[0,0,1]
v_pk_fma_f32 v[198:199], v[198:199], v[210:211], v[210:211] op_sel:[0,0,1] op_sel_hi:[1,0,1] neg_lo:[0,0,1] neg_hi:[0,0,1]
v_pk_fma_f32 v[200:201], v[200:201], v[210:211], v[210:211] op_sel:[0,0,1] op_sel_hi:[1,0,1] neg_lo:[0,0,1] neg_hi:[0,0,1]
v_pk_fma_f32 v[202:203], v[202:203], v[210:211], v[210:211] op_sel:[0,0,1] op_sel_hi:[1,0,1] neg_lo:[0,0,1] neg_hi:[0,0,1]
v_pk_fma_f32 v[204:205], v[204:205], v[210:211], v[210:211] op_sel:[0,0,1] op_sel_hi:[1,0,1] neg_lo:[0,0,1] neg_hi:[0,0,1]
v_pk_fma_f32 v[206:207], v[206:207], v[210:211], v[210:211] op_sel:[0,0,1] op_sel_hi:[1,0,1] neg_lo:[0,0,1] neg_hi:[0,0,1]
v_cvt_pk_bf16_f32 v60, v152, v153
v_cvt_pk_bf16_f32 v61, v154, v155
v_cvt_pk_bf16_f32 v62, v156, v157
v_cvt_pk_bf16_f32 v63, v158, v159
v_cvt_pk_bf16_f32 v64, v160, v161
v_cvt_pk_bf16_f32 v65, v162, v163
v_cvt_pk_bf16_f32 v66, v164, v165
v_cvt_pk_bf16_f32 v67, v166, v167
v_cvt_pk_bf16_f32 v68, v168, v169
v_cvt_pk_bf16_f32 v69, v170, v171
v_cvt_pk_bf16_f32 v70, v172, v173
v_cvt_pk_bf16_f32 v71, v174, v175
v_cvt_pk_bf16_f32 v72, v176, v177
v_cvt_pk_bf16_f32 v73, v178, v179
v_cvt_pk_bf16_f32 v74, v180, v181
v_cvt_pk_bf16_f32 v75, v182, v183
v_cvt_pk_bf16_f32 v76, v184, v185
v_cvt_pk_bf16_f32 v77, v186, v187
v_cvt_pk_bf16_f32 v78, v188, v189
v_cvt_pk_bf16_f32 v79, v190, v191
v_cvt_pk_bf16_f32 v80, v192, v193
v_cvt_pk_bf16_f32 v81, v194, v195
v_cvt_pk_bf16_f32 v82, v196, v197
v_cvt_pk_bf16_f32 v83, v198, v199
v_cvt_pk_bf16_f32 v84, v200, v201
v_cvt_pk_bf16_f32 v85, v202, v203
v_cvt_pk_bf16_f32 v86, v204, v205
v_cvt_pk_bf16_f32 v87, v206, v207
s_add_u32 s33, s38, 0
buffer_store_dwordx4 v[60:63], v26, s[4:7], s33 offen
s_add_u32 s33, s38, 4096
buffer_store_dwordx4 v[64:67], v26, s[4:7], s33 offen
s_add_u32 s33, s38, 8192
buffer_store_dwordx4 v[68:71], v26, s[4:7], s33 offen
s_add_u32 s33, s38, 12288
buffer_store_dwordx4 v[72:75], v26, s[4:7], s33 offen
s_add_u32 s33, s38, 16384
buffer_store_dwordx4 v[76:79], v26, s[4:7], s33 offen
s_add_u32 s33, s38, 20480
buffer_store_dwordx4 v[80:83], v26, s[4:7], s33 offen
s_add_u32 s33, s38, 24576
buffer_store_dwordx4 v[84:87], v26, s[4:7], s33 offen
s_barrier
s_add_u32 s33, s30, 2
s_mul_i32 s36, s33, 28672
s_add_u32 s37, s36, 22028288
s_add_u32 s38, s36, 14688256
s_add_u32 s33, s37, 0
buffer_store_dwordx4 v[88:91], v26, s[4:7], s33 offen
s_add_u32 s33, s37, 4096
buffer_store_dwordx4 v[92:95], v26, s[4:7], s33 offen
s_add_u32 s33, s37, 8192
buffer_store_dwordx4 v[96:99], v26, s[4:7], s33 offen
s_add_u32 s33, s37, 12288
buffer_store_dwordx4 v[100:103], v26, s[4:7], s33 offen
s_add_u32 s33, s37, 16384
buffer_store_dwordx4 v[104:107], v26, s[4:7], s33 offen
s_add_u32 s33, s37, 20480
buffer_store_dwordx4 v[108:111], v26, s[4:7], s33 offen
s_add_u32 s33, s37, 24576
buffer_store_dwordx4 v[112:115], v26, s[4:7], s33 offen
v_lshlrev_b32 v152, 16, v88
v_and_b32 v153, 0xffff0000, v88
v_lshlrev_b32 v154, 16, v89
v_and_b32 v155, 0xffff0000, v89
v_lshlrev_b32 v156, 16, v90
v_and_b32 v157, 0xffff0000, v90
v_lshlrev_b32 v158, 16, v91
v_and_b32 v159, 0xffff0000, v91
v_lshlrev_b32 v160, 16, v92
v_and_b32 v161, 0xffff0000, v92
v_lshlrev_b32 v162, 16, v93
v_and_b32 v163, 0xffff0000, v93
v_lshlrev_b32 v164, 16, v94
v_and_b32 v165, 0xffff0000, v94
v_lshlrev_b32 v166, 16, v95
v_and_b32 v167, 0xffff0000, v95
v_lshlrev_b32 v168, 16, v96
v_and_b32 v169, 0xffff0000, v96
v_lshlrev_b32 v170, 16, v97
v_and_b32 v171, 0xffff0000, v97
v_lshlrev_b32 v172, 16, v98
v_and_b32 v173, 0xffff0000, v98
v_lshlrev_b32 v174, 16, v99
v_and_b32 v175, 0xffff0000, v99
v_lshlrev_b32 v176, 16, v100
v_and_b32 v177, 0xffff0000, v100
v_lshlrev_b32 v178, 16, v101
v_and_b32 v179, 0xffff0000, v101
v_lshlrev_b32 v180, 16, v102
v_and_b32 v181, 0xffff0000, v102
v_lshlrev_b32 v182, 16, v103
v_and_b32 v183, 0xffff0000, v103
v_lshlrev_b32 v184, 16, v104
v_and_b32 v185, 0xffff0000, v104
v_lshlrev_b32 v186, 16, v105
v_and_b32 v187, 0xffff0000, v105
v_lshlrev_b32 v188, 16, v106
v_and_b32 v189, 0xffff0000, v106
v_lshlrev_b32 v190, 16, v107
v_and_b32 v191, 0xffff0000, v107
v_lshlrev_b32 v192, 16, v108
v_and_b32 v193, 0xffff0000, v108
v_lshlrev_b32 v194, 16, v109
v_and_b32 v195, 0xffff0000, v109
v_lshlrev_b32 v196, 16, v110
v_and_b32 v197, 0xffff0000, v110
v_lshlrev_b32 v198, 16, v111
v_and_b32 v199, 0xffff0000, v111
v_lshlrev_b32 v200, 16, v112
v_and_b32 v201, 0xffff0000, v112
v_lshlrev_b32 v202, 16, v113
v_and_b32 v203, 0xffff0000, v113
v_lshlrev_b32 v204, 16, v114
v_and_b32 v205, 0xffff0000, v114
v_lshlrev_b32 v206, 16, v115
v_and_b32 v207, 0xffff0000, v115
v_pk_add_f32 v[208:209], v[152:153], v[154:155]
v_pk_mul_f32 v[210:211], v[152:153], v[152:153]
v_pk_fma_f32 v[210:211], v[154:155], v[154:155], v[210:211]
v_pk_add_f32 v[208:209], v[208:209], v[156:157]
v_pk_fma_f32 v[210:211], v[156:157], v[156:157], v[210:211]
v_pk_add_f32 v[208:209], v[208:209], v[158:159]
v_pk_fma_f32 v[210:211], v[158:159], v[158:159], v[210:211]
v_pk_add_f32 v[208:209], v[208:209], v[160:161]
v_pk_fma_f32 v[210:211], v[160:161], v[160:161], v[210:211]
v_pk_add_f32 v[208:209], v[208:209], v[162:163]
v_pk_fma_f32 v[210:211], v[162:163], v[162:163], v[210:211]
v_pk_add_f32 v[208:209], v[208:209], v[164:165]
v_pk_fma_f32 v[210:211], v[164:165], v[164:165], v[210:211]
v_pk_add_f32 v[208:209], v[208:209], v[166:167]
v_pk_fma_f32 v[210:211], v[166:167], v[166:167], v[210:211]
v_pk_add_f32 v[208:209], v[208:209], v[168:169]
v_pk_fma_f32 v[210:211], v[168:169], v[168:169], v[210:211]
v_pk_add_f32 v[208:209], v[208:209], v[170:171]
v_pk_fma_f32 v[210:211], v[170:171], v[170:171], v[210:211]
v_pk_add_f32 v[208:209], v[208:209], v[172:173]
v_pk_fma_f32 v[210:211], v[172:173], v[172:173], v[210:211]
v_pk_add_f32 v[208:209], v[208:209], v[174:175]
v_pk_fma_f32 v[210:211], v[174:175], v[174:175], v[210:211]
v_pk_add_f32 v[208:209], v[208:209], v[176:177]
v_pk_fma_f32 v[210:211], v[176:177], v[176:177], v[210:211]
v_pk_add_f32 v[208:209], v[208:209], v[178:179]
v_pk_fma_f32 v[210:211], v[178:179], v[178:179], v[210:211]
v_pk_add_f32 v[208:209], v[208:209], v[180:181]
v_pk_fma_f32 v[210:211], v[180:181], v[180:181], v[210:211]
v_pk_add_f32 v[208:209], v[208:209], v[182:183]
v_pk_fma_f32 v[210:211], v[182:183], v[182:183], v[210:211]
v_pk_add_f32 v[208:209], v[208:209], v[184:185]
v_pk_fma_f32 v[210:211], v[184:185], v[184:185], v[210:211]
v_pk_add_f32 v[208:209], v[208:209], v[186:187]
v_pk_fma_f32 v[210:211], v[186:187], v[186:187], v[210:211]
v_pk_add_f32 v[208:209], v[208:209], v[188:189]
v_pk_fma_f32 v[210:211], v[188:189], v[188:189], v[210:211]
v_pk_add_f32 v[208:209], v[208:209], v[190:191]
v_pk_fma_f32 v[210:211], v[190:191], v[190:191], v[210:211]
v_pk_add_f32 v[208:209], v[208:209], v[192:193]
v_pk_fma_f32 v[210:211], v[192:193], v[192:193], v[210:211]
v_pk_add_f32 v[208:209], v[208:209], v[194:195]
v_pk_fma_f32 v[210:211], v[194:195], v[194:195], v[210:211]
v_pk_add_f32 v[208:209], v[208:209], v[196:197]
v_pk_fma_f32 v[210:211], v[196:197], v[196:197], v[210:211]
v_pk_add_f32 v[208:209], v[208:209], v[198:199]
v_pk_fma_f32 v[210:211], v[198:199], v[198:199], v[210:211]
v_pk_add_f32 v[208:209], v[208:209], v[200:201]
v_pk_fma_f32 v[210:211], v[200:201], v[200:201], v[210:211]
v_pk_add_f32 v[208:209], v[208:209], v[202:203]
v_pk_fma_f32 v[210:211], v[202:203], v[202:203], v[210:211]
v_pk_add_f32 v[208:209], v[208:209], v[204:205]
v_pk_fma_f32 v[210:211], v[204:205], v[204:205], v[210:211]
v_pk_add_f32 v[208:209], v[208:209], v[206:207]
v_pk_fma_f32 v[210:211], v[206:207], v[206:207], v[210:211]
v_add_f32 v208, v208, v209
v_add_f32 v209, v210, v211
v_mov_b32 v210, v208
v_mov_b32 v211, v209
s_nop 0
v_permlane32_swap_b32 v208, v210
v_permlane32_swap_b32 v209, v211
v_add_f32 v208, v208, v210
v_add_f32 v209, v209, v211
ds_write_b64 v28, v[208:209]
s_waitcnt lgkmcnt(0)
s_barrier
ds_read_b64 v[208:209], v27
ds_read_b64 v[210:211], v27 offset:256
ds_read_b64 v[212:213], v27 offset:512
ds_read_b64 v[214:215], v27 offset:768
s_waitcnt lgkmcnt(0)
v_pk_add_f32 v[208:209], v[208:209], v[210:211]
v_pk_add_f32 v[212:213], v[212:213], v[214:215]
v_pk_add_f32 v[208:209], v[208:209], v[212:213]
v_mul_f32 v208, 0x3b124925, v208
v_mul_f32 v209, 0x3b124925, v209
v_fma_f32 v209, -v208, v208, v209
v_max_f32 v209, 0, v209
v_add_f32 v209, 0x3727c5ac, v209
v_rsq_f32 v209, v209
s_nop 0
v_mul_f32 v208, v208, v209
v_mov_b32 v210, v209
v_mov_b32 v211, v208
v_pk_fma_f32 v[152:153], v[152:153], v[210:211], v[210:211] op_sel:[0,0,1] op_sel_hi:[1,0,1] neg_lo:[0,0,1] neg_hi:[0,0,1]
v_pk_fma_f32 v[154:155], v[154:155], v[210:211], v[210:211] op_sel:[0,0,1] op_sel_hi:[1,0,1] neg_lo:[0,0,1] neg_hi:[0,0,1]
v_pk_fma_f32 v[156:157], v[156:157], v[210:211], v[210:211] op_sel:[0,0,1] op_sel_hi:[1,0,1] neg_lo:[0,0,1] neg_hi:[0,0,1]
v_pk_fma_f32 v[158:159], v[158:159], v[210:211], v[210:211] op_sel:[0,0,1] op_sel_hi:[1,0,1] neg_lo:[0,0,1] neg_hi:[0,0,1]
v_pk_fma_f32 v[160:161], v[160:161], v[210:211], v[210:211] op_sel:[0,0,1] op_sel_hi:[1,0,1] neg_lo:[0,0,1] neg_hi:[0,0,1]
v_pk_fma_f32 v[162:163], v[162:163], v[210:211], v[210:211] op_sel:[0,0,1] op_sel_hi:[1,0,1] neg_lo:[0,0,1] neg_hi:[0,0,1]
v_pk_fma_f32 v[164:165], v[164:165], v[210:211], v[210:211] op_sel:[0,0,1] op_sel_hi:[1,0,1] neg_lo:[0,0,1] neg_hi:[0,0,1]
v_pk_fma_f32 v[166:167], v[166:167], v[210:211], v[210:211] op_sel:[0,0,1] op_sel_hi:[1,0,1] neg_lo:[0,0,1] neg_hi:[0,0,1]
v_pk_fma_f32 v[168:169], v[168:169], v[210:211], v[210:211] op_sel:[0,0,1] op_sel_hi:[1,0,1] neg_lo:[0,0,1] neg_hi:[0,0,1]
v_pk_fma_f32 v[170:171], v[170:171], v[210:211], v[210:211] op_sel:[0,0,1] op_sel_hi:[1,0,1] neg_lo:[0,0,1] neg_hi:[0,0,1]
v_pk_fma_f32 v[172:173], v[172:173], v[210:211], v[210:211] op_sel:[0,0,1] op_sel_hi:[1,0,1] neg_lo:[0,0,1] neg_hi:[0,0,1]
v_pk_fma_f32 v[174:175], v[174:175], v[210:211], v[210:211] op_sel:[0,0,1] op_sel_hi:[1,0,1] neg_lo:[0,0,1] neg_hi:[0,0,1]
v_pk_fma_f32 v[176:177], v[176:177], v[210:211], v[210:211] op_sel:[0,0,1] op_sel_hi:[1,0,1] neg_lo:[0,0,1] neg_hi:[0,0,1]
v_pk_fma_f32 v[178:179], v[178:179], v[210:211], v[210:211] op_sel:[0,0,1] op_sel_hi:[1,0,1] neg_lo:[0,0,1] neg_hi:[0,0,1]
v_pk_fma_f32 v[180:181], v[180:181], v[210:211], v[210:211] op_sel:[0,0,1] op_sel_hi:[1,0,1] neg_lo:[0,0,1] neg_hi:[0,0,1]
v_pk_fma_f32 v[182:183], v[182:183], v[210:211], v[210:211] op_sel:[0,0,1] op_sel_hi:[1,0,1] neg_lo:[0,0,1] neg_hi:[0,0,1]
v_pk_fma_f32 v[184:185], v[184:185], v[210:211], v[210:211] op_sel:[0,0,1] op_sel_hi:[1,0,1] neg_lo:[0,0,1] neg_hi:[0,0,1]
v_pk_fma_f32 v[186:187], v[186:187], v[210:211], v[210:211] op_sel:[0,0,1] op_sel_hi:[1,0,1] neg_lo:[0,0,1] neg_hi:[0,0,1]
v_pk_fma_f32 v[188:189], v[188:189], v[210:211], v[210:211] op_sel:[0,0,1] op_sel_hi:[1,0,1] neg_lo:[0,0,1] neg_hi:[0,0,1]
v_pk_fma_f32 v[190:191], v[190:191], v[210:211], v[210:211] op_sel:[0,0,1] op_sel_hi:[1,0,1] neg_lo:[0,0,1] neg_hi:[0,0,1]
v_pk_fma_f32 v[192:193], v[192:193], v[210:211], v[210:211] op_sel:[0,0,1] op_sel_hi:[1,0,1] neg_lo:[0,0,1] neg_hi:[0,0,1]
v_pk_fma_f32 v[194:195], v[194:195], v[210:211], v[210:211] op_sel:[0,0,1] op_sel_hi:[1,0,1] neg_lo:[0,0,1] neg_hi:[0,0,1]
v_pk_fma_f32 v[196:197], v[196:197], v[210:211], v[210:211] op_sel:[0,0,1] op_sel_hi:[1,0,1] neg_lo:[0,0,1] neg_hi:[0,0,1]
v_pk_fma_f32 v[198:199], v[198:199], v[210:211], v[210:211] op_sel:[0,0,1] op_sel_hi:[1,0,1] neg_lo:[0,0,1] neg_hi:[0,0,1]
v_pk_fma_f32 v[200:201], v[200:201], v[210:211], v[210:211] op_sel:[0,0,1] op_sel_hi:[1,0,1] neg_lo:[0,0,1] neg_hi:[0,0,1]
v_pk_fma_f32 v[202:203], v[202:203], v[210:211], v[210:211] op_sel:[0,0,1] op_sel_hi:[1,0,1] neg_lo:[0,0,1] neg_hi:[0,0,1]
v_pk_fma_f32 v[204:205], v[204:205], v[210:211], v[210:211] op_sel:[0,0,1] op_sel_hi:[1,0,1] neg_lo:[0,0,1] neg_hi:[0,0,1]
v_pk_fma_f32 v[206:207], v[206:207], v[210:211], v[210:211] op_sel:[0,0,1] op_sel_hi:[1,0,1] neg_lo:[0,0,1] neg_hi:[0,0,1]
v_cvt_pk_bf16_f32 v88, v152, v153
v_cvt_pk_bf16_f32 v89, v154, v155
v_cvt_pk_bf16_f32 v90, v156, v157
v_cvt_pk_bf16_f32 v91, v158, v159
v_cvt_pk_bf16_f32 v92, v160, v161
v_cvt_pk_bf16_f32 v93, v162, v163
v_cvt_pk_bf16_f32 v94, v164, v165
v_cvt_pk_bf16_f32 v95, v166, v167
v_cvt_pk_bf16_f32 v96, v168, v169
v_cvt_pk_bf16_f32 v97, v170, v171
v_cvt_pk_bf16_f32 v98, v172, v173
v_cvt_pk_bf16_f32 v99, v174, v175
v_cvt_pk_bf16_f32 v100, v176, v177
v_cvt_pk_bf16_f32 v101, v178, v179
v_cvt_pk_bf16_f32 v102, v180, v181
v_cvt_pk_bf16_f32 v103, v182, v183
v_cvt_pk_bf16_f32 v104, v184, v185
v_cvt_pk_bf16_f32 v105, v186, v187
v_cvt_pk_bf16_f32 v106, v188, v189
v_cvt_pk_bf16_f32 v107, v190, v191
v_cvt_pk_bf16_f32 v108, v192, v193
v_cvt_pk_bf16_f32 v109, v194, v195
v_cvt_pk_bf16_f32 v110, v196, v197
v_cvt_pk_bf16_f32 v111, v198, v199
v_cvt_pk_bf16_f32 v112, v200, v201
v_cvt_pk_bf16_f32 v113, v202, v203
v_cvt_pk_bf16_f32 v114, v204, v205
v_cvt_pk_bf16_f32 v115, v206, v207
s_add_u32 s33, s38, 0
buffer_store_dwordx4 v[88:91], v26, s[4:7], s33 offen
s_add_u32 s33, s38, 4096
buffer_store_dwordx4 v[92:95], v26, s[4:7], s33 offen
s_add_u32 s33, s38, 8192
buffer_store_dwordx4 v[96:99], v26, s[4:7], s33 offen
s_add_u32 s33, s38, 12288
buffer_store_dwordx4 v[100:103], v26, s[4:7], s33 offen
s_add_u32 s33, s38, 16384
buffer_store_dwordx4 v[104:107], v26, s[4:7], s33 offen
s_add_u32 s33, s38, 20480
buffer_store_dwordx4 v[108:111], v26, s[4:7], s33 offen
s_add_u32 s33, s38, 24576
buffer_store_dwordx4 v[112:115], v26, s[4:7], s33 offen
s_barrier
s_add_u32 s33, s30, 3
s_mul_i32 s36, s33, 28672
s_add_u32 s37, s36, 22028288
s_add_u32 s38, s36, 14688256
s_add_u32 s33, s37, 0
buffer_store_dwordx4 v[116:119], v26, s[4:7], s33 offen
s_add_u32 s33, s37, 4096
buffer_store_dwordx4 v[120:123], v26, s[4:7], s33 offen
s_add_u32 s33, s37, 8192
buffer_store_dwordx4 v[124:127], v26, s[4:7], s33 offen
s_add_u32 s33, s37, 12288
buffer_store_dwordx4 v[128:131], v26, s[4:7], s33 offen
s_add_u32 s33, s37, 16384
buffer_store_dwordx4 v[132:135], v26, s[4:7], s33 offen
s_add_u32 s33, s37, 20480
buffer_store_dwordx4 v[136:139], v26, s[4:7], s33 offen
s_add_u32 s33, s37, 24576
buffer_store_dwordx4 v[140:143], v26, s[4:7], s33 offen
v_lshlrev_b32 v152, 16, v116
v_and_b32 v153, 0xffff0000, v116
v_lshlrev_b32 v154, 16, v117
v_and_b32 v155, 0xffff0000, v117
v_lshlrev_b32 v156, 16, v118
v_and_b32 v157, 0xffff0000, v118
v_lshlrev_b32 v158, 16, v119
v_and_b32 v159, 0xffff0000, v119
v_lshlrev_b32 v160, 16, v120
v_and_b32 v161, 0xffff0000, v120
v_lshlrev_b32 v162, 16, v121
v_and_b32 v163, 0xffff0000, v121
v_lshlrev_b32 v164, 16, v122
v_and_b32 v165, 0xffff0000, v122
v_lshlrev_b32 v166, 16, v123
v_and_b32 v167, 0xffff0000, v123
v_lshlrev_b32 v168, 16, v124
v_and_b32 v169, 0xffff0000, v124
v_lshlrev_b32 v170, 16, v125
v_and_b32 v171, 0xffff0000, v125
v_lshlrev_b32 v172, 16, v126
v_and_b32 v173, 0xffff0000, v126
v_lshlrev_b32 v174, 16, v127
v_and_b32 v175, 0xffff0000, v127
v_lshlrev_b32 v176, 16, v128
v_and_b32 v177, 0xffff0000, v128
v_lshlrev_b32 v178, 16, v129
v_and_b32 v179, 0xffff0000, v129
v_lshlrev_b32 v180, 16, v130
v_and_b32 v181, 0xffff0000, v130
v_lshlrev_b32 v182, 16, v131
v_and_b32 v183, 0xffff0000, v131
v_lshlrev_b32 v184, 16, v132
v_and_b32 v185, 0xffff0000, v132
v_lshlrev_b32 v186, 16, v133
v_and_b32 v187, 0xffff0000, v133
v_lshlrev_b32 v188, 16, v134
v_and_b32 v189, 0xffff0000, v134
v_lshlrev_b32 v190, 16, v135
v_and_b32 v191, 0xffff0000, v135
v_lshlrev_b32 v192, 16, v136
v_and_b32 v193, 0xffff0000, v136
v_lshlrev_b32 v194, 16, v137
v_and_b32 v195, 0xffff0000, v137
v_lshlrev_b32 v196, 16, v138
v_and_b32 v197, 0xffff0000, v138
v_lshlrev_b32 v198, 16, v139
v_and_b32 v199, 0xffff0000, v139
v_lshlrev_b32 v200, 16, v140
v_and_b32 v201, 0xffff0000, v140
v_lshlrev_b32 v202, 16, v141
v_and_b32 v203, 0xffff0000, v141
v_lshlrev_b32 v204, 16, v142
v_and_b32 v205, 0xffff0000, v142
v_lshlrev_b32 v206, 16, v143
v_and_b32 v207, 0xffff0000, v143
v_pk_add_f32 v[208:209], v[152:153], v[154:155]
v_pk_mul_f32 v[210:211], v[152:153], v[152:153]
v_pk_fma_f32 v[210:211], v[154:155], v[154:155], v[210:211]
v_pk_add_f32 v[208:209], v[208:209], v[156:157]
v_pk_fma_f32 v[210:211], v[156:157], v[156:157], v[210:211]
v_pk_add_f32 v[208:209], v[208:209], v[158:159]
v_pk_fma_f32 v[210:211], v[158:159], v[158:159], v[210:211]
v_pk_add_f32 v[208:209], v[208:209], v[160:161]
v_pk_fma_f32 v[210:211], v[160:161], v[160:161], v[210:211]
v_pk_add_f32 v[208:209], v[208:209], v[162:163]
v_pk_fma_f32 v[210:211], v[162:163], v[162:163], v[210:211]
v_pk_add_f32 v[208:209], v[208:209], v[164:165]
v_pk_fma_f32 v[210:211], v[164:165], v[164:165], v[210:211]
v_pk_add_f32 v[208:209], v[208:209], v[166:167]
v_pk_fma_f32 v[210:211], v[166:167], v[166:167], v[210:211]
v_pk_add_f32 v[208:209], v[208:209], v[168:169]
v_pk_fma_f32 v[210:211], v[168:169], v[168:169], v[210:211]
v_pk_add_f32 v[208:209], v[208:209], v[170:171]
v_pk_fma_f32 v[210:211], v[170:171], v[170:171], v[210:211]
v_pk_add_f32 v[208:209], v[208:209], v[172:173]
v_pk_fma_f32 v[210:211], v[172:173], v[172:173], v[210:211]
v_pk_add_f32 v[208:209], v[208:209], v[174:175]
v_pk_fma_f32 v[210:211], v[174:175], v[174:175], v[210:211]
v_pk_add_f32 v[208:209], v[208:209], v[176:177]
v_pk_fma_f32 v[210:211], v[176:177], v[176:177], v[210:211]
v_pk_add_f32 v[208:209], v[208:209], v[178:179]
v_pk_fma_f32 v[210:211], v[178:179], v[178:179], v[210:211]
v_pk_add_f32 v[208:209], v[208:209], v[180:181]
v_pk_fma_f32 v[210:211], v[180:181], v[180:181], v[210:211]
v_pk_add_f32 v[208:209], v[208:209], v[182:183]
v_pk_fma_f32 v[210:211], v[182:183], v[182:183], v[210:211]
v_pk_add_f32 v[208:209], v[208:209], v[184:185]
v_pk_fma_f32 v[210:211], v[184:185], v[184:185], v[210:211]
v_pk_add_f32 v[208:209], v[208:209], v[186:187]
v_pk_fma_f32 v[210:211], v[186:187], v[186:187], v[210:211]
v_pk_add_f32 v[208:209], v[208:209], v[188:189]
v_pk_fma_f32 v[210:211], v[188:189], v[188:189], v[210:211]
v_pk_add_f32 v[208:209], v[208:209], v[190:191]
v_pk_fma_f32 v[210:211], v[190:191], v[190:191], v[210:211]
v_pk_add_f32 v[208:209], v[208:209], v[192:193]
v_pk_fma_f32 v[210:211], v[192:193], v[192:193], v[210:211]
v_pk_add_f32 v[208:209], v[208:209], v[194:195]
v_pk_fma_f32 v[210:211], v[194:195], v[194:195], v[210:211]
v_pk_add_f32 v[208:209], v[208:209], v[196:197]
v_pk_fma_f32 v[210:211], v[196:197], v[196:197], v[210:211]
v_pk_add_f32 v[208:209], v[208:209], v[198:199]
v_pk_fma_f32 v[210:211], v[198:199], v[198:199], v[210:211]
v_pk_add_f32 v[208:209], v[208:209], v[200:201]
v_pk_fma_f32 v[210:211], v[200:201], v[200:201], v[210:211]
v_pk_add_f32 v[208:209], v[208:209], v[202:203]
v_pk_fma_f32 v[210:211], v[202:203], v[202:203], v[210:211]
v_pk_add_f32 v[208:209], v[208:209], v[204:205]
v_pk_fma_f32 v[210:211], v[204:205], v[204:205], v[210:211]
v_pk_add_f32 v[208:209], v[208:209], v[206:207]
v_pk_fma_f32 v[210:211], v[206:207], v[206:207], v[210:211]
v_add_f32 v208, v208, v209
v_add_f32 v209, v210, v211
v_mov_b32 v210, v208
v_mov_b32 v211, v209
s_nop 0
v_permlane32_swap_b32 v208, v210
v_permlane32_swap_b32 v209, v211
v_add_f32 v208, v208, v210
v_add_f32 v209, v209, v211
ds_write_b64 v28, v[208:209]
s_waitcnt lgkmcnt(0)
s_barrier
ds_read_b64 v[208:209], v27
ds_read_b64 v[210:211], v27 offset:256
ds_read_b64 v[212:213], v27 offset:512
ds_read_b64 v[214:215], v27 offset:768
s_waitcnt lgkmcnt(0)
v_pk_add_f32 v[208:209], v[208:209], v[210:211]
v_pk_add_f32 v[212:213], v[212:213], v[214:215]
v_pk_add_f32 v[208:209], v[208:209], v[212:213]
v_mul_f32 v208, 0x3b124925, v208
v_mul_f32 v209, 0x3b124925, v209
v_fma_f32 v209, -v208, v208, v209
v_max_f32 v209, 0, v209
v_add_f32 v209, 0x3727c5ac, v209
v_rsq_f32 v209, v209
s_nop 0
v_mul_f32 v208, v208, v209
v_mov_b32 v210, v209
v_mov_b32 v211, v208
v_pk_fma_f32 v[152:153], v[152:153], v[210:211], v[210:211] op_sel:[0,0,1] op_sel_hi:[1,0,1] neg_lo:[0,0,1] neg_hi:[0,0,1]
v_pk_fma_f32 v[154:155], v[154:155], v[210:211], v[210:211] op_sel:[0,0,1] op_sel_hi:[1,0,1] neg_lo:[0,0,1] neg_hi:[0,0,1]
v_pk_fma_f32 v[156:157], v[156:157], v[210:211], v[210:211] op_sel:[0,0,1] op_sel_hi:[1,0,1] neg_lo:[0,0,1] neg_hi:[0,0,1]
v_pk_fma_f32 v[158:159], v[158:159], v[210:211], v[210:211] op_sel:[0,0,1] op_sel_hi:[1,0,1] neg_lo:[0,0,1] neg_hi:[0,0,1]
v_pk_fma_f32 v[160:161], v[160:161], v[210:211], v[210:211] op_sel:[0,0,1] op_sel_hi:[1,0,1] neg_lo:[0,0,1] neg_hi:[0,0,1]
v_pk_fma_f32 v[162:163], v[162:163], v[210:211], v[210:211] op_sel:[0,0,1] op_sel_hi:[1,0,1] neg_lo:[0,0,1] neg_hi:[0,0,1]
v_pk_fma_f32 v[164:165], v[164:165], v[210:211], v[210:211] op_sel:[0,0,1] op_sel_hi:[1,0,1] neg_lo:[0,0,1] neg_hi:[0,0,1]
v_pk_fma_f32 v[166:167], v[166:167], v[210:211], v[210:211] op_sel:[0,0,1] op_sel_hi:[1,0,1] neg_lo:[0,0,1] neg_hi:[0,0,1]
v_pk_fma_f32 v[168:169], v[168:169], v[210:211], v[210:211] op_sel:[0,0,1] op_sel_hi:[1,0,1] neg_lo:[0,0,1] neg_hi:[0,0,1]
v_pk_fma_f32 v[170:171], v[170:171], v[210:211], v[210:211] op_sel:[0,0,1] op_sel_hi:[1,0,1] neg_lo:[0,0,1] neg_hi:[0,0,1]
v_pk_fma_f32 v[172:173], v[172:173], v[210:211], v[210:211] op_sel:[0,0,1] op_sel_hi:[1,0,1] neg_lo:[0,0,1] neg_hi:[0,0,1]
v_pk_fma_f32 v[174:175], v[174:175], v[210:211], v[210:211] op_sel:[0,0,1] op_sel_hi:[1,0,1] neg_lo:[0,0,1] neg_hi:[0,0,1]
v_pk_fma_f32 v[176:177], v[176:177], v[210:211], v[210:211] op_sel:[0,0,1] op_sel_hi:[1,0,1] neg_lo:[0,0,1] neg_hi:[0,0,1]
v_pk_fma_f32 v[178:179], v[178:179], v[210:211], v[210:211] op_sel:[0,0,1] op_sel_hi:[1,0,1] neg_lo:[0,0,1] neg_hi:[0,0,1]
v_pk_fma_f32 v[180:181], v[180:181], v[210:211], v[210:211] op_sel:[0,0,1] op_sel_hi:[1,0,1] neg_lo:[0,0,1] neg_hi:[0,0,1]
v_pk_fma_f32 v[182:183], v[182:183], v[210:211], v[210:211] op_sel:[0,0,1] op_sel_hi:[1,0,1] neg_lo:[0,0,1] neg_hi:[0,0,1]
v_pk_fma_f32 v[184:185], v[184:185], v[210:211], v[210:211] op_sel:[0,0,1] op_sel_hi:[1,0,1] neg_lo:[0,0,1] neg_hi:[0,0,1]
v_pk_fma_f32 v[186:187], v[186:187], v[210:211], v[210:211] op_sel:[0,0,1] op_sel_hi:[1,0,1] neg_lo:[0,0,1] neg_hi:[0,0,1]
v_pk_fma_f32 v[188:189], v[188:189], v[210:211], v[210:211] op_sel:[0,0,1] op_sel_hi:[1,0,1] neg_lo:[0,0,1] neg_hi:[0,0,1]
v_pk_fma_f32 v[190:191], v[190:191], v[210:211], v[210:211] op_sel:[0,0,1] op_sel_hi:[1,0,1] neg_lo:[0,0,1] neg_hi:[0,0,1]
v_pk_fma_f32 v[192:193], v[192:193], v[210:211], v[210:211] op_sel:[0,0,1] op_sel_hi:[1,0,1] neg_lo:[0,0,1] neg_hi:[0,0,1]
v_pk_fma_f32 v[194:195], v[194:195], v[210:211], v[210:211] op_sel:[0,0,1] op_sel_hi:[1,0,1] neg_lo:[0,0,1] neg_hi:[0,0,1]
v_pk_fma_f32 v[196:197], v[196:197], v[210:211], v[210:211] op_sel:[0,0,1] op_sel_hi:[1,0,1] neg_lo:[0,0,1] neg_hi:[0,0,1]
v_pk_fma_f32 v[198:199], v[198:199], v[210:211], v[210:211] op_sel:[0,0,1] op_sel_hi:[1,0,1] neg_lo:[0,0,1] neg_hi:[0,0,1]
v_pk_fma_f32 v[200:201], v[200:201], v[210:211], v[210:211] op_sel:[0,0,1] op_sel_hi:[1,0,1] neg_lo:[0,0,1] neg_hi:[0,0,1]
v_pk_fma_f32 v[202:203], v[202:203], v[210:211], v[210:211] op_sel:[0,0,1] op_sel_hi:[1,0,1] neg_lo:[0,0,1] neg_hi:[0,0,1]
v_pk_fma_f32 v[204:205], v[204:205], v[210:211], v[210:211] op_sel:[0,0,1] op_sel_hi:[1,0,1] neg_lo:[0,0,1] neg_hi:[0,0,1]
v_pk_fma_f32 v[206:207], v[206:207], v[210:211], v[210:211] op_sel:[0,0,1] op_sel_hi:[1,0,1] neg_lo:[0,0,1] neg_hi:[0,0,1]
v_cvt_pk_bf16_f32 v116, v152, v153
v_cvt_pk_bf16_f32 v117, v154, v155
v_cvt_pk_bf16_f32 v118, v156, v157
v_cvt_pk_bf16_f32 v119, v158, v159
v_cvt_pk_bf16_f32 v120, v160, v161
v_cvt_pk_bf16_f32 v121, v162, v163
v_cvt_pk_bf16_f32 v122, v164, v165
v_cvt_pk_bf16_f32 v123, v166, v167
v_cvt_pk_bf16_f32 v124, v168, v169
v_cvt_pk_bf16_f32 v125, v170, v171
v_cvt_pk_bf16_f32 v126, v172, v173
v_cvt_pk_bf16_f32 v127, v174, v175
v_cvt_pk_bf16_f32 v128, v176, v177
v_cvt_pk_bf16_f32 v129, v178, v179
v_cvt_pk_bf16_f32 v130, v180, v181
v_cvt_pk_bf16_f32 v131, v182, v183
v_cvt_pk_bf16_f32 v132, v184, v185
v_cvt_pk_bf16_f32 v133, v186, v187
v_cvt_pk_bf16_f32 v134, v188, v189
v_cvt_pk_bf16_f32 v135, v190, v191
v_cvt_pk_bf16_f32 v136, v192, v193
v_cvt_pk_bf16_f32 v137, v194, v195
v_cvt_pk_bf16_f32 v138, v196, v197
v_cvt_pk_bf16_f32 v139, v198, v199
v_cvt_pk_bf16_f32 v140, v200, v201
v_cvt_pk_bf16_f32 v141, v202, v203
v_cvt_pk_bf16_f32 v142, v204, v205
v_cvt_pk_bf16_f32 v143, v206, v207
s_add_u32 s33, s38, 0
buffer_store_dwordx4 v[116:119], v26, s[4:7], s33 offen
s_add_u32 s33, s38, 4096
buffer_store_dwordx4 v[120:123], v26, s[4:7], s33 offen
s_add_u32 s33, s38, 8192
buffer_store_dwordx4 v[124:127], v26, s[4:7], s33 offen
s_add_u32 s33, s38, 12288
buffer_store_dwordx4 v[128:131], v26, s[4:7], s33 offen
s_add_u32 s33, s38, 16384
buffer_store_dwordx4 v[132:135], v26, s[4:7], s33 offen
s_add_u32 s33, s38, 20480
buffer_store_dwordx4 v[136:139], v26, s[4:7], s33 offen
s_add_u32 s33, s38, 24576
buffer_store_dwordx4 v[140:143], v26, s[4:7], s33 offen
s_barrier
PREP_TAIL:
s_waitcnt vmcnt(0)
v_and_b32 v16, 63, v0
v_lshlrev_b32 v2, 4, v16
v_and_b32 v17, 31, v16
v_cmp_gt_u32 s[42:43], 28, v17
v_cmp_eq_u32 s[44:45], 28, v17
s_cmp_eq_u32 s72, -1
s_cbranch_scc1 PT_E0
v_lshl_or_b32 v32, v225, 16, v224
v_lshl_or_b32 v33, v227, 16, v226
v_lshl_or_b32 v34, v229, 16, v228
v_lshl_or_b32 v35, v231, 16, v230
s_cmp_eq_u32 s74, 7
s_cbranch_scc1 PT_S0
v_cndmask_b32 v32, 0, v32, s[42:43]
v_cndmask_b32 v33, 0, v33, s[42:43]
v_cndmask_b32 v34, 0, v34, s[42:43]
v_cndmask_b32 v35, 0, v35, s[42:43]
v_mov_b32 v36, 0
v_cndmask_b32 v32, v32, v36, s[44:45]
v_cndmask_b32 v33, v33, v36, s[44:45]
v_cndmask_b32 v34, v34, v36, s[44:45]
v_cndmask_b32 v35, v35, v36, s[44:45]
PT_S0:
buffer_store_dwordx4 v[32:35], v2, s[4:7], s72 offen
s_nop 1
PT_E0:
s_cmp_eq_u32 s73, -1
s_cbranch_scc1 PT_E1
v_lshl_or_b32 v32, v233, 16, v232
v_lshl_or_b32 v33, v235, 16, v234
v_lshl_or_b32 v34, v237, 16, v236
v_lshl_or_b32 v35, v239, 16, v238
s_cmp_eq_u32 s75, 7
s_cbranch_scc1 PT_S1
v_cndmask_b32 v32, 0, v32, s[42:43]
v_cndmask_b32 v33, 0, v33, s[42:43]
v_cndmask_b32 v34, 0, v34, s[42:43]
v_cndmask_b32 v35, 0, v35, s[42:43]
v_mov_b32 v36, 0
v_cndmask_b32 v32, v32, v36, s[44:45]
v_cndmask_b32 v33, v33, v36, s[44:45]
v_cndmask_b32 v34, v34, v36, s[44:45]
v_cndmask_b32 v35, v35, v36, s[44:45]
PT_S1:
buffer_store_dwordx4 v[32:35], v2, s[4:7], s73 offen
s_nop 1
PT_E1:
s_waitcnt vmcnt(0)
PREP_END:
s_endpgm
.globl interleave_layers__memory_aug_recurrent_mem_tr__sliding_block__prompt_kernel
.p2align 8
.type interleave_layers__memory_aug_recurrent_mem_tr__sliding_block__prompt_kernel,@function
interleave_layers__memory_aug_recurrent_mem_tr__sliding_block__prompt_kernel:
s_mov_b32 s70, 0
MAIN:
s_cmp_ge_u32 s2, 256
s_cbranch_scc1 L_END
s_load_dwordx2 s[4:5], s[0:1], 96
s_load_dwordx2 s[8:9], s[0:1], 88
s_load_dwordx2 s[12:13], s[0:1], 80
s_getreg_b32 s16, hwreg(HW_REG_XCC_ID, 0, 4)
v_lshrrev_b32 v1, 6, v0
s_mov_b32 s40, 0
v_readfirstlane_b32 s18, v1
s_waitcnt lgkmcnt(0)
s_and_b32 s5, s5, 0xffff
s_mov_b32 s6, 268435456
s_mov_b32 s7, 0x20000
s_and_b32 s9, s9, 0xffff
s_mov_b32 s10, 256
s_mov_b32 s11, 0x20000
s_and_b32 s13, s13, 0xffff
s_mov_b32 s14, 1835008
s_mov_b32 s15, 0x20000
v_cmp_eq_u32 vcc, 0, v0
s_lshl_b32 s46, s16, 2
v_mov_b32 v1, 1
v_mov_b32 v2, s46
v_mov_b32 v3, 0
s_and_saveexec_b64 s[42:43], vcc
s_cbranch_execz TK_1
buffer_atomic_add v1, v2, s[8:11], 0 offen sc0
s_waitcnt vmcnt(0)
ds_write_b32 v3, v1
s_waitcnt lgkmcnt(0)
TK_1:
s_mov_b64 exec, s[42:43]
s_barrier
ds_read_b32 v1, v3
s_waitcnt lgkmcnt(0)
v_readfirstlane_b32 s17, v1
s_barrier
s_cmp_ge_u32 s17, 32
s_cbranch_scc1 L_END
s_cmp_ge_u32 s16, 4
s_cbranch_scc1 D_PROJ
s_lshr_b32 s19, s16, 1
s_bitcmp1_b32 s16, 0
s_cbranch_scc1 D_B
s_mul_i32 s46, s19, 3
s_add_u32 s46, s46, 2
s_cmp_eq_u32 s70, 0
s_cbranch_scc1 D_REC
s_cmp_eq_u32 s70, s46
s_cbranch_scc0 L_END
D_REC:
s_cmp_eq_u32 s19, 0
s_cbranch_scc1 D_REC2
D_REC2:
s_and_b32 s20, s17, 15
s_cmp_lt_u32 s17, 16
s_cbranch_scc1 D_RP
s_branch RV_START
D_RP:
s_branch RP_START
D_B:
s_mul_i32 s46, s19, 3
s_add_u32 s46, s46, 3
s_cmp_eq_u32 s70, 0
s_cbranch_scc1 D_B2
s_cmp_eq_u32 s70, s46
s_cbranch_scc0 L_END
D_B2:
s_cmp_eq_u32 s19, 0
s_cbranch_scc1 D_B0
s_branch D_B3
D_B0:
s_cmp_lt_u32 s17, 16
s_cbranch_scc1 D_B3
s_cmp_lt_u32 s17, 23
s_cbranch_scc1 D_BW
s_cmp_lt_u32 s17, 27
s_cbranch_scc1 D_B3
D_BW:
D_B3:
s_mov_b32 s20, s17
s_cmp_lt_u32 s17, 16
s_cbranch_scc1 BH_START
s_sub_u32 s20, s17, 16
s_cmp_lt_u32 s17, 23
s_cbranch_scc1 WO_START
s_sub_u32 s20, s17, 23
s_cmp_lt_u32 s17, 27
s_cbranch_scc1 STA_START
s_sub_u32 s20, s17, 27
s_cmp_ge_u32 s17, 31
s_cbranch_scc1 L_END
s_cmp_eq_u32 s19, 0
s_cbranch_scc1 LNO_START
s_branch L_END
D_PROJ:
s_sub_u32 s20, s16, 4
s_lshl_b32 s20, s20, 5
s_add_u32 s20, s20, s17
s_cmp_ge_u32 s20, 112
s_cbranch_scc1 L_END
s_mov_b32 s19, 0
s_cmp_eq_u32 s70, 0
s_cbranch_scc1 PJ_START
s_cmp_eq_u32 s70, 1
s_cbranch_scc1 PJ_START
s_mov_b32 s19, 1
s_cmp_eq_u32 s70, 4
s_cbranch_scc1 PJ_START
s_branch L_END
PJ_START:
v_and_b32 v16, 63, v0
v_and_b32 v17, 31, v16
v_lshrrev_b32 v18, 5, v16
v_and_b32 v19, 15, v16
v_bfe_u32 v20, v16, 4, 1
v_lshlrev_b32 v0, 4, v16
s_lshl_b32 s32, s20, 3
s_lshl_b32 s33, s18, 1
s_add_u32 s32, s32, s33
s_mul_i32 s33, s32, 14336
s_add_u32 s33, s33, 65536
v_mul_u32_u24 v21, 14336, v20
v_lshl_add_u32 v21, v18, 8, v21
v_lshl_add_u32 v21, v19, 4, v21
s_add_u32 s34, s33, 0
buffer_load_dwordx4 a[0:3], v21, s[4:7], s34 offen
buffer_load_dwordx4 a[4:7], v21, s[4:7], s34 offen offset:512
buffer_load_dwordx4 a[8:11], v21, s[4:7], s34 offen offset:1024
buffer_load_dwordx4 a[12:15], v21, s[4:7], s34 offen offset:1536
buffer_load_dwordx4 a[16:19], v21, s[4:7], s34 offen offset:2048
buffer_load_dwordx4 a[20:23], v21, s[4:7], s34 offen offset:2560
buffer_load_dwordx4 a[24:27], v21, s[4:7], s34 offen offset:3072
buffer_load_dwordx4 a[28:31], v21, s[4:7], s34 offen offset:3584
s_add_u32 s34, s33, 4096
buffer_load_dwordx4 a[32:35], v21, s[4:7], s34 offen
buffer_load_dwordx4 a[36:39], v21, s[4:7], s34 offen offset:512
buffer_load_dwordx4 a[40:43], v21, s[4:7], s34 offen offset:1024
buffer_load_dwordx4 a[44:47], v21, s[4:7], s34 offen offset:1536
buffer_load_dwordx4 a[48:51], v21, s[4:7], s34 offen offset:2048
buffer_load_dwordx4 a[52:55], v21, s[4:7], s34 offen offset:2560
buffer_load_dwordx4 a[56:59], v21, s[4:7], s34 offen offset:3072
buffer_load_dwordx4 a[60:63], v21, s[4:7], s34 offen offset:3584
s_add_u32 s34, s33, 8192
buffer_load_dwordx4 a[64:67], v21, s[4:7], s34 offen
buffer_load_dwordx4 a[68:71], v21, s[4:7], s34 offen offset:512
buffer_load_dwordx4 a[72:75], v21, s[4:7], s34 offen offset:1024
buffer_load_dwordx4 a[76:79], v21, s[4:7], s34 offen offset:1536
buffer_load_dwordx4 a[80:83], v21, s[4:7], s34 offen offset:2048
buffer_load_dwordx4 a[84:87], v21, s[4:7], s34 offen offset:2560
buffer_load_dwordx4 a[88:91], v21, s[4:7], s34 offen offset:3072
buffer_load_dwordx4 a[92:95], v21, s[4:7], s34 offen offset:3584
s_add_u32 s34, s33, 12288
buffer_load_dwordx4 a[96:99], v21, s[4:7], s34 offen
buffer_load_dwordx4 a[100:103], v21, s[4:7], s34 offen offset:512
buffer_load_dwordx4 a[104:107], v21, s[4:7], s34 offen offset:1024
buffer_load_dwordx4 a[108:111], v21, s[4:7], s34 offen offset:1536
s_cmp_ge_u32 s20, 56
s_cselect_b32 s50, 1, 0
s_cbranch_scc1 PJ_INITV
s_mul_hi_u32 s33, s32, 153391690
s_mul_i32 s34, s33, 28
s_sub_u32 s34, s32, s34
s_lshr_b32 s34, s34, 1
s_mul_i32 s33, s33, 28672
s_lshl_b32 s34, s34, 11
s_add_u32 s33, s33, s34
v_lshlrev_b32 v21, 9, v18
v_lshl_add_u32 v21, v17, 4, v21
v_add_u32 v2, s33, v21
s_mov_b32 s55, 1024
s_branch PJ_INITD
PJ_INITV:
s_sub_u32 s32, s32, 448
s_mul_hi_u32 s34, s32, 153391690
s_mul_i32 s35, s34, 28
s_sub_u32 s35, s32, s35
s_lshl_b32 s35, s35, 4
v_add_u32 v19, s35, v17
v_mul_u32_u24 v20, 2341, v19
v_lshrrev_b32 v20, 16, v20
v_mul_u32_u24 v21, 28, v20
v_sub_u32 v21, v19, v21
v_mul_u32_u24 v20, 1792, v20
v_lshl_add_u32 v20, v21, 4, v20
v_mul_u32_u24 v21, 448, v18
v_add_u32 v20, v20, v21
s_mul_i32 s34, s34, 28672
v_add_u32 v2, s34, v20
s_mov_b32 s55, 896
PJ_INITD:
s_mul_i32 s54, s50, 56
s_sub_u32 s54, s20, s54
s_lshl_b32 s54, s54, 2
s_mul_i32 s33, s50, 16384
s_add_u32 s54, s54, s33
s_add_u32 s54, s54, 157966336
s_mul_i32 s56, s50, 58720256
s_add_u32 s56, s56, 40525824
s_mov_b32 s22, 0
s_mov_b32 s25, 0
s_mov_b32 s30, 0
s_mov_b32 s57, 0
s_cmp_eq_u32 s70, 0
s_cselect_b32 s71, 128, 64
s_cmp_lg_u32 s70, 0
s_cbranch_scc1 PJ_NOWARM
s_lshl_b32 s33, s17, 2
s_add_u32 s33, s33, s18
s_lshl_b32 s33, s33, 14
s_add_u32 s33, s33, 14688256
v_lshlrev_b32 v7, 3, v0
buffer_load_dword v60, v7, s[4:7], s33 offen
s_add_u32 s33, s33, 8192
buffer_load_dword v61, v7, s[4:7], s33 offen
PJ_NOWARM:
s_mov_b32 s59, 0
s_sub_u32 s72, s59, 15
s_lshr_b32 s73, s72, 1
s_add_u32 s74, s73, 15
s_bitcmp1_b32 s72, 0
s_cselect_b32 s23, s74, s73
s_cselect_b32 s24, 0, 1
s_sub_u32 s74, s72, 49
s_cmp_ge_i32 s72, 98
s_cselect_b32 s23, s74, s23
s_cselect_b32 s24, 1, s24
s_cmp_lt_u32 s59, 15
s_cselect_b32 s23, s59, s23
s_cselect_b32 s24, 0, s24
s_cmp_lg_u32 s70, 0
s_cselect_b32 s23, s59, s23
s_cselect_b32 s24, s19, s24
s_mov_b32 s59, 1
s_sub_u32 s72, s59, 15
s_lshr_b32 s73, s72, 1
s_add_u32 s74, s73, 15
s_bitcmp1_b32 s72, 0
s_cselect_b32 s26, s74, s73
s_cselect_b32 s27, 0, 1
s_sub_u32 s74, s72, 49
s_cmp_ge_i32 s72, 98
s_cselect_b32 s26, s74, s26
s_cselect_b32 s27, 1, s27
s_cmp_lt_u32 s59, 15
s_cselect_b32 s26, s59, s26
s_cselect_b32 s27, 0, s27
s_cmp_lg_u32 s70, 0
s_cselect_b32 s26, s59, s26
s_cselect_b32 s27, s19, s27
s_cmp_eq_u32 s24, 0
s_cbranch_scc1 PJ_F0
s_lshl_b32 s38, s23, 4
s_add_u32 s38, s38, 1536
s_cmp_eq_u32 s40, 0
s_cselect_b32 s41, 20000, 0
XW_2:
buffer_load_dwordx4 v[24:27], off, s[4:7], s38 sc1
s_waitcnt vmcnt(0)
v_min3_u32 v24, v24, v25, v26
v_min_u32 v24, v24, v27
v_cmp_eq_u32 vcc, 0, v24
s_nop 0
s_cbranch_vccz XWD_3
s_sub_u32 s41, s41, 1
s_cbranch_scc0 XW_2
s_or_b32 s40, s40, 1
XWD_3:
PJ_F0:
s_mul_i32 s36, s24, 3670016
s_add_u32 s36, s36, 14688256
s_mul_i32 s37, s23, 28672
s_add_u32 s36, s36, s37
s_mul_i32 s37, s18, 7168
s_add_u32 s36, s36, s37
s_add_u32 s37, s37, s25
s_add_u32 m0, s37, 0
s_nop 0
buffer_load_dwordx4 v0, s[4:7], s36 offen sc1 lds
buffer_load_dwordx4 v0, s[4:7], s36 offen offset:1024 sc1 lds
buffer_load_dwordx4 v0, s[4:7], s36 offen offset:2048 sc1 lds
buffer_load_dwordx4 v0, s[4:7], s36 offen offset:3072 sc1 lds
s_add_u32 s37, s37, 4096
s_add_u32 s36, s36, 4096
s_add_u32 m0, s37, 0
s_nop 0
buffer_load_dwordx4 v0, s[4:7], s36 offen sc1 lds
buffer_load_dwordx4 v0, s[4:7], s36 offen offset:1024 sc1 lds
buffer_load_dwordx4 v0, s[4:7], s36 offen offset:2048 sc1 lds
s_xor_b32 s52, s25, 32768
s_mul_i32 s36, s27, 3670016
s_add_u32 s36, s36, 14688256
s_mul_i32 s37, s26, 28672
s_add_u32 s36, s36, s37
s_mul_i32 s37, s18, 7168
s_add_u32 s36, s36, s37
s_add_u32 s37, s37, s52
v_mov_b32 v64, 0
v_mov_b32 v65, 0xf000
ds_write_b32 v65, v64
s_waitcnt vmcnt(0) lgkmcnt(0)
s_mov_b32 s38, 127
PJ_LOOP:
v_add_u32 v6, s25, v0
s_barrier
s_cmp_eq_u32 s50, 1
s_cbranch_scc1 PJ_BODYV
ds_read_b32 v64, v65
ds_read_b128 v[24:27], v6 offset:0
ds_read_b128 v[28:31], v6 offset:1024
ds_read_b128 v[32:35], v6 offset:2048
ds_read_b128 v[36:39], v6 offset:3072
ds_read_b128 v[40:43], v6 offset:4096
ds_read_b128 v[44:47], v6 offset:5120
s_waitcnt lgkmcnt(6)
v_readfirstlane_b32 s57, v64
s_add_u32 s39, s22, 1
s_cmp_eq_u32 s27, 0
s_cselect_b32 s51, 1, s57
s_cmp_ge_u32 s39, s71
s_cselect_b32 s51, 0, s51
s_add_u32 s59, s22, 2
s_waitcnt lgkmcnt(5)
v_mfma_f32_32x32x16_bf16 v[8:23], a[0:3], v[24:27], 0
ds_read_b128 v[48:51], v6 offset:6144
s_cmp_eq_u32 s51, 1
s_cbranch_scc0 PJ_NDK0
s_add_u32 m0, s37, 0
s_nop 0
buffer_load_dwordx4 v0, s[4:7], s36 offen sc1 lds
PJ_NDK0:
s_waitcnt lgkmcnt(5)
v_mfma_f32_32x32x16_bf16 v[8:23], a[4:7], v[28:31], v[8:23]
ds_read_b128 v[52:55], v6 offset:7168
s_cmp_eq_u32 s51, 1
s_cbranch_scc0 PJ_NDK1
buffer_load_dwordx4 v0, s[4:7], s36 offen offset:1024 sc1 lds
PJ_NDK1:
s_waitcnt lgkmcnt(5)
v_mfma_f32_32x32x16_bf16 v[8:23], a[8:11], v[32:35], v[8:23]
ds_read_b128 v[24:27], v6 offset:8192
s_cmp_eq_u32 s51, 1
s_cbranch_scc0 PJ_NDK2
buffer_load_dwordx4 v0, s[4:7], s36 offen offset:2048 sc1 lds
PJ_NDK2:
s_waitcnt lgkmcnt(5)
v_mfma_f32_32x32x16_bf16 v[8:23], a[12:15], v[36:39], v[8:23]
ds_read_b128 v[28:31], v6 offset:9216
s_cmp_eq_u32 s51, 1
s_cbranch_scc0 PJ_NDK3
buffer_load_dwordx4 v0, s[4:7], s36 offen offset:3072 sc1 lds
PJ_NDK3:
s_waitcnt lgkmcnt(5)
v_mfma_f32_32x32x16_bf16 v[8:23], a[16:19], v[40:43], v[8:23]
ds_read_b128 v[32:35], v6 offset:10240
s_cmp_eq_u32 s51, 1
s_cbranch_scc0 PJ_NDK4
s_add_u32 s37, s37, 4096
s_add_u32 s36, s36, 4096
s_add_u32 m0, s37, 0
s_nop 0
buffer_load_dwordx4 v0, s[4:7], s36 offen sc1 lds
PJ_NDK4:
s_waitcnt lgkmcnt(5)
v_mfma_f32_32x32x16_bf16 v[8:23], a[20:23], v[44:47], v[8:23]
ds_read_b128 v[36:39], v6 offset:11264
s_cmp_eq_u32 s51, 1
s_cbranch_scc0 PJ_NDK5
buffer_load_dwordx4 v0, s[4:7], s36 offen offset:1024 sc1 lds
PJ_NDK5:
s_waitcnt lgkmcnt(5)
v_mfma_f32_32x32x16_bf16 v[8:23], a[24:27], v[48:51], v[8:23]
ds_read_b128 v[40:43], v6 offset:12288
s_cmp_eq_u32 s51, 1
s_cbranch_scc0 PJ_NDK6
buffer_load_dwordx4 v0, s[4:7], s36 offen offset:2048 sc1 lds
PJ_NDK6:
s_waitcnt lgkmcnt(5)
v_mfma_f32_32x32x16_bf16 v[8:23], a[28:31], v[52:55], v[8:23]
ds_read_b128 v[44:47], v6 offset:13312
s_sub_u32 s72, s59, 15
s_lshr_b32 s73, s72, 1
s_add_u32 s74, s73, 15
s_waitcnt lgkmcnt(5)
v_mfma_f32_32x32x16_bf16 v[8:23], a[32:35], v[24:27], v[8:23]
ds_read_b128 v[48:51], v6 offset:14336
s_bitcmp1_b32 s72, 0
s_cselect_b32 s60, s74, s73
s_cselect_b32 s61, 0, 1
s_waitcnt lgkmcnt(5)
v_mfma_f32_32x32x16_bf16 v[8:23], a[36:39], v[28:31], v[8:23]
ds_read_b128 v[52:55], v6 offset:15360
s_sub_u32 s74, s72, 49
s_cmp_ge_i32 s72, 98
s_cselect_b32 s60, s74, s60
s_waitcnt lgkmcnt(5)
v_mfma_f32_32x32x16_bf16 v[8:23], a[40:43], v[32:35], v[8:23]
ds_read_b128 v[24:27], v6 offset:16384
s_cselect_b32 s61, 1, s61
s_cmp_lt_u32 s59, 15
s_cselect_b32 s60, s59, s60
s_waitcnt lgkmcnt(5)
v_mfma_f32_32x32x16_bf16 v[8:23], a[44:47], v[36:39], v[8:23]
ds_read_b128 v[28:31], v6 offset:17408
s_cselect_b32 s61, 0, s61
s_cmp_lg_u32 s70, 0
s_cselect_b32 s60, s59, s60
s_waitcnt lgkmcnt(5)
v_mfma_f32_32x32x16_bf16 v[8:23], a[48:51], v[40:43], v[8:23]
ds_read_b128 v[32:35], v6 offset:18432
s_cselect_b32 s61, s19, s61
s_lshl_b32 s58, s60, 4
s_and_b32 s58, s58, 0x3f0
s_waitcnt lgkmcnt(5)
v_mfma_f32_32x32x16_bf16 v[8:23], a[52:55], v[44:47], v[8:23]
ds_read_b128 v[36:39], v6 offset:19456
s_add_u32 s58, s58, 1536
s_waitcnt lgkmcnt(5)
v_mfma_f32_32x32x16_bf16 v[8:23], a[56:59], v[48:51], v[8:23]
ds_read_b128 v[40:43], v6 offset:20480
buffer_load_dwordx4 v[68:71], off, s[4:7], s58 sc1
s_waitcnt lgkmcnt(5)
v_mfma_f32_32x32x16_bf16 v[8:23], a[60:63], v[52:55], v[8:23]
ds_read_b128 v[44:47], v6 offset:21504
s_mul_i32 s28, s24, 29360128
s_add_u32 s28, s28, s56
s_waitcnt lgkmcnt(5)
v_mfma_f32_32x32x16_bf16 v[8:23], a[64:67], v[24:27], v[8:23]
ds_read_b128 v[48:51], v6 offset:22528
s_mul_i32 s33, s23, 458752
s_add_u32 s28, s28, s33
s_waitcnt lgkmcnt(5)
v_mfma_f32_32x32x16_bf16 v[8:23], a[68:71], v[28:31], v[8:23]
ds_read_b128 v[52:55], v6 offset:23552
s_add_u32 s34, s28, s55
s_mul_i32 s35, s24, 32768
s_waitcnt lgkmcnt(5)
v_mfma_f32_32x32x16_bf16 v[8:23], a[72:75], v[32:35], v[8:23]
ds_read_b128 v[24:27], v6 offset:24576
s_add_u32 s35, s35, s54
s_lshl_b32 s33, s23, 8
s_waitcnt lgkmcnt(5)
v_mfma_f32_32x32x16_bf16 v[8:23], a[76:79], v[36:39], v[8:23]
ds_read_b128 v[28:31], v6 offset:25600
s_add_u32 s35, s35, s33
s_waitcnt lgkmcnt(5)
v_mfma_f32_32x32x16_bf16 v[8:23], a[80:83], v[40:43], v[8:23]
ds_read_b128 v[32:35], v6 offset:26624
s_waitcnt lgkmcnt(5)
v_mfma_f32_32x32x16_bf16 v[8:23], a[84:87], v[44:47], v[8:23]
ds_read_b128 v[36:39], v6 offset:27648
s_waitcnt lgkmcnt(5)
v_mfma_f32_32x32x16_bf16 v[8:23], a[88:91], v[48:51], v[8:23]
s_cmp_eq_u32 s30, 0
s_cbranch_scc1 PJ_SGK
s_cmp_eq_u32 s51, 1
s_cbranch_scc1 PJ_SGK
s_waitcnt vmcnt(0)
s_cmp_eq_u32 s30, 0
s_cbranch_scc1 SIG_4
s_mov_b32 s30, 0
s_barrier
s_cmp_lg_u32 s18, 0
s_cbranch_scc1 SIG_4
v_mov_b32 v5, 1
s_mov_b64 exec, 1
buffer_store_dword v5, off, s[4:7], s31 sc1
s_mov_b64 exec, -1
SIG_4:
PJ_SGK:
s_waitcnt lgkmcnt(4)
v_mfma_f32_32x32x16_bf16 v[8:23], a[92:95], v[52:55], v[8:23]
s_waitcnt lgkmcnt(3)
v_mfma_f32_32x32x16_bf16 v[8:23], a[96:99], v[24:27], v[8:23]
s_waitcnt lgkmcnt(2)
v_mfma_f32_32x32x16_bf16 v[8:23], a[100:103], v[28:31], v[8:23]
s_waitcnt lgkmcnt(1)
v_mfma_f32_32x32x16_bf16 v[8:23], a[104:107], v[32:35], v[8:23]
s_waitcnt lgkmcnt(0)
v_mfma_f32_32x32x16_bf16 v[8:23], a[108:111], v[36:39], v[8:23]
s_nop 11
v_cvt_pk_bf16_f32 v56, v8, v9
v_cvt_pk_bf16_f32 v57, v10, v11
v_cvt_pk_bf16_f32 v58, v16, v17
v_cvt_pk_bf16_f32 v59, v18, v19
v_cvt_pk_bf16_f32 v60, v12, v13
v_cvt_pk_bf16_f32 v61, v14, v15
v_cvt_pk_bf16_f32 v62, v20, v21
v_cvt_pk_bf16_f32 v63, v22, v23
s_branch PJ_STORE
PJ_BODYV:
ds_read_b32 v64, v65
ds_read_b128 v[24:27], v6 offset:0
ds_read_b128 v[28:31], v6 offset:1024
ds_read_b128 v[32:35], v6 offset:2048
ds_read_b128 v[36:39], v6 offset:3072
ds_read_b128 v[40:43], v6 offset:4096
ds_read_b128 v[44:47], v6 offset:5120
s_waitcnt lgkmcnt(6)
v_readfirstlane_b32 s57, v64
s_add_u32 s39, s22, 1
s_cmp_eq_u32 s27, 0
s_cselect_b32 s51, 1, s57
s_cmp_ge_u32 s39, s71
s_cselect_b32 s51, 0, s51
s_add_u32 s59, s22, 2
s_waitcnt lgkmcnt(5)
v_mfma_f32_32x32x16_bf16 v[8:23], v[24:27], a[0:3], 0
ds_read_b128 v[48:51], v6 offset:6144
s_cmp_eq_u32 s51, 1
s_cbranch_scc0 PJ_NDV0
s_add_u32 m0, s37, 0
s_nop 0
buffer_load_dwordx4 v0, s[4:7], s36 offen sc1 lds
PJ_NDV0:
s_waitcnt lgkmcnt(5)
v_mfma_f32_32x32x16_bf16 v[8:23], v[28:31], a[4:7], v[8:23]
ds_read_b128 v[52:55], v6 offset:7168
s_cmp_eq_u32 s51, 1
s_cbranch_scc0 PJ_NDV1
buffer_load_dwordx4 v0, s[4:7], s36 offen offset:1024 sc1 lds
PJ_NDV1:
s_waitcnt lgkmcnt(5)
v_mfma_f32_32x32x16_bf16 v[8:23], v[32:35], a[8:11], v[8:23]
ds_read_b128 v[24:27], v6 offset:8192
s_cmp_eq_u32 s51, 1
s_cbranch_scc0 PJ_NDV2
buffer_load_dwordx4 v0, s[4:7], s36 offen offset:2048 sc1 lds
PJ_NDV2:
s_waitcnt lgkmcnt(5)
v_mfma_f32_32x32x16_bf16 v[8:23], v[36:39], a[12:15], v[8:23]
ds_read_b128 v[28:31], v6 offset:9216
s_cmp_eq_u32 s51, 1
s_cbranch_scc0 PJ_NDV3
buffer_load_dwordx4 v0, s[4:7], s36 offen offset:3072 sc1 lds
PJ_NDV3:
s_waitcnt lgkmcnt(5)
v_mfma_f32_32x32x16_bf16 v[8:23], v[40:43], a[16:19], v[8:23]
ds_read_b128 v[32:35], v6 offset:10240
s_cmp_eq_u32 s51, 1
s_cbranch_scc0 PJ_NDV4
s_add_u32 s37, s37, 4096
s_add_u32 s36, s36, 4096
s_add_u32 m0, s37, 0
s_nop 0
buffer_load_dwordx4 v0, s[4:7], s36 offen sc1 lds
PJ_NDV4:
s_waitcnt lgkmcnt(5)
v_mfma_f32_32x32x16_bf16 v[8:23], v[44:47], a[20:23], v[8:23]
ds_read_b128 v[36:39], v6 offset:11264
s_cmp_eq_u32 s51, 1
s_cbranch_scc0 PJ_NDV5
buffer_load_dwordx4 v0, s[4:7], s36 offen offset:1024 sc1 lds
PJ_NDV5:
s_waitcnt lgkmcnt(5)
v_mfma_f32_32x32x16_bf16 v[8:23], v[48:51], a[24:27], v[8:23]
ds_read_b128 v[40:43], v6 offset:12288
s_cmp_eq_u32 s51, 1
s_cbranch_scc0 PJ_NDV6
buffer_load_dwordx4 v0, s[4:7], s36 offen offset:2048 sc1 lds
PJ_NDV6:
s_waitcnt lgkmcnt(5)
v_mfma_f32_32x32x16_bf16 v[8:23], v[52:55], a[28:31], v[8:23]
ds_read_b128 v[44:47], v6 offset:13312
s_sub_u32 s72, s59, 15
s_lshr_b32 s73, s72, 1
s_add_u32 s74, s73, 15
s_waitcnt lgkmcnt(5)
v_mfma_f32_32x32x16_bf16 v[8:23], v[24:27], a[32:35], v[8:23]
ds_read_b128 v[48:51], v6 offset:14336
s_bitcmp1_b32 s72, 0
s_cselect_b32 s60, s74, s73
s_cselect_b32 s61, 0, 1
s_waitcnt lgkmcnt(5)
v_mfma_f32_32x32x16_bf16 v[8:23], v[28:31], a[36:39], v[8:23]
ds_read_b128 v[52:55], v6 offset:15360
s_sub_u32 s74, s72, 49
s_cmp_ge_i32 s72, 98
s_cselect_b32 s60, s74, s60
s_waitcnt lgkmcnt(5)
v_mfma_f32_32x32x16_bf16 v[8:23], v[32:35], a[40:43], v[8:23]
ds_read_b128 v[24:27], v6 offset:16384
s_cselect_b32 s61, 1, s61
s_cmp_lt_u32 s59, 15
s_cselect_b32 s60, s59, s60
s_waitcnt lgkmcnt(5)
v_mfma_f32_32x32x16_bf16 v[8:23], v[36:39], a[44:47], v[8:23]
ds_read_b128 v[28:31], v6 offset:17408
s_cselect_b32 s61, 0, s61
s_cmp_lg_u32 s70, 0
s_cselect_b32 s60, s59, s60
s_waitcnt lgkmcnt(5)
v_mfma_f32_32x32x16_bf16 v[8:23], v[40:43], a[48:51], v[8:23]
ds_read_b128 v[32:35], v6 offset:18432
s_cselect_b32 s61, s19, s61
s_lshl_b32 s58, s60, 4
s_and_b32 s58, s58, 0x3f0
s_waitcnt lgkmcnt(5)
v_mfma_f32_32x32x16_bf16 v[8:23], v[44:47], a[52:55], v[8:23]
ds_read_b128 v[36:39], v6 offset:19456
s_add_u32 s58, s58, 1536
s_waitcnt lgkmcnt(5)
v_mfma_f32_32x32x16_bf16 v[8:23], v[48:51], a[56:59], v[8:23]
ds_read_b128 v[40:43], v6 offset:20480
buffer_load_dwordx4 v[68:71], off, s[4:7], s58 sc1
s_waitcnt lgkmcnt(5)
v_mfma_f32_32x32x16_bf16 v[8:23], v[52:55], a[60:63], v[8:23]
ds_read_b128 v[44:47], v6 offset:21504
s_mul_i32 s28, s24, 29360128
s_add_u32 s28, s28, s56
s_waitcnt lgkmcnt(5)
v_mfma_f32_32x32x16_bf16 v[8:23], v[24:27], a[64:67], v[8:23]
ds_read_b128 v[48:51], v6 offset:22528
s_mul_i32 s33, s23, 458752
s_add_u32 s28, s28, s33
s_waitcnt lgkmcnt(5)
v_mfma_f32_32x32x16_bf16 v[8:23], v[28:31], a[68:71], v[8:23]
ds_read_b128 v[52:55], v6 offset:23552
s_add_u32 s34, s28, s55
s_mul_i32 s35, s24, 32768
s_waitcnt lgkmcnt(5)
v_mfma_f32_32x32x16_bf16 v[8:23], v[32:35], a[72:75], v[8:23]
ds_read_b128 v[24:27], v6 offset:24576
s_add_u32 s35, s35, s54
s_lshl_b32 s33, s23, 8
s_waitcnt lgkmcnt(5)
v_mfma_f32_32x32x16_bf16 v[8:23], v[36:39], a[76:79], v[8:23]
ds_read_b128 v[28:31], v6 offset:25600
s_add_u32 s35, s35, s33
s_waitcnt lgkmcnt(5)
v_mfma_f32_32x32x16_bf16 v[8:23], v[40:43], a[80:83], v[8:23]
ds_read_b128 v[32:35], v6 offset:26624
s_waitcnt lgkmcnt(5)
v_mfma_f32_32x32x16_bf16 v[8:23], v[44:47], a[84:87], v[8:23]
ds_read_b128 v[36:39], v6 offset:27648
s_waitcnt lgkmcnt(5)
v_mfma_f32_32x32x16_bf16 v[8:23], v[48:51], a[88:91], v[8:23]
s_cmp_eq_u32 s30, 0
s_cbranch_scc1 PJ_SGV
s_cmp_eq_u32 s51, 1
s_cbranch_scc1 PJ_SGV
s_waitcnt vmcnt(0)
s_cmp_eq_u32 s30, 0
s_cbranch_scc1 SIG_5
s_mov_b32 s30, 0
s_barrier
s_cmp_lg_u32 s18, 0
s_cbranch_scc1 SIG_5
v_mov_b32 v5, 1
s_mov_b64 exec, 1
buffer_store_dword v5, off, s[4:7], s31 sc1
s_mov_b64 exec, -1
SIG_5:
PJ_SGV:
s_waitcnt lgkmcnt(4)
v_mfma_f32_32x32x16_bf16 v[8:23], v[52:55], a[92:95], v[8:23]
s_waitcnt lgkmcnt(3)
v_mfma_f32_32x32x16_bf16 v[8:23], v[24:27], a[96:99], v[8:23]
s_waitcnt lgkmcnt(2)
v_mfma_f32_32x32x16_bf16 v[8:23], v[28:31], a[100:103], v[8:23]
s_waitcnt lgkmcnt(1)
v_mfma_f32_32x32x16_bf16 v[8:23], v[32:35], a[104:107], v[8:23]
s_waitcnt lgkmcnt(0)
v_mfma_f32_32x32x16_bf16 v[8:23], v[36:39], a[108:111], v[8:23]
s_nop 11
v_cvt_pk_bf16_f32 v56, v8, v9
v_cvt_pk_bf16_f32 v57, v10, v11
v_cvt_pk_bf16_f32 v58, v16, v17
v_cvt_pk_bf16_f32 v59, v18, v19
v_cvt_pk_bf16_f32 v60, v12, v13
v_cvt_pk_bf16_f32 v61, v14, v15
v_cvt_pk_bf16_f32 v62, v20, v21
v_cvt_pk_bf16_f32 v63, v22, v23
PJ_STORE:
s_waitcnt vmcnt(0)
v_min3_u32 v68, v68, v69, v70
v_min_u32 v68, v68, v71
v_cmp_eq_u32 vcc, 0, v68
s_mov_b32 s57, 1
s_cbranch_vccz PJ_RDY
s_mov_b32 s57, 0
PJ_RDY:
s_cmp_lg_u32 s18, 0
s_cbranch_scc1 PJ_RDY2
v_mov_b32 v64, s57
ds_write_b32 v65, v64
PJ_RDY2:
s_cmp_eq_u32 s30, 0
s_cbranch_scc1 SIG_6
s_mov_b32 s30, 0
s_barrier
s_cmp_lg_u32 s18, 0
s_cbranch_scc1 SIG_6
v_mov_b32 v5, 1
s_mov_b64 exec, 1
buffer_store_dword v5, off, s[4:7], s31 sc1
s_mov_b64 exec, -1
SIG_6:
buffer_store_dwordx4 v[56:59], v2, s[4:7], s28 offen sc1
buffer_store_dwordx4 v[60:63], v2, s[4:7], s34 offen sc1
s_mov_b32 s31, s35
s_mov_b32 s30, 1
s_add_u32 s22, s22, 1
s_cmp_ge_u32 s22, s71
s_cbranch_scc1 PJ_END
s_cmp_eq_u32 s51, 1
s_cbranch_scc1 PJ_ADV
s_waitcnt vmcnt(0)
s_cmp_eq_u32 s30, 0
s_cbranch_scc1 SIG_7
s_mov_b32 s30, 0
s_barrier
s_cmp_lg_u32 s18, 0
s_cbranch_scc1 SIG_7
v_mov_b32 v5, 1
s_mov_b64 exec, 1
buffer_store_dword v5, off, s[4:7], s31 sc1
s_mov_b64 exec, -1
SIG_7:
s_cmp_eq_u32 s27, 0
s_cbranch_scc1 PJ_NF
s_lshl_b32 s38, s26, 4
s_add_u32 s38, s38, 1536
s_cmp_eq_u32 s40, 0
s_cselect_b32 s41, 20000, 0
XW_8:
buffer_load_dwordx4 v[24:27], off, s[4:7], s38 sc1
s_waitcnt vmcnt(0)
v_min3_u32 v24, v24, v25, v26
v_min_u32 v24, v24, v27
v_cmp_eq_u32 vcc, 0, v24
s_nop 0
s_cbranch_vccz XWD_9
s_sub_u32 s41, s41, 1
s_cbranch_scc0 XW_8
s_or_b32 s40, s40, 1
XWD_9:
PJ_NF:
s_add_u32 m0, s37, 0
s_nop 0
buffer_load_dwordx4 v0, s[4:7], s36 offen sc1 lds
buffer_load_dwordx4 v0, s[4:7], s36 offen offset:1024 sc1 lds
buffer_load_dwordx4 v0, s[4:7], s36 offen offset:2048 sc1 lds
buffer_load_dwordx4 v0, s[4:7], s36 offen offset:3072 sc1 lds
s_add_u32 s37, s37, 4096
s_add_u32 s36, s36, 4096
s_add_u32 m0, s37, 0
s_nop 0
buffer_load_dwordx4 v0, s[4:7], s36 offen sc1 lds
buffer_load_dwordx4 v0, s[4:7], s36 offen offset:1024 sc1 lds
buffer_load_dwordx4 v0, s[4:7], s36 offen offset:2048 sc1 lds
s_waitcnt vmcnt(0)
PJ_ADV:
s_and_b32 s76, s20, 63
s_and_b32 s49, s22, 63
s_sub_u32 s38, s22, 1
s_mov_b32 s23, s26
s_mov_b32 s24, s27
s_mov_b32 s26, s60
s_mov_b32 s27, s61
s_mov_b32 s52, s25
s_xor_b32 s25, s25, 32768
s_mul_i32 s36, s27, 3670016
s_add_u32 s36, s36, 14688256
s_mul_i32 s37, s26, 28672
s_add_u32 s36, s36, s37
s_mul_i32 s37, s18, 7168
s_add_u32 s36, s36, s37
s_add_u32 s37, s37, s52
s_waitcnt lgkmcnt(0)
s_branch PJ_LOOP
PJ_END:
s_waitcnt vmcnt(0)
s_cmp_eq_u32 s30, 0
s_cbranch_scc1 SIG_10
s_mov_b32 s30, 0
s_barrier
s_cmp_lg_u32 s18, 0
s_cbranch_scc1 SIG_10
v_mov_b32 v5, 1
s_mov_b64 exec, 1
buffer_store_dword v5, off, s[4:7], s31 sc1
s_mov_b64 exec, -1
SIG_10:
s_branch L_ROLE_END
RP_START:
v_and_b32 v16, 63, v0
v_and_b32 v17, 15, v16
v_lshrrev_b32 v18, 4, v16
v_and_b32 v19, 7, v16
v_lshlrev_b32 v0, 4, v16
s_lshl_b32 s46, s18, 1
s_add_u32 s46, s46, 0
s_cmp_ge_u32 s46, 7
s_cselect_b32 s47, 7, 0
s_sub_u32 s46, s46, s47
s_lshl_b32 s56, s46, 10
s_lshl_b32 s46, s18, 1
s_add_u32 s46, s46, 1
s_cmp_ge_u32 s46, 7
s_cselect_b32 s47, 7, 0
s_sub_u32 s46, s46, s47
s_lshl_b32 s57, s46, 10
s_lshl_b32 s46, s18, 1
s_add_u32 s46, s46, 2
s_cmp_ge_u32 s46, 7
s_cselect_b32 s47, 7, 0
s_sub_u32 s46, s46, s47
s_lshl_b32 s58, s46, 10
s_lshl_b32 s46, s18, 1
s_add_u32 s46, s46, 3
s_cmp_ge_u32 s46, 7
s_cselect_b32 s47, 7, 0
s_sub_u32 s46, s46, s47
s_lshl_b32 s59, s46, 10
s_lshl_b32 s46, s18, 1
s_add_u32 s46, s46, 4
s_cmp_ge_u32 s46, 7
s_cselect_b32 s47, 7, 0
s_sub_u32 s46, s46, s47
s_lshl_b32 s60, s46, 10
s_lshl_b32 s46, s18, 1
s_add_u32 s46, s46, 5
s_cmp_ge_u32 s46, 7
s_cselect_b32 s47, 7, 0
s_sub_u32 s46, s46, s47
s_lshl_b32 s61, s46, 10
s_lshl_b32 s46, s18, 1
s_add_u32 s46, s46, 6
s_cmp_ge_u32 s46, 7
s_cselect_b32 s47, 7, 0
s_sub_u32 s46, s46, s47
s_lshl_b32 s62, s46, 10
s_and_b32 s33, s18, 1
s_mul_i32 s34, s18, 7
s_add_u32 s35, s34, s33
s_lshr_b32 s37, s35, 1
s_cmp_eq_u32 s33, 0
s_cselect_b32 s36, 6, 0
s_cselect_b32 s29, -1, 0
s_cselect_b32 s30, 0, -1
s_add_u32 s36, s36, s34
s_lshr_b32 s38, s36, 1
s_mul_i32 s39, s20, 28
s_add_u32 s32, s39, s36
s_mul_i32 s32, s32, 14336
s_add_u32 s32, s32, 65536
s_lshl_b32 s47, s56, 1
s_add_u32 s47, s47, s32
buffer_load_dwordx4 a[0:3], v0, s[4:7], s47 offen
buffer_load_dwordx4 a[4:7], v0, s[4:7], s47 offen offset:1024
s_lshl_b32 s47, s57, 1
s_add_u32 s47, s47, s32
buffer_load_dwordx4 a[8:11], v0, s[4:7], s47 offen
buffer_load_dwordx4 a[12:15], v0, s[4:7], s47 offen offset:1024
s_lshl_b32 s47, s58, 1
s_add_u32 s47, s47, s32
buffer_load_dwordx4 a[16:19], v0, s[4:7], s47 offen
buffer_load_dwordx4 a[20:23], v0, s[4:7], s47 offen offset:1024
s_lshl_b32 s47, s59, 1
s_add_u32 s47, s47, s32
buffer_load_dwordx4 a[24:27], v0, s[4:7], s47 offen
buffer_load_dwordx4 a[28:31], v0, s[4:7], s47 offen offset:1024
s_lshl_b32 s47, s60, 1
s_add_u32 s47, s47, s32
buffer_load_dwordx4 a[32:35], v0, s[4:7], s47 offen
buffer_load_dwordx4 a[36:39], v0, s[4:7], s47 offen offset:1024
s_lshl_b32 s47, s61, 1
s_add_u32 s47, s47, s32
buffer_load_dwordx4 a[40:43], v0, s[4:7], s47 offen
buffer_load_dwordx4 a[44:47], v0, s[4:7], s47 offen offset:1024
s_lshl_b32 s47, s62, 1
s_add_u32 s47, s47, s32
buffer_load_dwordx4 a[48:51], v0, s[4:7], s47 offen
buffer_load_dwordx4 a[52:55], v0, s[4:7], s47 offen offset:1024
s_add_u32 s32, s39, s35
s_mul_i32 s32, s32, 14336
s_add_u32 s32, s32, 65536
s_lshl_b32 s47, s56, 1
s_add_u32 s47, s47, s32
buffer_load_dwordx4 a[56:59], v0, s[4:7], s47 offen
buffer_load_dwordx4 a[60:63], v0, s[4:7], s47 offen offset:1024
s_lshl_b32 s47, s57, 1
s_add_u32 s47, s47, s32
buffer_load_dwordx4 a[64:67], v0, s[4:7], s47 offen
buffer_load_dwordx4 a[68:71], v0, s[4:7], s47 offen offset:1024
s_lshl_b32 s47, s58, 1
s_add_u32 s47, s47, s32
buffer_load_dwordx4 a[72:75], v0, s[4:7], s47 offen
buffer_load_dwordx4 a[76:79], v0, s[4:7], s47 offen offset:1024
s_lshl_b32 s47, s59, 1
s_add_u32 s47, s47, s32
buffer_load_dwordx4 a[80:83], v0, s[4:7], s47 offen
buffer_load_dwordx4 a[84:87], v0, s[4:7], s47 offen offset:1024
s_lshl_b32 s47, s60, 1
s_add_u32 s47, s47, s32
buffer_load_dwordx4 a[88:91], v0, s[4:7], s47 offen
buffer_load_dwordx4 a[92:95], v0, s[4:7], s47 offen offset:1024
s_lshl_b32 s47, s61, 1
s_add_u32 s47, s47, s32
buffer_load_dwordx4 a[96:99], v0, s[4:7], s47 offen
buffer_load_dwordx4 a[100:103], v0, s[4:7], s47 offen offset:1024
s_lshl_b32 s47, s62, 1
s_add_u32 s47, s47, s32
buffer_load_dwordx4 a[104:107], v0, s[4:7], s47 offen
buffer_load_dwordx4 a[108:111], v0, s[4:7], s47 offen offset:1024
s_add_u32 s32, s39, s35
s_add_u32 s32, s32, 1
s_mul_i32 s32, s32, 14336
s_add_u32 s32, s32, 65536
s_lshl_b32 s47, s56, 1
s_add_u32 s47, s47, s32
buffer_load_dwordx4 a[112:115], v0, s[4:7], s47 offen
buffer_load_dwordx4 a[116:119], v0, s[4:7], s47 offen offset:1024
s_lshl_b32 s47, s57, 1
s_add_u32 s47, s47, s32
buffer_load_dwordx4 a[120:123], v0, s[4:7], s47 offen
buffer_load_dwordx4 a[124:127], v0, s[4:7], s47 offen offset:1024
s_lshl_b32 s47, s58, 1
s_add_u32 s47, s47, s32
buffer_load_dwordx4 a[128:131], v0, s[4:7], s47 offen
buffer_load_dwordx4 a[132:135], v0, s[4:7], s47 offen offset:1024
s_lshl_b32 s47, s59, 1
s_add_u32 s47, s47, s32
buffer_load_dwordx4 a[136:139], v0, s[4:7], s47 offen
buffer_load_dwordx4 a[140:143], v0, s[4:7], s47 offen offset:1024
s_lshl_b32 s47, s60, 1
s_add_u32 s47, s47, s32
buffer_load_dwordx4 a[144:147], v0, s[4:7], s47 offen
buffer_load_dwordx4 a[148:151], v0, s[4:7], s47 offen offset:1024
s_lshl_b32 s47, s61, 1
s_add_u32 s47, s47, s32
buffer_load_dwordx4 a[152:155], v0, s[4:7], s47 offen
buffer_load_dwordx4 a[156:159], v0, s[4:7], s47 offen offset:1024
s_lshl_b32 s47, s62, 1
s_add_u32 s47, s47, s32
buffer_load_dwordx4 a[160:163], v0, s[4:7], s47 offen
buffer_load_dwordx4 a[164:167], v0, s[4:7], s47 offen offset:1024
s_add_u32 s32, s39, s35
s_add_u32 s32, s32, 2
s_mul_i32 s32, s32, 14336
s_add_u32 s32, s32, 65536
s_lshl_b32 s47, s56, 1
s_add_u32 s47, s47, s32
buffer_load_dwordx4 a[168:171], v0, s[4:7], s47 offen
buffer_load_dwordx4 a[172:175], v0, s[4:7], s47 offen offset:1024
s_lshl_b32 s47, s57, 1
s_add_u32 s47, s47, s32
buffer_load_dwordx4 a[176:179], v0, s[4:7], s47 offen
buffer_load_dwordx4 a[180:183], v0, s[4:7], s47 offen offset:1024
s_lshl_b32 s47, s58, 1
s_add_u32 s47, s47, s32
buffer_load_dwordx4 a[184:187], v0, s[4:7], s47 offen
buffer_load_dwordx4 a[188:191], v0, s[4:7], s47 offen offset:1024
s_lshl_b32 s47, s59, 1
s_add_u32 s47, s47, s32
buffer_load_dwordx4 a[192:195], v0, s[4:7], s47 offen
buffer_load_dwordx4 a[196:199], v0, s[4:7], s47 offen offset:1024
s_lshl_b32 s47, s60, 1
s_add_u32 s47, s47, s32
buffer_load_dwordx4 a[200:203], v0, s[4:7], s47 offen
buffer_load_dwordx4 a[204:207], v0, s[4:7], s47 offen offset:1024
s_lshl_b32 s47, s61, 1
s_add_u32 s47, s47, s32
buffer_load_dwordx4 a[208:211], v0, s[4:7], s47 offen
buffer_load_dwordx4 a[212:215], v0, s[4:7], s47 offen offset:1024
s_lshl_b32 s47, s62, 1
s_add_u32 s47, s47, s32
buffer_load_dwordx4 a[216:219], v0, s[4:7], s47 offen
buffer_load_dwordx4 a[220:223], v0, s[4:7], s47 offen offset:1024
s_add_u32 s32, s39, s35
s_add_u32 s32, s32, 3
s_mul_i32 s32, s32, 14336
s_add_u32 s32, s32, 65536
s_lshl_b32 s47, s56, 1
s_add_u32 s47, s47, s32
buffer_load_dwordx4 a[224:227], v0, s[4:7], s47 offen
buffer_load_dwordx4 a[228:231], v0, s[4:7], s47 offen offset:1024
s_lshl_b32 s47, s57, 1
s_add_u32 s47, s47, s32
buffer_load_dwordx4 a[232:235], v0, s[4:7], s47 offen
buffer_load_dwordx4 a[236:239], v0, s[4:7], s47 offen offset:1024
s_lshl_b32 s47, s58, 1
s_add_u32 s47, s47, s32
buffer_load_dwordx4 a[240:243], v0, s[4:7], s47 offen
buffer_load_dwordx4 a[244:247], v0, s[4:7], s47 offen offset:1024
s_lshl_b32 s47, s59, 1
s_add_u32 s47, s47, s32
buffer_load_dwordx4 a[248:251], v0, s[4:7], s47 offen
buffer_load_dwordx4 a[252:255], v0, s[4:7], s47 offen offset:1024
s_lshl_b32 s47, s60, 1
s_add_u32 s47, s47, s32
buffer_load_dwordx4 v[120:123], v0, s[4:7], s47 offen
buffer_load_dwordx4 v[124:127], v0, s[4:7], s47 offen offset:1024
s_lshl_b32 s47, s61, 1
s_add_u32 s47, s47, s32
buffer_load_dwordx4 v[128:131], v0, s[4:7], s47 offen
buffer_load_dwordx4 v[132:135], v0, s[4:7], s47 offen offset:1024
s_lshl_b32 s47, s62, 1
s_add_u32 s47, s47, s32
buffer_load_dwordx4 v[136:139], v0, s[4:7], s47 offen
buffer_load_dwordx4 v[140:143], v0, s[4:7], s47 offen offset:1024
s_add_u32 s32, s39, s35
s_add_u32 s32, s32, 4
s_mul_i32 s32, s32, 14336
s_add_u32 s32, s32, 65536
s_lshl_b32 s47, s56, 1
s_add_u32 s47, s47, s32
buffer_load_dwordx4 v[144:147], v0, s[4:7], s47 offen
buffer_load_dwordx4 v[148:151], v0, s[4:7], s47 offen offset:1024
s_lshl_b32 s47, s57, 1
s_add_u32 s47, s47, s32
buffer_load_dwordx4 v[152:155], v0, s[4:7], s47 offen
buffer_load_dwordx4 v[156:159], v0, s[4:7], s47 offen offset:1024
s_lshl_b32 s47, s58, 1
s_add_u32 s47, s47, s32
buffer_load_dwordx4 v[160:163], v0, s[4:7], s47 offen
buffer_load_dwordx4 v[164:167], v0, s[4:7], s47 offen offset:1024
s_lshl_b32 s47, s59, 1
s_add_u32 s47, s47, s32
buffer_load_dwordx4 v[168:171], v0, s[4:7], s47 offen
buffer_load_dwordx4 v[172:175], v0, s[4:7], s47 offen offset:1024
s_lshl_b32 s47, s60, 1
s_add_u32 s47, s47, s32
buffer_load_dwordx4 v[176:179], v0, s[4:7], s47 offen
buffer_load_dwordx4 v[180:183], v0, s[4:7], s47 offen offset:1024
s_lshl_b32 s47, s61, 1
s_add_u32 s47, s47, s32
buffer_load_dwordx4 v[184:187], v0, s[4:7], s47 offen
buffer_load_dwordx4 v[188:191], v0, s[4:7], s47 offen offset:1024
s_lshl_b32 s47, s62, 1
s_add_u32 s47, s47, s32
buffer_load_dwordx4 v[192:195], v0, s[4:7], s47 offen
buffer_load_dwordx4 v[196:199], v0, s[4:7], s47 offen offset:1024
s_add_u32 s32, s39, s35
s_add_u32 s32, s32, 5
s_mul_i32 s32, s32, 14336
s_add_u32 s32, s32, 65536
s_lshl_b32 s47, s56, 1
s_add_u32 s47, s47, s32
buffer_load_dwordx4 v[200:203], v0, s[4:7], s47 offen
buffer_load_dwordx4 v[204:207], v0, s[4:7], s47 offen offset:1024
s_lshl_b32 s47, s57, 1
s_add_u32 s47, s47, s32
buffer_load_dwordx4 v[208:211], v0, s[4:7], s47 offen
buffer_load_dwordx4 v[212:215], v0, s[4:7], s47 offen offset:1024
s_lshl_b32 s47, s58, 1
s_add_u32 s47, s47, s32
buffer_load_dwordx4 v[216:219], v0, s[4:7], s47 offen
buffer_load_dwordx4 v[220:223], v0, s[4:7], s47 offen offset:1024
s_lshl_b32 s47, s59, 1
s_add_u32 s47, s47, s32
buffer_load_dwordx4 v[224:227], v0, s[4:7], s47 offen
buffer_load_dwordx4 v[228:231], v0, s[4:7], s47 offen offset:1024
s_lshl_b32 s47, s60, 1
s_add_u32 s47, s47, s32
buffer_load_dwordx4 v[232:235], v0, s[4:7], s47 offen
buffer_load_dwordx4 v[236:239], v0, s[4:7], s47 offen offset:1024
s_lshl_b32 s47, s61, 1
s_add_u32 s47, s47, s32
buffer_load_dwordx4 v[240:243], v0, s[4:7], s47 offen
buffer_load_dwordx4 v[244:247], v0, s[4:7], s47 offen offset:1024
s_lshl_b32 s47, s62, 1
s_add_u32 s47, s47, s32
buffer_load_dwordx4 v[248:251], v0, s[4:7], s47 offen
buffer_load_dwordx4 v[252:255], v0, s[4:7], s47 offen offset:1024
v_mov_b32 v1, 0x4444
v_mov_b32 v21, 0xeeee
v_cmp_gt_u32 vcc, 8, v17
s_nop 1
v_cndmask_b32 v1, v21, v1, vcc
v_lshrrev_b32 v21, 1, v18
v_lshlrev_b32 v21, 8, v21
v_lshl_add_u32 v21, v19, 4, v21
v_and_b32 v22, 1, v18
v_lshl_add_u32 v21, v22, 3, v21
s_lshl_b32 s33, s37, 9
v_add_u32 v2, s33, v21
v_add_u32 v3, 1024, v2
s_lshl_b32 s33, s38, 9
v_add_u32 v4, s33, v21
v_lshlrev_b32 v22, 9, v18
v_lshl_add_u32 v22, v17, 4, v22
v_add_u32 v22, 32768, v22
s_lshl_b32 s33, s37, 11
v_add_u32 v5, s33, v22
s_lshl_b32 s33, s38, 11
v_add_u32 v6, s33, v22
s_mul_i32 s33, s18, 896
v_mul_u32_u24 v23, 3648, v18
v_lshl_add_u32 v23, v17, 3, v23
v_add_u32 v23, 13440, v23
v_add_u32 v7, s33, v23
v_and_b32 v24, 3, v16
v_mul_u32_u24 v24, 3648, v24
v_lshrrev_b32 v25, 2, v17
v_lshl_add_u32 v25, v18, 2, v25
v_lshl_add_u32 v24, v25, 3, v24
v_add_u32 v24, 13440, v24
v_add_u32 v8, s33, v24
s_mul_i32 s39, s18, 1552
s_add_u32 s39, s39, 7168
v_lshl_add_u32 v25, v18, 1, v17
v_and_b32 v25, 15, v25
v_lshlrev_b32 v25, 4, v25
v_lshl_add_u32 v25, v18, 8, v25
v_add_u32 v9, s39, v25
v_lshlrev_b32 v25, 7, v18
v_lshl_add_u32 v25, v19, 4, v25
v_add_u32 v25, 1024, v25
v_add_u32 v10, s39, v25
s_mov_b32 s50, 0x00ff00ff
s_mov_b32 s51, 0x00ff00ff
s_mov_b32 s52, 0x03ff03ff
s_mov_b32 s53, 0x03ff03ff
s_mov_b32 s54, -1
s_mov_b32 s55, 0
s_mul_i32 s22, s19, 466944
s_add_u32 s22, s22, 33038336
s_mul_i32 s24, s19, 655360
s_add_u32 s24, s24, 33972224
s_mul_i32 s25, s19, 2621440
s_add_u32 s25, s25, 35282944
s_mul_i32 s26, s19, 29360128
s_add_u32 s26, s26, 40525824
s_mul_i32 s27, s19, 3670016
s_add_u32 s27, s27, 14688256
s_mul_i32 s46, s20, 28672
s_add_u32 s26, s26, s46
s_mul_i32 s46, s20, 640
s_add_u32 s24, s24, s46
s_mul_i32 s46, s20, 2560
s_add_u32 s25, s25, s46
s_mul_i32 s28, s19, 32768
s_add_u32 s28, s28, 157966336
s_mov_b32 s44, -1
s_mov_b32 s45, 0x00ffffff
s_mov_b32 s21, 0
v_mov_b32 v28, 4048155338
v_mov_b32 v29, 4048155338
v_mov_b32 v30, 4048155338
v_mov_b32 v31, 4048155338
s_add_u32 s39, s39, 1536
v_mov_b32 v27, s39
ds_write_b128 v27, v[28:31]
s_cmp_ge_u32 s18, 2
s_cbranch_scc1 RP_INIT23
s_lshl_b32 s33, s18, 2
v_add_u32 v21, s33, v18
v_lshrrev_b32 v22, 2, v17
v_and_b32 v23, 3, v17
v_lshl_add_u32 v24, v22, 3, v21
v_lshl_add_u32 v24, v23, 1, v24
v_and_b32 v24, 15, v24
v_lshlrev_b32 v24, 4, v24
v_lshl_add_u32 v24, v23, 8, v24
v_lshlrev_b32 v25, 7, v23
v_lshl_add_u32 v25, v21, 4, v25
v_add_u32 v25, 1024, v25
v_cmp_gt_u32 vcc, 8, v17
s_nop 1
v_cndmask_b32 v24, v25, v24, vcc
v_mov_b32 v25, 1536
v_cmp_gt_u32 s[32:33], 12, v17
s_nop 1
v_cndmask_b32 v24, v25, v24, s[32:33]
v_add_u32 v11, 7168, v24
v_lshlrev_b32 v24, 7, v23
v_lshl_add_u32 v24, v22, 3, v24
v_lshlrev_b32 v25, 3, v23
v_add_u32 v25, 512, v25
v_cndmask_b32 v24, v25, v24, vcc
v_lshl_add_u32 v12, v21, 4, v24
v_mov_b32 v14, 0
v_mov_b32 v15, 0
buffer_load_dwordx2 v[28:29], v12, s[4:7], s24 offen
s_branch RP_INITDONE
RP_INIT23:
v_mov_b32 v11, v22
v_mov_b32 v12, v24
s_sub_u32 s33, s18, 2
s_lshl_b32 s34, s33, 8
s_add_u32 s34, s34, 65536
v_add_u32 v13, s34, v22
s_lshl_b32 s34, s33, 10
v_add_u32 v14, s34, v0
s_lshl_b32 s34, s33, 8
s_add_u32 s34, s34, 2048
v_lshlrev_b32 v25, 4, v17
v_lshl_add_u32 v25, v18, 3, v25
v_add_u32 v15, s34, v25
s_lshl_b32 s34, s33, 4
v_add_u32 v21, s34, v17
v_lshlrev_b32 v26, 2, v18
v_add_u32 v27, 0, v26
v_cmp_le_u32 s[64:65], v27, v21
v_add_u32 v27, 1, v26
v_cmp_le_u32 s[66:67], v27, v21
v_add_u32 v27, 2, v26
v_cmp_le_u32 s[68:69], v27, v21
v_add_u32 v27, 3, v26
v_cmp_le_u32 s[70:71], v27, v21
v_add_u32 v27, 16, v26
v_cmp_le_u32 s[72:73], v27, v21
v_add_u32 v27, 17, v26
v_cmp_le_u32 s[74:75], v27, v21
v_add_u32 v27, 18, v26
v_cmp_le_u32 s[76:77], v27, v21
v_add_u32 v27, 19, v26
v_cmp_le_u32 s[78:79], v27, v21
buffer_load_dwordx4 v[100:103], v14, s[4:7], s25 offen
buffer_load_dwordx2 v[104:105], v15, s[4:7], s25 offen
RP_INITDONE:
s_waitcnt vmcnt(0)
s_mov_b32 s34, 0
s_cmp_eq_u32 s40, 0
s_cselect_b32 s41, 20000, 0
FW_11:
v_lshrrev_b32 v16, 2, v0
buffer_load_dword v16, v16, s[4:7], s28 offen sc1
s_waitcnt vmcnt(0)
s_mov_b64 exec, s[44:45]
v_cmp_eq_u32 vcc, 0, v16
s_mov_b64 exec, -1
s_cbranch_vccz FWD_12
s_sub_u32 s41, s41, 1
s_cbranch_scc0 FW_11
s_or_b32 s40, s40, 2
FWD_12:
s_cmp_ge_u32 s18, 2
s_cbranch_scc1 RP_PRE23
s_and_b32 s35, s34, 1
s_lshl_b32 s35, s35, 15
s_and_b32 s36, s18, 1
s_mul_i32 s36, s36, 14336
s_add_u32 s35, s35, s36
s_mul_i32 s37, s34, 458752
s_add_u32 s37, s37, s26
s_add_u32 s37, s37, s36
s_add_u32 m0, s35, 32768
s_nop 0
buffer_load_dwordx4 v0, s[4:7], s37 offen sc1 lds
buffer_load_dwordx4 v0, s[4:7], s37 offen offset:1024 sc1 lds
buffer_load_dwordx4 v0, s[4:7], s37 offen offset:2048 sc1 lds
buffer_load_dwordx4 v0, s[4:7], s37 offen offset:3072 sc1 lds
s_add_u32 s35, s35, 4096
s_add_u32 s37, s37, 4096
s_add_u32 m0, s35, 32768
s_nop 0
buffer_load_dwordx4 v0, s[4:7], s37 offen sc1 lds
buffer_load_dwordx4 v0, s[4:7], s37 offen offset:1024 sc1 lds
buffer_load_dwordx4 v0, s[4:7], s37 offen offset:2048 sc1 lds
buffer_load_dwordx4 v0, s[4:7], s37 offen offset:3072 sc1 lds
s_add_u32 s35, s35, 4096
s_add_u32 s37, s37, 4096
s_add_u32 m0, s35, 32768
s_nop 0
buffer_load_dwordx4 v0, s[4:7], s37 offen sc1 lds
buffer_load_dwordx4 v0, s[4:7], s37 offen offset:1024 sc1 lds
buffer_load_dwordx4 v0, s[4:7], s37 offen offset:2048 sc1 lds
buffer_load_dwordx4 v0, s[4:7], s37 offen offset:3072 sc1 lds
s_add_u32 s35, s35, 4096
s_add_u32 s37, s37, 4096
s_add_u32 m0, s35, 32768
s_nop 0
buffer_load_dwordx4 v0, s[4:7], s37 offen sc1 lds
buffer_load_dwordx4 v0, s[4:7], s37 offen offset:1024 sc1 lds
s_branch RP_PRELOOP
RP_PRE23:
s_and_b32 s35, s34, 1
s_lshl_b32 s35, s35, 15
s_and_b32 s36, s18, 1
s_mul_i32 s36, s36, 14336
s_add_u32 s35, s35, s36
s_mul_i32 s37, s34, 28672
s_add_u32 s37, s37, s27
s_add_u32 s37, s37, s36
s_add_u32 m0, s35, 98304
s_nop 0
buffer_load_dwordx4 v0, s[4:7], s37 offen sc1 lds
buffer_load_dwordx4 v0, s[4:7], s37 offen offset:1024 sc1 lds
buffer_load_dwordx4 v0, s[4:7], s37 offen offset:2048 sc1 lds
buffer_load_dwordx4 v0, s[4:7], s37 offen offset:3072 sc1 lds
s_add_u32 s35, s35, 4096
s_add_u32 s37, s37, 4096
s_add_u32 m0, s35, 98304
s_nop 0
buffer_load_dwordx4 v0, s[4:7], s37 offen sc1 lds
buffer_load_dwordx4 v0, s[4:7], s37 offen offset:1024 sc1 lds
buffer_load_dwordx4 v0, s[4:7], s37 offen offset:2048 sc1 lds
buffer_load_dwordx4 v0, s[4:7], s37 offen offset:3072 sc1 lds
s_add_u32 s35, s35, 4096
s_add_u32 s37, s37, 4096
s_add_u32 m0, s35, 98304
s_nop 0
buffer_load_dwordx4 v0, s[4:7], s37 offen sc1 lds
buffer_load_dwordx4 v0, s[4:7], s37 offen offset:1024 sc1 lds
buffer_load_dwordx4 v0, s[4:7], s37 offen offset:2048 sc1 lds
buffer_load_dwordx4 v0, s[4:7], s37 offen offset:3072 sc1 lds
s_add_u32 s35, s35, 4096
s_add_u32 s37, s37, 4096
s_add_u32 m0, s35, 98304
s_nop 0
buffer_load_dwordx4 v0, s[4:7], s37 offen sc1 lds
buffer_load_dwordx4 v0, s[4:7], s37 offen offset:1024 sc1 lds
RP_PRELOOP:
s_mov_b32 s39, 127
RP_LOOP:
v_mov_b64 v[44:45], 0
v_mov_b64 v[46:47], 0
v_mov_b64 v[48:49], 0
v_mov_b64 v[50:51], 0
v_mov_b64 v[52:53], 0
v_mov_b64 v[54:55], 0
v_mov_b64 v[56:57], 0
v_mov_b64 v[58:59], 0
v_mov_b64 v[60:61], 0
v_mov_b64 v[62:63], 0
v_mov_b64 v[64:65], 0
v_mov_b64 v[66:67], 0
v_mov_b64 v[68:69], 0
v_mov_b64 v[70:71], 0
v_add_u32 v24, s58, v0
v_add_u32 v28, s59, v0
v_add_u32 v32, s60, v0
v_add_u32 v36, s61, v0
v_add_u32 v40, s62, v0
v_add_u32 v116, s56, v0
v_add_u32 v117, s57, v0
s_add_u32 s34, s22, s56
s_add_u32 s35, s22, s57
s_cmp_eq_u32 s40, 0
s_cselect_b32 s41, 20000, 0
POLL_13:
buffer_load_dwordx4 v[16:19], v0, s[4:7], s34 offen sc1
buffer_load_dwordx4 v[20:23], v0, s[4:7], s35 offen sc1
s_waitcnt vmcnt(0)
v_max3_u32 v118, v16, v18, v20
v_max3_u32 v119, v17, v19, v21
v_max_u32 v118, v118, v22
v_max_u32 v119, v119, v23
v_max_u32 v118, v118, v119
v_cmp_eq_u32 vcc, -1, v118
s_nop 0
s_cbranch_vccz PDONE_14
s_sub_u32 s41, s41, 1
s_cbranch_scc0 POLL_13
s_or_b32 s40, s40, 4
PDONE_14:
ds_write_b128 v116, v[16:19]
ds_write_b128 v117, v[20:23]
v_smfmac_f32_16x16x64_bf16 v[44:47], v[16:19], a[0:7], v1
v_smfmac_f32_16x16x64_bf16 v[48:51], v[16:19], a[56:63], v1
v_smfmac_f32_16x16x64_bf16 v[52:55], v[16:19], a[112:119], v1
v_smfmac_f32_16x16x64_bf16 v[56:59], v[16:19], a[168:175], v1
v_smfmac_f32_16x16x64_bf16 v[60:63], v[16:19], a[224:231], v1
v_smfmac_f32_16x16x64_bf16 v[64:67], v[16:19], v[144:151], v1
v_smfmac_f32_16x16x64_bf16 v[68:71], v[16:19], v[200:207], v1
s_waitcnt lgkmcnt(0)
s_barrier
s_add_u32 s33, s21, 1
s_lshl_b32 s33, s33, 8
s_add_u32 s33, s33, s28
v_smfmac_f32_16x16x64_bf16 v[44:47], v[20:23], a[8:15], v1
ds_read_b128 v[24:27], v24
v_smfmac_f32_16x16x64_bf16 v[48:51], v[20:23], a[64:71], v1
ds_read_b128 v[28:31], v28
v_smfmac_f32_16x16x64_bf16 v[52:55], v[20:23], a[120:127], v1
ds_read_b128 v[32:35], v32
v_smfmac_f32_16x16x64_bf16 v[56:59], v[20:23], a[176:183], v1
ds_read_b128 v[36:39], v36
v_smfmac_f32_16x16x64_bf16 v[60:63], v[20:23], a[232:239], v1
ds_read_b128 v[40:43], v40
v_smfmac_f32_16x16x64_bf16 v[64:67], v[20:23], v[152:159], v1
ds_read2_b32 v[84:85], v4 offset0:0 offset1:32
v_smfmac_f32_16x16x64_bf16 v[68:71], v[20:23], v[208:215], v1
ds_read2_b32 v[86:87], v4 offset0:1 offset1:33
s_waitcnt lgkmcnt(6)
v_smfmac_f32_16x16x64_bf16 v[44:47], v[24:27], a[16:23], v1
ds_read2_b32 v[72:73], v2 offset0:0 offset1:32
s_waitcnt lgkmcnt(6)
v_smfmac_f32_16x16x64_bf16 v[44:47], v[28:31], a[24:31], v1
ds_read2_b32 v[74:75], v2 offset0:1 offset1:33
s_waitcnt lgkmcnt(6)
v_smfmac_f32_16x16x64_bf16 v[44:47], v[32:35], a[32:39], v1
ds_read2_b32 v[76:77], v2 offset0:128 offset1:160
s_waitcnt lgkmcnt(6)
v_smfmac_f32_16x16x64_bf16 v[44:47], v[36:39], a[40:47], v1
ds_read2_b32 v[78:79], v2 offset0:129 offset1:161
s_waitcnt lgkmcnt(6)
v_smfmac_f32_16x16x64_bf16 v[44:47], v[40:43], a[48:55], v1
ds_read2_b32 v[80:81], v3 offset0:0 offset1:32
v_smfmac_f32_16x16x64_bf16 v[48:51], v[24:27], a[72:79], v1
ds_read2_b32 v[82:83], v3 offset0:1 offset1:33
v_smfmac_f32_16x16x64_bf16 v[48:51], v[28:31], a[80:87], v1
s_waitcnt lgkmcnt(6)
v_and_b32 v84, s29, v84
v_smfmac_f32_16x16x64_bf16 v[48:51], v[32:35], a[88:95], v1
v_and_b32 v85, s29, v85
v_cvt_pk_bf16_f32 v44, v44, v45
v_smfmac_f32_16x16x64_bf16 v[48:51], v[36:39], a[96:103], v1
v_and_b32 v86, s30, v86
v_cvt_pk_bf16_f32 v45, v46, v47
v_smfmac_f32_16x16x64_bf16 v[48:51], v[40:43], a[104:111], v1
v_and_b32 v87, s30, v87
ds_write_b64 v7, v[44:45] offset:0
v_smfmac_f32_16x16x64_bf16 v[52:55], v[24:27], a[128:135], v1
ds_read_b64_tr_b16 v[116:117], v8 offset:0
v_smfmac_f32_16x16x64_bf16 v[52:55], v[28:31], a[136:143], v1
ds_read_b64_tr_b16 v[118:119], v8 offset:0
v_smfmac_f32_16x16x64_bf16 v[52:55], v[32:35], a[144:151], v1
s_nop 0
v_cvt_pk_bf16_f32 v48, v48, v49
v_cvt_pk_bf16_f32 v49, v50, v51
v_smfmac_f32_16x16x64_bf16 v[52:55], v[36:39], a[152:159], v1
ds_write_b64 v7, v[48:49] offset:128
v_smfmac_f32_16x16x64_bf16 v[52:55], v[40:43], a[160:167], v1
ds_read_b128 v[100:103], v5 offset:0
v_smfmac_f32_16x16x64_bf16 v[56:59], v[24:27], a[184:191], v1
ds_read_b128 v[104:107], v5 offset:2048
v_smfmac_f32_16x16x64_bf16 v[56:59], v[28:31], a[192:199], v1
ds_read_b128 v[108:111], v5 offset:4096
v_smfmac_f32_16x16x64_bf16 v[56:59], v[32:35], a[200:207], v1
s_nop 1
v_cvt_pk_bf16_f32 v52, v52, v53
v_cvt_pk_bf16_f32 v53, v54, v55
v_smfmac_f32_16x16x64_bf16 v[56:59], v[36:39], a[208:215], v1
ds_write_b64 v7, v[52:53] offset:256
v_smfmac_f32_16x16x64_bf16 v[56:59], v[40:43], a[216:223], v1
s_waitcnt lgkmcnt(5)
v_mfma_f32_16x16x32_bf16 v[88:91], v[116:119], v[84:87], 0
v_lshrrev_b32 v46, 2, v0
buffer_load_dword v46, v46, s[4:7], s33 offen sc1
v_smfmac_f32_16x16x64_bf16 v[60:63], v[24:27], a[240:247], v1
ds_read_b64_tr_b16 v[116:117], v8 offset:128
v_smfmac_f32_16x16x64_bf16 v[60:63], v[28:31], a[248:255], v1
ds_read_b64_tr_b16 v[118:119], v8 offset:256
v_smfmac_f32_16x16x64_bf16 v[60:63], v[32:35], v[120:127], v1
v_cvt_pk_bf16_f32 v56, v56, v57
v_cvt_pk_bf16_f32 v57, v58, v59
v_smfmac_f32_16x16x64_bf16 v[60:63], v[36:39], v[128:135], v1
ds_write_b64 v7, v[56:57] offset:384
v_smfmac_f32_16x16x64_bf16 v[60:63], v[40:43], v[136:143], v1
ds_read_b128 v[112:115], v6 offset:0
v_smfmac_f32_16x16x64_bf16 v[64:67], v[24:27], v[160:167], v1
ds_read_b128 v[16:19], v5 offset:256
v_smfmac_f32_16x16x64_bf16 v[64:67], v[28:31], v[168:175], v1
ds_read_b128 v[20:23], v5 offset:2304
v_smfmac_f32_16x16x64_bf16 v[64:67], v[32:35], v[176:183], v1
s_nop 1
v_cvt_pk_bf16_f32 v60, v60, v61
v_cvt_pk_bf16_f32 v61, v62, v63
v_smfmac_f32_16x16x64_bf16 v[64:67], v[36:39], v[184:191], v1
ds_write_b64 v7, v[60:61] offset:512
v_smfmac_f32_16x16x64_bf16 v[64:67], v[40:43], v[192:199], v1
s_waitcnt lgkmcnt(5)
v_mfma_f32_16x16x32_bf16 v[88:91], v[116:119], v[72:75], v[88:91]
v_smfmac_f32_16x16x64_bf16 v[68:71], v[24:27], v[216:223], v1
ds_read_b64_tr_b16 v[116:117], v8 offset:384
v_smfmac_f32_16x16x64_bf16 v[68:71], v[28:31], v[224:231], v1
ds_read_b64_tr_b16 v[118:119], v8 offset:512
v_smfmac_f32_16x16x64_bf16 v[68:71], v[32:35], v[232:239], v1
s_nop 0
v_cvt_pk_bf16_f32 v64, v64, v65
v_cvt_pk_bf16_f32 v65, v66, v67
v_smfmac_f32_16x16x64_bf16 v[68:71], v[36:39], v[240:247], v1
ds_write_b64 v7, v[64:65] offset:640
v_smfmac_f32_16x16x64_bf16 v[68:71], v[40:43], v[248:255], v1
s_waitcnt lgkmcnt(4)
v_mfma_f32_16x16x32_bf16 v[92:95], v[112:115], v[84:87], 0
ds_read_b128 v[24:27], v5 offset:4352
ds_read_b128 v[28:31], v6 offset:256
v_mfma_f32_16x16x32_bf16 v[92:95], v[100:103], v[72:75], v[92:95]
v_mfma_f32_16x16x32_bf16 v[96:99], v[16:19], v[72:75], 0
s_nop 1
v_cvt_pk_bf16_f32 v68, v68, v69
v_cvt_pk_bf16_f32 v69, v70, v71
v_mfma_f32_16x16x32_bf16 v[92:95], v[104:107], v[76:79], v[92:95]
ds_write_b64 v7, v[68:69] offset:768
ds_read_b64_tr_b16 v[32:33], v8 offset:640
ds_read_b64_tr_b16 v[34:35], v8 offset:768
v_mfma_f32_16x16x32_bf16 v[96:99], v[20:23], v[76:79], v[96:99]
v_mfma_f32_16x16x32_bf16 v[92:95], v[108:111], v[80:83], v[92:95]
s_waitcnt lgkmcnt(6)
v_mfma_f32_16x16x32_bf16 v[88:91], v[116:119], v[76:79], v[88:91]
s_waitcnt lgkmcnt(3)
v_mfma_f32_16x16x32_bf16 v[96:99], v[24:27], v[80:83], v[96:99]
v_mfma_f32_16x16x32_bf16 v[96:99], v[28:31], v[84:87], v[96:99]
s_waitcnt lgkmcnt(0)
v_mfma_f32_16x16x32_bf16 v[88:91], v[32:35], v[80:83], v[88:91]
s_nop 5
v_mov_b32_dpp v92, v96 row_shr:8 row_mask:0xf bank_mask:0xc
v_mov_b32_dpp v93, v97 row_shr:8 row_mask:0xf bank_mask:0xc
v_mov_b32_dpp v94, v98 row_shr:8 row_mask:0xf bank_mask:0xc
v_mov_b32_dpp v95, v99 row_shr:8 row_mask:0xf bank_mask:0xc
ds_write_b128 v9, v[92:95]
s_mov_b64 exec, s[50:51]
ds_write_b128 v10, v[88:91]
s_mov_b64 exec, -1
s_waitcnt lgkmcnt(0)
s_barrier
s_cmp_ge_u32 s18, 2
s_cbranch_scc1 RP_XROWS
ds_read_b128 v[16:19], v11 offset:0
ds_read_b128 v[20:23], v11 offset:1552
ds_read_b128 v[24:27], v11 offset:3104
ds_read_b128 v[28:31], v11 offset:4656
s_mul_i32 s34, s21, 10240
s_add_u32 s34, s34, s24
s_waitcnt lgkmcnt(2)
v_add_f32 v16, v16, v20
v_add_f32 v17, v17, v21
v_add_f32 v18, v18, v22
v_add_f32 v19, v19, v23
s_waitcnt lgkmcnt(0)
v_add_f32 v24, v24, v28
v_add_f32 v25, v25, v29
v_add_f32 v26, v26, v30
v_add_f32 v27, v27, v31
v_add_f32 v16, v16, v24
v_add_f32 v17, v17, v25
v_add_f32 v18, v18, v26
v_add_f32 v19, v19, v27
v_add_f32_dpp v16, v16, v16 row_shl:2 row_mask:0xf bank_mask:0x4
v_add_f32_dpp v17, v17, v17 row_shl:2 row_mask:0xf bank_mask:0x4
v_add_f32_dpp v18, v18, v18 row_shl:2 row_mask:0xf bank_mask:0x4
v_add_f32_dpp v19, v19, v19 row_shl:2 row_mask:0xf bank_mask:0x4
v_max3_f32 v20, v16, v17, v18
v_max_f32 v20, v20, v19
s_nop 1
v_max_f32_dpp v21, v20, v20 row_ror:8 row_mask:0xf bank_mask:0xf
v_sub_f32 v16, v16, v20
v_sub_f32 v17, v17, v20
v_max_f32_dpp v21, v21, v21 row_ror:4 row_mask:0xf bank_mask:0xf
v_sub_f32 v18, v18, v20
v_sub_f32 v19, v19, v20
v_max_f32_dpp v21, v21, v21 row_ror:2 row_mask:0xf bank_mask:0xf
v_exp_f32 v16, v16
v_exp_f32 v17, v17
v_max_f32_dpp v21, v21, v21 row_ror:1 row_mask:0xf bank_mask:0xf
v_exp_f32 v18, v18
v_exp_f32 v19, v19
v_sub_f32 v20, v20, v21
v_add_f32 v22, v16, v17
v_exp_f32 v20, v20
v_add_f32 v23, v18, v19
v_add_f32 v22, v22, v23
v_mul_f32 v22, v22, v20
s_nop 1
v_add_f32_dpp v22, v22, v22 row_ror:8 row_mask:0xf bank_mask:0xf
s_nop 1
v_add_f32_dpp v22, v22, v22 row_ror:4 row_mask:0xf bank_mask:0xf
s_nop 1
v_add_f32_dpp v22, v22, v22 row_ror:2 row_mask:0xf bank_mask:0xf
s_nop 1
v_add_f32_dpp v22, v22, v22 row_ror:1 row_mask:0xf bank_mask:0xf
v_rcp_f32 v22, v22
s_mov_b64 exec, s[52:53]
v_mul_f32 v20, v20, v22
v_mul_f32 v16, v16, v20
v_mul_f32 v17, v17, v20
v_mul_f32 v18, v18, v20
v_mul_f32 v19, v19, v20
v_cvt_pk_bf16_f32 v24, v16, v17
v_cvt_pk_bf16_f32 v25, v18, v19
buffer_store_dwordx2 v[24:25], v12, s[4:7], s34 offen
s_add_u32 s34, s34, 10240
buffer_load_dwordx2 v[106:107], v12, s[4:7], s34 offen
s_mov_b64 exec, -1
s_add_u32 s34, s21, 1
s_cmp_ge_u32 s34, 64
s_cbranch_scc1 RP_NEXT
s_waitcnt vmcnt(1)
s_mov_b64 exec, s[44:45]
v_cmp_eq_u32 vcc, 0, v46
s_mov_b64 exec, -1
s_cbranch_vccz FC_15
s_cmp_eq_u32 s40, 0
s_cselect_b32 s41, 20000, 0
FW_16:
v_lshrrev_b32 v46, 2, v0
buffer_load_dword v46, v46, s[4:7], s33 offen sc1
s_waitcnt vmcnt(0)
s_mov_b64 exec, s[44:45]
v_cmp_eq_u32 vcc, 0, v46
s_mov_b64 exec, -1
s_cbranch_vccz FWD_17
s_sub_u32 s41, s41, 1
s_cbranch_scc0 FW_16
s_or_b32 s40, s40, 2
FWD_17:
FC_15:
s_and_b32 s35, s34, 1
s_lshl_b32 s35, s35, 15
s_and_b32 s36, s18, 1
s_mul_i32 s36, s36, 14336
s_add_u32 s35, s35, s36
s_mul_i32 s37, s34, 458752
s_add_u32 s37, s37, s26
s_add_u32 s37, s37, s36
s_add_u32 m0, s35, 32768
s_nop 0
buffer_load_dwordx4 v0, s[4:7], s37 offen sc1 lds
buffer_load_dwordx4 v0, s[4:7], s37 offen offset:1024 sc1 lds
buffer_load_dwordx4 v0, s[4:7], s37 offen offset:2048 sc1 lds
buffer_load_dwordx4 v0, s[4:7], s37 offen offset:3072 sc1 lds
s_add_u32 s35, s35, 4096
s_add_u32 s37, s37, 4096
s_add_u32 m0, s35, 32768
s_nop 0
buffer_load_dwordx4 v0, s[4:7], s37 offen sc1 lds
buffer_load_dwordx4 v0, s[4:7], s37 offen offset:1024 sc1 lds
buffer_load_dwordx4 v0, s[4:7], s37 offen offset:2048 sc1 lds
buffer_load_dwordx4 v0, s[4:7], s37 offen offset:3072 sc1 lds
s_add_u32 s35, s35, 4096
s_add_u32 s37, s37, 4096
s_add_u32 m0, s35, 32768
s_nop 0
buffer_load_dwordx4 v0, s[4:7], s37 offen sc1 lds
buffer_load_dwordx4 v0, s[4:7], s37 offen offset:1024 sc1 lds
buffer_load_dwordx4 v0, s[4:7], s37 offen offset:2048 sc1 lds
buffer_load_dwordx4 v0, s[4:7], s37 offen offset:3072 sc1 lds
s_add_u32 s35, s35, 4096
s_add_u32 s37, s37, 4096
s_add_u32 m0, s35, 32768
s_nop 0
buffer_load_dwordx4 v0, s[4:7], s37 offen sc1 lds
buffer_load_dwordx4 v0, s[4:7], s37 offen offset:1024 sc1 lds
s_branch RP_NEXT
RP_XROWS:
s_add_u32 s34, s21, 1
s_mul_i32 s34, s34, 40960
s_add_u32 s34, s34, s25
buffer_load_dwordx4 v[100:103], v14, s[4:7], s34 offen
buffer_load_dwordx2 v[104:105], v15, s[4:7], s34 offen
s_add_u32 s34, s21, 1
s_min_u32 s34, s34, 63
s_waitcnt vmcnt(2)
s_add_u32 s38, s21, 1
s_cmp_ge_u32 s38, 64
s_cbranch_scc1 RP_NOXN
s_mov_b64 exec, s[44:45]
v_cmp_eq_u32 vcc, 0, v46
s_mov_b64 exec, -1
s_cbranch_vccz FC_18
s_cmp_eq_u32 s40, 0
s_cselect_b32 s41, 20000, 0
FW_19:
v_lshrrev_b32 v46, 2, v0
buffer_load_dword v46, v46, s[4:7], s33 offen sc1
s_waitcnt vmcnt(0)
s_mov_b64 exec, s[44:45]
v_cmp_eq_u32 vcc, 0, v46
s_mov_b64 exec, -1
s_cbranch_vccz FWD_20
s_sub_u32 s41, s41, 1
s_cbranch_scc0 FW_19
s_or_b32 s40, s40, 2
FWD_20:
FC_18:
RP_NOXN:
s_and_b32 s35, s34, 1
s_lshl_b32 s35, s35, 15
s_and_b32 s36, s18, 1
s_mul_i32 s36, s36, 14336
s_add_u32 s35, s35, s36
s_mul_i32 s37, s34, 28672
s_add_u32 s37, s37, s27
s_add_u32 s37, s37, s36
ds_read_b128 v[16:19], v13 offset:0
ds_read_b128 v[24:27], v11 offset:0
ds_read_b128 v[28:31], v11 offset:256
ds_read_b64_tr_b16 v[20:21], v12 offset:128
ds_read_b64_tr_b16 v[22:23], v12 offset:256
ds_read_b128 v[72:75], v13 offset:2048
ds_read_b128 v[80:83], v11 offset:2048
ds_read_b128 v[84:87], v11 offset:2304
ds_read_b64_tr_b16 v[76:77], v12 offset:384
ds_read_b64_tr_b16 v[78:79], v12 offset:512
s_waitcnt lgkmcnt(5)
v_mfma_f32_16x16x32_bf16 v[48:51], v[24:27], v[16:19], 0
ds_read_b128 v[56:59], v13 offset:4096
ds_read_b128 v[64:67], v11 offset:4096
v_mfma_f32_16x16x32_bf16 v[52:55], v[28:31], v[16:19], 0
ds_read_b128 v[68:71], v11 offset:4352
ds_read_b64_tr_b16 v[60:61], v12 offset:640
v_mfma_f32_16x16x32_bf16 v[44:47], v[20:23], v[16:19], 0
ds_read_b64_tr_b16 v[62:63], v12 offset:768
s_waitcnt lgkmcnt(5)
v_mfma_f32_16x16x32_bf16 v[48:51], v[80:83], v[72:75], v[48:51]
ds_read_b128 v[16:19], v13 offset:6144
ds_read_b128 v[24:27], v11 offset:6144
v_mfma_f32_16x16x32_bf16 v[52:55], v[84:87], v[72:75], v[52:55]
ds_read_b128 v[28:31], v11 offset:6400
ds_read_b64_tr_b16 v[20:21], v12 offset:0
v_mfma_f32_16x16x32_bf16 v[44:47], v[76:79], v[72:75], v[44:47]
ds_read_b64_tr_b16 v[22:23], v12 offset:896
s_waitcnt lgkmcnt(5)
v_mfma_f32_16x16x32_bf16 v[48:51], v[64:67], v[56:59], v[48:51]
ds_read_b128 v[72:75], v13 offset:8192
ds_read_b128 v[80:83], v11 offset:8192
v_mfma_f32_16x16x32_bf16 v[52:55], v[68:71], v[56:59], v[52:55]
ds_read_b128 v[84:87], v11 offset:8448
ds_read_b64_tr_b16 v[76:77], v12 offset:1024
v_mfma_f32_16x16x32_bf16 v[44:47], v[60:63], v[56:59], v[44:47]
ds_read_b64_tr_b16 v[78:79], v12 offset:1152
s_waitcnt lgkmcnt(5)
v_mfma_f32_16x16x32_bf16 v[48:51], v[24:27], v[16:19], v[48:51]
ds_read_b128 v[56:59], v13 offset:10240
ds_read_b128 v[64:67], v11 offset:10240
v_mfma_f32_16x16x32_bf16 v[52:55], v[28:31], v[16:19], v[52:55]
ds_read_b128 v[68:71], v11 offset:10496
ds_read_b64_tr_b16 v[60:61], v12 offset:1280
v_mfma_f32_16x16x32_bf16 v[44:47], v[20:23], v[16:19], v[44:47]
ds_read_b64_tr_b16 v[62:63], v12 offset:1408
s_waitcnt lgkmcnt(5)
v_mfma_f32_16x16x32_bf16 v[48:51], v[80:83], v[72:75], v[48:51]
ds_read_b128 v[16:19], v13 offset:12288
ds_read_b128 v[24:27], v11 offset:12288
v_mfma_f32_16x16x32_bf16 v[52:55], v[84:87], v[72:75], v[52:55]
ds_read_b128 v[28:31], v11 offset:12544
ds_read_b64_tr_b16 v[20:21], v12 offset:1536
v_mfma_f32_16x16x32_bf16 v[44:47], v[76:79], v[72:75], v[44:47]
ds_read_b64_tr_b16 v[22:23], v12 offset:1664
s_waitcnt lgkmcnt(5)
v_mfma_f32_16x16x32_bf16 v[48:51], v[64:67], v[56:59], v[48:51]
ds_read_b128 v[72:75], v13 offset:14336
ds_read_b128 v[80:83], v11 offset:14336
v_mfma_f32_16x16x32_bf16 v[52:55], v[68:71], v[56:59], v[52:55]
ds_read_b128 v[84:87], v11 offset:14592
ds_read_b64_tr_b16 v[76:77], v12 offset:1920
v_mfma_f32_16x16x32_bf16 v[44:47], v[60:63], v[56:59], v[44:47]
ds_read_b64_tr_b16 v[78:79], v12 offset:2048
s_waitcnt lgkmcnt(5)
v_mfma_f32_16x16x32_bf16 v[48:51], v[24:27], v[16:19], v[48:51]
ds_read_b128 v[56:59], v13 offset:16384
ds_read_b128 v[64:67], v11 offset:16384
v_mfma_f32_16x16x32_bf16 v[52:55], v[28:31], v[16:19], v[52:55]
ds_read_b128 v[68:71], v11 offset:16640
ds_read_b64_tr_b16 v[60:61], v12 offset:2176
v_mfma_f32_16x16x32_bf16 v[44:47], v[20:23], v[16:19], v[44:47]
ds_read_b64_tr_b16 v[62:63], v12 offset:2304
s_waitcnt lgkmcnt(5)
v_mfma_f32_16x16x32_bf16 v[48:51], v[80:83], v[72:75], v[48:51]
ds_read_b128 v[16:19], v13 offset:18432
ds_read_b128 v[24:27], v11 offset:18432
v_mfma_f32_16x16x32_bf16 v[52:55], v[84:87], v[72:75], v[52:55]
ds_read_b128 v[28:31], v11 offset:18688
ds_read_b64_tr_b16 v[20:21], v12 offset:2432
v_mfma_f32_16x16x32_bf16 v[44:47], v[76:79], v[72:75], v[44:47]
ds_read_b64_tr_b16 v[22:23], v12 offset:2560
s_add_u32 m0, s35, 98304
s_nop 0
buffer_load_dwordx4 v0, s[4:7], s37 offen sc1 lds
buffer_load_dwordx4 v0, s[4:7], s37 offen offset:1024 sc1 lds
s_waitcnt lgkmcnt(5)
v_mfma_f32_16x16x32_bf16 v[48:51], v[64:67], v[56:59], v[48:51]
ds_read_b128 v[72:75], v13 offset:20480
ds_read_b128 v[80:83], v11 offset:20480
v_mfma_f32_16x16x32_bf16 v[52:55], v[68:71], v[56:59], v[52:55]
ds_read_b128 v[84:87], v11 offset:20736
ds_read_b64_tr_b16 v[76:77], v12 offset:1792
v_mfma_f32_16x16x32_bf16 v[44:47], v[60:63], v[56:59], v[44:47]
ds_read_b64_tr_b16 v[78:79], v12 offset:2688
buffer_load_dwordx4 v0, s[4:7], s37 offen offset:2048 sc1 lds
buffer_load_dwordx4 v0, s[4:7], s37 offen offset:3072 sc1 lds
s_waitcnt lgkmcnt(5)
v_mfma_f32_16x16x32_bf16 v[48:51], v[24:27], v[16:19], v[48:51]
ds_read_b128 v[56:59], v13 offset:22528
ds_read_b128 v[64:67], v11 offset:22528
v_mfma_f32_16x16x32_bf16 v[52:55], v[28:31], v[16:19], v[52:55]
ds_read_b128 v[68:71], v11 offset:22784
ds_read_b64_tr_b16 v[60:61], v12 offset:2816
v_mfma_f32_16x16x32_bf16 v[44:47], v[20:23], v[16:19], v[44:47]
ds_read_b64_tr_b16 v[62:63], v12 offset:2944
s_add_u32 s35, s35, 4096
s_add_u32 s37, s37, 4096
s_add_u32 m0, s35, 98304
s_nop 0
buffer_load_dwordx4 v0, s[4:7], s37 offen sc1 lds
buffer_load_dwordx4 v0, s[4:7], s37 offen offset:1024 sc1 lds
s_waitcnt lgkmcnt(5)
v_mfma_f32_16x16x32_bf16 v[48:51], v[80:83], v[72:75], v[48:51]
ds_read_b128 v[16:19], v13 offset:24576
ds_read_b128 v[24:27], v11 offset:24576
v_mfma_f32_16x16x32_bf16 v[52:55], v[84:87], v[72:75], v[52:55]
ds_read_b128 v[28:31], v11 offset:24832
ds_read_b64_tr_b16 v[20:21], v12 offset:3072
v_mfma_f32_16x16x32_bf16 v[44:47], v[76:79], v[72:75], v[44:47]
ds_read_b64_tr_b16 v[22:23], v12 offset:3200
buffer_load_dwordx4 v0, s[4:7], s37 offen offset:2048 sc1 lds
buffer_load_dwordx4 v0, s[4:7], s37 offen offset:3072 sc1 lds
s_waitcnt lgkmcnt(5)
v_mfma_f32_16x16x32_bf16 v[48:51], v[64:67], v[56:59], v[48:51]
ds_read_b128 v[72:75], v13 offset:26624
ds_read_b128 v[80:83], v11 offset:26624
v_mfma_f32_16x16x32_bf16 v[52:55], v[68:71], v[56:59], v[52:55]
ds_read_b128 v[84:87], v11 offset:26880
ds_read_b64_tr_b16 v[76:77], v12 offset:3328
v_mfma_f32_16x16x32_bf16 v[44:47], v[60:63], v[56:59], v[44:47]
ds_read_b64_tr_b16 v[78:79], v12 offset:3456
s_add_u32 s35, s35, 4096
s_add_u32 s37, s37, 4096
s_add_u32 m0, s35, 98304
s_nop 0
buffer_load_dwordx4 v0, s[4:7], s37 offen sc1 lds
buffer_load_dwordx4 v0, s[4:7], s37 offen offset:1024 sc1 lds
s_waitcnt lgkmcnt(5)
v_mfma_f32_16x16x32_bf16 v[48:51], v[24:27], v[16:19], v[48:51]
v_mfma_f32_16x16x32_bf16 v[52:55], v[28:31], v[16:19], v[52:55]
v_mfma_f32_16x16x32_bf16 v[44:47], v[20:23], v[16:19], v[44:47]
buffer_load_dwordx4 v0, s[4:7], s37 offen offset:2048 sc1 lds
buffer_load_dwordx4 v0, s[4:7], s37 offen offset:3072 sc1 lds
s_waitcnt lgkmcnt(0)
v_mfma_f32_16x16x32_bf16 v[48:51], v[80:83], v[72:75], v[48:51]
v_mfma_f32_16x16x32_bf16 v[52:55], v[84:87], v[72:75], v[52:55]
v_mfma_f32_16x16x32_bf16 v[44:47], v[76:79], v[72:75], v[44:47]
s_add_u32 s35, s35, 4096
s_add_u32 s37, s37, 4096
s_add_u32 m0, s35, 98304
s_nop 0
buffer_load_dwordx4 v0, s[4:7], s37 offen sc1 lds
buffer_load_dwordx4 v0, s[4:7], s37 offen offset:1024 sc1 lds
v_mov_b32 v116, 4048155338
v_cndmask_b32 v48, v116, v48, s[64:65]
v_cndmask_b32 v49, v116, v49, s[66:67]
v_cndmask_b32 v50, v116, v50, s[68:69]
v_cndmask_b32 v51, v116, v51, s[70:71]
v_cndmask_b32 v52, v116, v52, s[72:73]
v_cndmask_b32 v53, v116, v53, s[74:75]
v_cndmask_b32 v54, v116, v54, s[76:77]
v_cndmask_b32 v55, v116, v55, s[78:79]
v_mov_b32 v16, v44
v_mov_b32 v17, v45
v_mov_b32 v18, v46
v_mov_b32 v19, v47
v_permlane32_swap_b32 v44, v16
v_permlane32_swap_b32 v45, v17
v_permlane32_swap_b32 v46, v18
v_permlane32_swap_b32 v47, v19
v_add_f32 v44, v44, v16
v_add_f32 v45, v45, v17
v_add_f32 v46, v46, v18
v_add_f32 v47, v47, v19
v_cndmask_b32 v44, v116, v44, s[54:55]
v_cndmask_b32 v45, v116, v45, s[54:55]
v_cndmask_b32 v46, v116, v46, s[54:55]
v_cndmask_b32 v47, v116, v47, s[54:55]
v_max3_f32 v20, v48, v49, v50
v_max3_f32 v21, v51, v52, v53
v_max3_f32 v20, v20, v54, v55
v_max3_f32 v21, v21, v44, v45
v_max3_f32 v20, v20, v46, v47
v_max_f32 v20, v20, v21
v_mov_b32 v21, v20
s_nop 1
v_permlane32_swap_b32 v20, v21
v_max_f32 v20, v20, v21
v_mov_b32 v21, v20
s_nop 1
v_permlane16_swap_b32 v20, v21
v_max_f32 v20, v20, v21
v_pk_add_f32 v[44:45], v[44:45], v[20:21] op_sel_hi:[1,0] neg_lo:[0,1] neg_hi:[0,1]
v_pk_add_f32 v[46:47], v[46:47], v[20:21] op_sel_hi:[1,0] neg_lo:[0,1] neg_hi:[0,1]
v_pk_add_f32 v[48:49], v[48:49], v[20:21] op_sel_hi:[1,0] neg_lo:[0,1] neg_hi:[0,1]
v_pk_add_f32 v[50:51], v[50:51], v[20:21] op_sel_hi:[1,0] neg_lo:[0,1] neg_hi:[0,1]
v_pk_add_f32 v[52:53], v[52:53], v[20:21] op_sel_hi:[1,0] neg_lo:[0,1] neg_hi:[0,1]
v_pk_add_f32 v[54:55], v[54:55], v[20:21] op_sel_hi:[1,0] neg_lo:[0,1] neg_hi:[0,1]
v_exp_f32 v44, v44
v_exp_f32 v45, v45
v_exp_f32 v46, v46
v_exp_f32 v47, v47
v_exp_f32 v48, v48
v_exp_f32 v49, v49
v_exp_f32 v50, v50
v_exp_f32 v51, v51
v_exp_f32 v52, v52
v_exp_f32 v53, v53
v_exp_f32 v54, v54
v_exp_f32 v55, v55
v_pk_add_f32 v[22:23], v[44:45], v[46:47]
v_pk_add_f32 v[24:25], v[48:49], v[50:51]
v_pk_add_f32 v[22:23], v[22:23], v[52:53]
v_pk_add_f32 v[24:25], v[24:25], v[54:55]
v_pk_add_f32 v[22:23], v[22:23], v[24:25]
v_add_f32 v22, v22, v23
v_mov_b32 v23, v22
s_nop 1
v_permlane32_swap_b32 v22, v23
v_add_f32 v22, v22, v23
v_mov_b32 v23, v22
s_nop 1
v_permlane16_swap_b32 v22, v23
v_add_f32 v22, v22, v23
v_rcp_f32 v22, v22
s_nop 0
v_pk_mul_f32 v[44:45], v[44:45], v[22:23] op_sel_hi:[1,0]
v_pk_mul_f32 v[46:47], v[46:47], v[22:23] op_sel_hi:[1,0]
v_pk_mul_f32 v[48:49], v[48:49], v[22:23] op_sel_hi:[1,0]
v_pk_mul_f32 v[50:51], v[50:51], v[22:23] op_sel_hi:[1,0]
v_pk_mul_f32 v[52:53], v[52:53], v[22:23] op_sel_hi:[1,0]
v_pk_mul_f32 v[54:55], v[54:55], v[22:23] op_sel_hi:[1,0]
v_cvt_pk_bf16_f32 v28, v48, v49
v_cvt_pk_bf16_f32 v29, v50, v51
v_cvt_pk_bf16_f32 v30, v52, v53
v_cvt_pk_bf16_f32 v31, v54, v55
v_cvt_pk_bf16_f32 v32, v44, v45
v_cvt_pk_bf16_f32 v33, v46, v47
s_mul_i32 s34, s21, 40960
s_add_u32 s34, s34, s25
buffer_store_dwordx4 v[28:31], v14, s[4:7], s34 offen
s_mov_b64 exec, s[54:55]
buffer_store_dwordx2 v[32:33], v15, s[4:7], s34 offen
s_mov_b64 exec, -1
v_xor_b32 v11, 0x18000, v11
v_xor_b32 v13, 0x38000, v13
RP_NEXT:
s_lshl_b32 s33, s19, 5
s_add_u32 s33, s33, s20
v_xor_b32 v5, 0x18000, v5
v_xor_b32 v6, 0x18000, v6
s_add_u32 s22, s22, 7168
s_add_u32 s21, s21, 1
s_cmp_lt_u32 s21, 64
s_cbranch_scc1 RP_LOOP
s_branch L_ROLE_END
RV_START:
v_and_b32 v16, 63, v0
v_and_b32 v17, 15, v16
v_lshrrev_b32 v18, 4, v16
v_and_b32 v19, 7, v16
v_lshlrev_b32 v0, 4, v16
v_and_b32 v26, 31, v16
v_lshrrev_b32 v27, 5, v16
s_lshl_b32 s46, s18, 1
s_add_u32 s46, s46, 0
s_cmp_ge_u32 s46, 7
s_cselect_b32 s47, 7, 0
s_sub_u32 s46, s46, s47
s_lshl_b32 s56, s46, 10
s_lshl_b32 s46, s18, 1
s_add_u32 s46, s46, 1
s_cmp_ge_u32 s46, 7
s_cselect_b32 s47, 7, 0
s_sub_u32 s46, s46, s47
s_lshl_b32 s57, s46, 10
s_lshl_b32 s46, s18, 1
s_add_u32 s46, s46, 2
s_cmp_ge_u32 s46, 7
s_cselect_b32 s47, 7, 0
s_sub_u32 s46, s46, s47
s_lshl_b32 s58, s46, 10
s_lshl_b32 s46, s18, 1
s_add_u32 s46, s46, 3
s_cmp_ge_u32 s46, 7
s_cselect_b32 s47, 7, 0
s_sub_u32 s46, s46, s47
s_lshl_b32 s59, s46, 10
s_lshl_b32 s46, s18, 1
s_add_u32 s46, s46, 4
s_cmp_ge_u32 s46, 7
s_cselect_b32 s47, 7, 0
s_sub_u32 s46, s46, s47
s_lshl_b32 s60, s46, 10
s_lshl_b32 s46, s18, 1
s_add_u32 s46, s46, 5
s_cmp_ge_u32 s46, 7
s_cselect_b32 s47, 7, 0
s_sub_u32 s46, s46, s47
s_lshl_b32 s61, s46, 10
s_lshl_b32 s46, s18, 1
s_add_u32 s46, s46, 6
s_cmp_ge_u32 s46, 7
s_cselect_b32 s47, 7, 0
s_sub_u32 s46, s46, s47
s_lshl_b32 s62, s46, 10
s_mul_i32 s39, s20, 28
s_mul_i32 s34, s18, 7
s_add_u32 s39, s39, s34
s_add_u32 s39, s39, 448
s_add_u32 s32, s39, 0
s_mul_i32 s32, s32, 14336
s_add_u32 s32, s32, 65536
s_lshl_b32 s47, s56, 1
s_add_u32 s47, s47, s32
buffer_load_dwordx4 a[0:3], v0, s[4:7], s47 offen
buffer_load_dwordx4 a[4:7], v0, s[4:7], s47 offen offset:1024
s_lshl_b32 s47, s57, 1
s_add_u32 s47, s47, s32
buffer_load_dwordx4 a[8:11], v0, s[4:7], s47 offen
buffer_load_dwordx4 a[12:15], v0, s[4:7], s47 offen offset:1024
s_lshl_b32 s47, s58, 1
s_add_u32 s47, s47, s32
buffer_load_dwordx4 a[16:19], v0, s[4:7], s47 offen
buffer_load_dwordx4 a[20:23], v0, s[4:7], s47 offen offset:1024
s_lshl_b32 s47, s59, 1
s_add_u32 s47, s47, s32
buffer_load_dwordx4 a[24:27], v0, s[4:7], s47 offen
buffer_load_dwordx4 a[28:31], v0, s[4:7], s47 offen offset:1024
s_lshl_b32 s47, s60, 1
s_add_u32 s47, s47, s32
buffer_load_dwordx4 a[32:35], v0, s[4:7], s47 offen
buffer_load_dwordx4 a[36:39], v0, s[4:7], s47 offen offset:1024
s_lshl_b32 s47, s61, 1
s_add_u32 s47, s47, s32
buffer_load_dwordx4 a[40:43], v0, s[4:7], s47 offen
buffer_load_dwordx4 a[44:47], v0, s[4:7], s47 offen offset:1024
s_lshl_b32 s47, s62, 1
s_add_u32 s47, s47, s32
buffer_load_dwordx4 a[48:51], v0, s[4:7], s47 offen
buffer_load_dwordx4 a[52:55], v0, s[4:7], s47 offen offset:1024
s_add_u32 s32, s39, 1
s_mul_i32 s32, s32, 14336
s_add_u32 s32, s32, 65536
s_lshl_b32 s47, s56, 1
s_add_u32 s47, s47, s32
buffer_load_dwordx4 a[56:59], v0, s[4:7], s47 offen
buffer_load_dwordx4 a[60:63], v0, s[4:7], s47 offen offset:1024
s_lshl_b32 s47, s57, 1
s_add_u32 s47, s47, s32
buffer_load_dwordx4 a[64:67], v0, s[4:7], s47 offen
buffer_load_dwordx4 a[68:71], v0, s[4:7], s47 offen offset:1024
s_lshl_b32 s47, s58, 1
s_add_u32 s47, s47, s32
buffer_load_dwordx4 a[72:75], v0, s[4:7], s47 offen
buffer_load_dwordx4 a[76:79], v0, s[4:7], s47 offen offset:1024
s_lshl_b32 s47, s59, 1
s_add_u32 s47, s47, s32
buffer_load_dwordx4 a[80:83], v0, s[4:7], s47 offen
buffer_load_dwordx4 a[84:87], v0, s[4:7], s47 offen offset:1024
s_lshl_b32 s47, s60, 1
s_add_u32 s47, s47, s32
buffer_load_dwordx4 a[88:91], v0, s[4:7], s47 offen
buffer_load_dwordx4 a[92:95], v0, s[4:7], s47 offen offset:1024
s_lshl_b32 s47, s61, 1
s_add_u32 s47, s47, s32
buffer_load_dwordx4 a[96:99], v0, s[4:7], s47 offen
buffer_load_dwordx4 a[100:103], v0, s[4:7], s47 offen offset:1024
s_lshl_b32 s47, s62, 1
s_add_u32 s47, s47, s32
buffer_load_dwordx4 a[104:107], v0, s[4:7], s47 offen
buffer_load_dwordx4 a[108:111], v0, s[4:7], s47 offen offset:1024
s_add_u32 s32, s39, 2
s_mul_i32 s32, s32, 14336
s_add_u32 s32, s32, 65536
s_lshl_b32 s47, s56, 1
s_add_u32 s47, s47, s32
buffer_load_dwordx4 a[112:115], v0, s[4:7], s47 offen
buffer_load_dwordx4 a[116:119], v0, s[4:7], s47 offen offset:1024
s_lshl_b32 s47, s57, 1
s_add_u32 s47, s47, s32
buffer_load_dwordx4 a[120:123], v0, s[4:7], s47 offen
buffer_load_dwordx4 a[124:127], v0, s[4:7], s47 offen offset:1024
s_lshl_b32 s47, s58, 1
s_add_u32 s47, s47, s32
buffer_load_dwordx4 a[128:131], v0, s[4:7], s47 offen
buffer_load_dwordx4 a[132:135], v0, s[4:7], s47 offen offset:1024
s_lshl_b32 s47, s59, 1
s_add_u32 s47, s47, s32
buffer_load_dwordx4 a[136:139], v0, s[4:7], s47 offen
buffer_load_dwordx4 a[140:143], v0, s[4:7], s47 offen offset:1024
s_lshl_b32 s47, s60, 1
s_add_u32 s47, s47, s32
buffer_load_dwordx4 a[144:147], v0, s[4:7], s47 offen
buffer_load_dwordx4 a[148:151], v0, s[4:7], s47 offen offset:1024
s_lshl_b32 s47, s61, 1
s_add_u32 s47, s47, s32
buffer_load_dwordx4 a[152:155], v0, s[4:7], s47 offen
buffer_load_dwordx4 a[156:159], v0, s[4:7], s47 offen offset:1024
s_lshl_b32 s47, s62, 1
s_add_u32 s47, s47, s32
buffer_load_dwordx4 a[160:163], v0, s[4:7], s47 offen
buffer_load_dwordx4 a[164:167], v0, s[4:7], s47 offen offset:1024
s_add_u32 s32, s39, 3
s_mul_i32 s32, s32, 14336
s_add_u32 s32, s32, 65536
s_lshl_b32 s47, s56, 1
s_add_u32 s47, s47, s32
buffer_load_dwordx4 a[168:171], v0, s[4:7], s47 offen
buffer_load_dwordx4 a[172:175], v0, s[4:7], s47 offen offset:1024
s_lshl_b32 s47, s57, 1
s_add_u32 s47, s47, s32
buffer_load_dwordx4 a[176:179], v0, s[4:7], s47 offen
buffer_load_dwordx4 a[180:183], v0, s[4:7], s47 offen offset:1024
s_lshl_b32 s47, s58, 1
s_add_u32 s47, s47, s32
buffer_load_dwordx4 a[184:187], v0, s[4:7], s47 offen
buffer_load_dwordx4 a[188:191], v0, s[4:7], s47 offen offset:1024
s_lshl_b32 s47, s59, 1
s_add_u32 s47, s47, s32
buffer_load_dwordx4 a[192:195], v0, s[4:7], s47 offen
buffer_load_dwordx4 a[196:199], v0, s[4:7], s47 offen offset:1024
s_lshl_b32 s47, s60, 1
s_add_u32 s47, s47, s32
buffer_load_dwordx4 a[200:203], v0, s[4:7], s47 offen
buffer_load_dwordx4 a[204:207], v0, s[4:7], s47 offen offset:1024
s_lshl_b32 s47, s61, 1
s_add_u32 s47, s47, s32
buffer_load_dwordx4 a[208:211], v0, s[4:7], s47 offen
buffer_load_dwordx4 a[212:215], v0, s[4:7], s47 offen offset:1024
s_lshl_b32 s47, s62, 1
s_add_u32 s47, s47, s32
buffer_load_dwordx4 a[216:219], v0, s[4:7], s47 offen
buffer_load_dwordx4 a[220:223], v0, s[4:7], s47 offen offset:1024
s_add_u32 s32, s39, 4
s_mul_i32 s32, s32, 14336
s_add_u32 s32, s32, 65536
s_lshl_b32 s47, s56, 1
s_add_u32 s47, s47, s32
buffer_load_dwordx4 a[224:227], v0, s[4:7], s47 offen
buffer_load_dwordx4 a[228:231], v0, s[4:7], s47 offen offset:1024
s_lshl_b32 s47, s57, 1
s_add_u32 s47, s47, s32
buffer_load_dwordx4 a[232:235], v0, s[4:7], s47 offen
buffer_load_dwordx4 a[236:239], v0, s[4:7], s47 offen offset:1024
s_lshl_b32 s47, s58, 1
s_add_u32 s47, s47, s32
buffer_load_dwordx4 a[240:243], v0, s[4:7], s47 offen
buffer_load_dwordx4 a[244:247], v0, s[4:7], s47 offen offset:1024
s_lshl_b32 s47, s59, 1
s_add_u32 s47, s47, s32
buffer_load_dwordx4 a[248:251], v0, s[4:7], s47 offen
buffer_load_dwordx4 a[252:255], v0, s[4:7], s47 offen offset:1024
s_lshl_b32 s47, s60, 1
s_add_u32 s47, s47, s32
buffer_load_dwordx4 v[120:123], v0, s[4:7], s47 offen
buffer_load_dwordx4 v[124:127], v0, s[4:7], s47 offen offset:1024
s_lshl_b32 s47, s61, 1
s_add_u32 s47, s47, s32
buffer_load_dwordx4 v[128:131], v0, s[4:7], s47 offen
buffer_load_dwordx4 v[132:135], v0, s[4:7], s47 offen offset:1024
s_lshl_b32 s47, s62, 1
s_add_u32 s47, s47, s32
buffer_load_dwordx4 v[136:139], v0, s[4:7], s47 offen
buffer_load_dwordx4 v[140:143], v0, s[4:7], s47 offen offset:1024
s_add_u32 s32, s39, 5
s_mul_i32 s32, s32, 14336
s_add_u32 s32, s32, 65536
s_lshl_b32 s47, s56, 1
s_add_u32 s47, s47, s32
buffer_load_dwordx4 v[144:147], v0, s[4:7], s47 offen
buffer_load_dwordx4 v[148:151], v0, s[4:7], s47 offen offset:1024
s_lshl_b32 s47, s57, 1
s_add_u32 s47, s47, s32
buffer_load_dwordx4 v[152:155], v0, s[4:7], s47 offen
buffer_load_dwordx4 v[156:159], v0, s[4:7], s47 offen offset:1024
s_lshl_b32 s47, s58, 1
s_add_u32 s47, s47, s32
buffer_load_dwordx4 v[160:163], v0, s[4:7], s47 offen
buffer_load_dwordx4 v[164:167], v0, s[4:7], s47 offen offset:1024
s_lshl_b32 s47, s59, 1
s_add_u32 s47, s47, s32
buffer_load_dwordx4 v[168:171], v0, s[4:7], s47 offen
buffer_load_dwordx4 v[172:175], v0, s[4:7], s47 offen offset:1024
s_lshl_b32 s47, s60, 1
s_add_u32 s47, s47, s32
buffer_load_dwordx4 v[176:179], v0, s[4:7], s47 offen
buffer_load_dwordx4 v[180:183], v0, s[4:7], s47 offen offset:1024
s_lshl_b32 s47, s61, 1
s_add_u32 s47, s47, s32
buffer_load_dwordx4 v[184:187], v0, s[4:7], s47 offen
buffer_load_dwordx4 v[188:191], v0, s[4:7], s47 offen offset:1024
s_lshl_b32 s47, s62, 1
s_add_u32 s47, s47, s32
buffer_load_dwordx4 v[192:195], v0, s[4:7], s47 offen
buffer_load_dwordx4 v[196:199], v0, s[4:7], s47 offen offset:1024
s_add_u32 s32, s39, 6
s_mul_i32 s32, s32, 14336
s_add_u32 s32, s32, 65536
s_lshl_b32 s47, s56, 1
s_add_u32 s47, s47, s32
buffer_load_dwordx4 v[200:203], v0, s[4:7], s47 offen
buffer_load_dwordx4 v[204:207], v0, s[4:7], s47 offen offset:1024
s_lshl_b32 s47, s57, 1
s_add_u32 s47, s47, s32
buffer_load_dwordx4 v[208:211], v0, s[4:7], s47 offen
buffer_load_dwordx4 v[212:215], v0, s[4:7], s47 offen offset:1024
s_lshl_b32 s47, s58, 1
s_add_u32 s47, s47, s32
buffer_load_dwordx4 v[216:219], v0, s[4:7], s47 offen
buffer_load_dwordx4 v[220:223], v0, s[4:7], s47 offen offset:1024
s_lshl_b32 s47, s59, 1
s_add_u32 s47, s47, s32
buffer_load_dwordx4 v[224:227], v0, s[4:7], s47 offen
buffer_load_dwordx4 v[228:231], v0, s[4:7], s47 offen offset:1024
s_lshl_b32 s47, s60, 1
s_add_u32 s47, s47, s32
buffer_load_dwordx4 v[232:235], v0, s[4:7], s47 offen
buffer_load_dwordx4 v[236:239], v0, s[4:7], s47 offen offset:1024
s_lshl_b32 s47, s61, 1
s_add_u32 s47, s47, s32
buffer_load_dwordx4 v[240:243], v0, s[4:7], s47 offen
buffer_load_dwordx4 v[244:247], v0, s[4:7], s47 offen offset:1024
s_lshl_b32 s47, s62, 1
s_add_u32 s47, s47, s32
buffer_load_dwordx4 v[248:251], v0, s[4:7], s47 offen
buffer_load_dwordx4 v[252:255], v0, s[4:7], s47 offen offset:1024
v_mov_b32 v1, 0x4444
v_mov_b32 v21, 0xeeee
v_cmp_gt_u32 vcc, 8, v17
s_nop 1
v_cndmask_b32 v1, v21, v1, vcc
s_mul_i32 s33, s18, 3584
s_add_u32 s33, s33, 16384
v_lshlrev_b32 v21, 5, v17
v_lshl_add_u32 v22, v18, 3, v21
v_add_u32 v2, s33, v22
v_lshrrev_b32 v22, 1, v18
v_mul_u32_u24 v23, 896, v22
v_add_u32 v23, v23, v21
v_and_b32 v24, 1, v18
v_lshl_add_u32 v23, v24, 4, v23
v_add_u32 v3, s33, v23
v_lshlrev_b32 v23, 5, v26
v_mul_u32_u24 v28, 896, v27
v_add_u32 v23, v23, v28
v_add_u32 v13, s33, v23
v_xor_b32 v13, 0xC000, v13
s_mul_i32 s33, s18, 7168
s_add_u32 s33, s33, 65536
v_mul_u32_u24 v23, 448, v18
v_lshl_add_u32 v23, v17, 4, v23
v_add_u32 v4, s33, v23
v_mul_u32_u24 v23, 448, v27
v_lshl_add_u32 v23, v26, 4, v23
v_add_u32 v12, s33, v23
s_mul_i32 s33, s18, 2560
v_lshrrev_b32 v20, 3, v17
v_mul_u32_u24 v23, 640, v20
v_lshl_add_u32 v23, v18, 7, v23
v_lshl_add_u32 v23, v19, 4, v23
v_add_u32 v5, s33, v23
v_lshl_add_u32 v23, v20, 1, v22
v_mul_u32_u24 v23, 640, v23
v_lshl_add_u32 v23, v19, 4, v23
v_add_u32 v23, 512, v23
v_add_u32 v6, s33, v23
s_lshl_b32 s33, s18, 10
s_add_u32 s33, s33, 7168
v_add_u32 v7, s33, v0
v_lshlrev_b32 v24, 4, v26
v_mul_u32_u24 v28, 2560, v27
v_add_u32 v24, v24, v28
v_add_u32 v9, 2048, v24
v_and_b32 v24, 1, v18
v_lshlrev_b32 v25, 10, v24
v_lshl_add_u32 v25, v27, 8, v25
v_lshl_add_u32 v14, v17, 4, v25
s_lshl_b32 s33, s18, 12
s_add_u32 s33, s33, 49152
v_lshlrev_b32 v25, 11, v24
v_lshl_add_u32 v25, v27, 8, v25
v_lshl_add_u32 v25, v17, 4, v25
v_add_u32 v10, s33, v25
v_lshl_add_u32 v21, v20, 2, v18
s_mul_i32 s33, s20, 14
v_lshl_add_u32 v22, v21, 1, s33
v_lshrrev_b32 v24, 3, v22
v_lshlrev_b32 v24, 8, v24
v_and_b32 v25, 7, v22
v_lshrrev_b32 v25, 1, v25
v_lshl_add_u32 v24, v25, 2, v24
v_lshl_add_u32 v8, v19, 4, v24
s_and_b32 s33, s18, 1
s_lshl_b32 s33, s33, 2
v_add_u32 v21, s33, v18
s_mul_i32 s34, s20, 28
v_lshl_add_u32 v22, v21, 2, s34
v_lshrrev_b32 v23, 3, v22
v_lshlrev_b32 v23, 9, v23
v_and_b32 v24, 4, v22
v_lshl_add_u32 v23, v24, 1, v23
s_lshr_b32 s33, s18, 1
s_lshl_b32 s33, s33, 8
v_lshl_add_u32 v23, v17, 4, v23
v_add_u32 v11, s33, v23
v_cmp_gt_u32 s[54:55], 7, v21
s_mov_b32 s52, -1
s_mov_b32 s53, 0x00ffffff
s_mul_i32 s22, s19, 466944
s_add_u32 s22, s22, 33038336
s_mul_i32 s24, s19, 655360
s_add_u32 s24, s24, 33972224
s_mul_i32 s25, s19, 2621440
s_add_u32 s25, s25, 35282944
s_mul_i32 s26, s19, 29360128
s_add_u32 s26, s26, 99246080
s_mul_i32 s46, s20, 28672
s_add_u32 s26, s26, s46
s_mul_i32 s46, s18, 7168
s_add_u32 s26, s26, s46
s_mul_i32 s46, s18, 10240
s_add_u32 s25, s25, s46
s_mul_i32 s27, s19, 3670016
s_add_u32 s28, s27, 23863296
s_add_u32 s27, s27, 22028288
s_mul_i32 s29, s19, 32768
s_add_u32 s29, s29, 157982720
s_mov_b32 s21, 0
s_waitcnt vmcnt(0)
s_mov_b32 s34, 0
s_mov_b32 s63, 0
s_mov_b32 s50, 0
s_cmp_eq_u32 s40, 0
s_cselect_b32 s41, 20000, 0
FW_21:
v_lshrrev_b32 v15, 2, v0
buffer_load_dword v15, v15, s[4:7], s29 offen sc1
s_waitcnt vmcnt(0)
s_mov_b64 exec, s[52:53]
v_cmp_eq_u32 vcc, 0, v15
s_mov_b64 exec, -1
s_cbranch_vccz FWD_22
s_sub_u32 s41, s41, 1
s_cbranch_scc0 FW_21
s_or_b32 s40, s40, 8
FWD_22:
s_mul_i32 s48, s18, 7168
s_mov_b32 s49, s26
s_add_u32 m0, s48, 65536
s_nop 0
buffer_load_dwordx4 v0, s[4:7], s49 offen sc1 lds
buffer_load_dwordx4 v0, s[4:7], s49 offen offset:1024 sc1 lds
buffer_load_dwordx4 v0, s[4:7], s49 offen offset:2048 sc1 lds
buffer_load_dwordx4 v0, s[4:7], s49 offen offset:3072 sc1 lds
s_add_u32 s48, s48, 4096
s_add_u32 s49, s49, 4096
s_add_u32 m0, s48, 65536
s_nop 0
buffer_load_dwordx4 v0, s[4:7], s49 offen sc1 lds
buffer_load_dwordx4 v0, s[4:7], s49 offen offset:1024 sc1 lds
buffer_load_dwordx4 v0, s[4:7], s49 offen offset:2048 sc1 lds
s_mov_b32 s39, 127
s_add_u32 s34, s22, s56
s_add_u32 s35, s22, s57
s_cmp_eq_u32 s40, 0
s_cselect_b32 s41, 20000, 0
POLL_23:
buffer_load_dwordx4 v[64:67], v0, s[4:7], s34 offen sc1
buffer_load_dwordx4 v[68:71], v0, s[4:7], s35 offen sc1
s_waitcnt vmcnt(0)
v_max3_u32 v116, v64, v66, v68
v_max3_u32 v117, v65, v67, v69
v_max_u32 v116, v116, v70
v_max_u32 v117, v117, v71
v_max_u32 v116, v116, v117
v_cmp_eq_u32 vcc, -1, v116
s_nop 0
s_cbranch_vccz PDONE_24
s_sub_u32 s41, s41, 1
s_cbranch_scc0 POLL_23
s_or_b32 s40, s40, 16
PDONE_24:
v_add_u32 v116, s56, v0
v_add_u32 v117, s57, v0
ds_write_b128 v116, v[64:67]
ds_write_b128 v117, v[68:71]
v_mov_b64 v[36:37], 0
v_mov_b64 v[38:39], 0
v_mov_b64 v[40:41], 0
v_mov_b64 v[42:43], 0
v_mov_b64 v[44:45], 0
v_mov_b64 v[46:47], 0
v_mov_b64 v[48:49], 0
v_mov_b64 v[50:51], 0
v_mov_b64 v[52:53], 0
v_mov_b64 v[54:55], 0
v_mov_b64 v[56:57], 0
v_mov_b64 v[58:59], 0
v_mov_b64 v[60:61], 0
v_mov_b64 v[62:63], 0
v_smfmac_f32_16x16x64_bf16 v[36:39], v[64:67], a[0:7], v1
v_add_u32 v16, s58, v0
v_smfmac_f32_16x16x64_bf16 v[40:43], v[64:67], a[56:63], v1
v_add_u32 v20, s59, v0
v_smfmac_f32_16x16x64_bf16 v[44:47], v[64:67], a[112:119], v1
v_add_u32 v24, s60, v0
v_smfmac_f32_16x16x64_bf16 v[48:51], v[64:67], a[168:175], v1
v_add_u32 v28, s61, v0
v_smfmac_f32_16x16x64_bf16 v[52:55], v[64:67], a[224:231], v1
v_add_u32 v32, s62, v0
v_smfmac_f32_16x16x64_bf16 v[56:59], v[64:67], v[144:151], v1
v_smfmac_f32_16x16x64_bf16 v[60:63], v[64:67], v[200:207], v1
s_waitcnt lgkmcnt(0)
s_barrier
v_smfmac_f32_16x16x64_bf16 v[36:39], v[68:71], a[8:15], v1
ds_read_b128 v[16:19], v16
v_smfmac_f32_16x16x64_bf16 v[40:43], v[68:71], a[64:71], v1
ds_read_b128 v[20:23], v20
v_smfmac_f32_16x16x64_bf16 v[44:47], v[68:71], a[120:127], v1
ds_read_b128 v[24:27], v24
v_smfmac_f32_16x16x64_bf16 v[48:51], v[68:71], a[176:183], v1
ds_read_b128 v[28:31], v28
v_smfmac_f32_16x16x64_bf16 v[52:55], v[68:71], a[232:239], v1
ds_read_b128 v[32:35], v32
v_smfmac_f32_16x16x64_bf16 v[56:59], v[68:71], v[152:159], v1
v_smfmac_f32_16x16x64_bf16 v[60:63], v[68:71], v[208:215], v1
s_waitcnt lgkmcnt(4)
v_smfmac_f32_16x16x64_bf16 v[36:39], v[16:19], a[16:23], v1
s_waitcnt lgkmcnt(3)
v_smfmac_f32_16x16x64_bf16 v[36:39], v[20:23], a[24:31], v1
s_waitcnt lgkmcnt(2)
v_smfmac_f32_16x16x64_bf16 v[36:39], v[24:27], a[32:39], v1
s_waitcnt lgkmcnt(1)
v_smfmac_f32_16x16x64_bf16 v[36:39], v[28:31], a[40:47], v1
s_waitcnt lgkmcnt(0)
v_smfmac_f32_16x16x64_bf16 v[36:39], v[32:35], a[48:55], v1
v_smfmac_f32_16x16x64_bf16 v[40:43], v[16:19], a[72:79], v1
v_smfmac_f32_16x16x64_bf16 v[40:43], v[20:23], a[80:87], v1
s_nop 5
v_cvt_pk_bf16_f32 v36, v36, v37
v_cvt_pk_bf16_f32 v37, v38, v39
v_smfmac_f32_16x16x64_bf16 v[40:43], v[24:27], a[88:95], v1
ds_write_b64 v2, v[36:37] offset:0
v_smfmac_f32_16x16x64_bf16 v[40:43], v[28:31], a[96:103], v1
v_smfmac_f32_16x16x64_bf16 v[40:43], v[32:35], a[104:111], v1
v_smfmac_f32_16x16x64_bf16 v[44:47], v[16:19], a[128:135], v1
v_smfmac_f32_16x16x64_bf16 v[44:47], v[20:23], a[136:143], v1
s_nop 5
v_cvt_pk_bf16_f32 v40, v40, v41
v_cvt_pk_bf16_f32 v41, v42, v43
v_smfmac_f32_16x16x64_bf16 v[44:47], v[24:27], a[144:151], v1
ds_write_b64 v2, v[40:41] offset:512
v_smfmac_f32_16x16x64_bf16 v[44:47], v[28:31], a[152:159], v1
v_smfmac_f32_16x16x64_bf16 v[44:47], v[32:35], a[160:167], v1
v_smfmac_f32_16x16x64_bf16 v[48:51], v[16:19], a[184:191], v1
v_smfmac_f32_16x16x64_bf16 v[48:51], v[20:23], a[192:199], v1
s_nop 5
v_cvt_pk_bf16_f32 v44, v44, v45
v_cvt_pk_bf16_f32 v45, v46, v47
v_smfmac_f32_16x16x64_bf16 v[48:51], v[24:27], a[200:207], v1
ds_write_b64 v2, v[44:45] offset:1024
v_smfmac_f32_16x16x64_bf16 v[48:51], v[28:31], a[208:215], v1
v_smfmac_f32_16x16x64_bf16 v[48:51], v[32:35], a[216:223], v1
v_smfmac_f32_16x16x64_bf16 v[52:55], v[16:19], a[240:247], v1
v_smfmac_f32_16x16x64_bf16 v[52:55], v[20:23], a[248:255], v1
s_nop 5
v_cvt_pk_bf16_f32 v48, v48, v49
v_cvt_pk_bf16_f32 v49, v50, v51
v_smfmac_f32_16x16x64_bf16 v[52:55], v[24:27], v[120:127], v1
ds_write_b64 v2, v[48:49] offset:1536
v_smfmac_f32_16x16x64_bf16 v[52:55], v[28:31], v[128:135], v1
v_smfmac_f32_16x16x64_bf16 v[52:55], v[32:35], v[136:143], v1
v_smfmac_f32_16x16x64_bf16 v[56:59], v[16:19], v[160:167], v1
v_smfmac_f32_16x16x64_bf16 v[56:59], v[20:23], v[168:175], v1
s_nop 5
v_cvt_pk_bf16_f32 v52, v52, v53
v_cvt_pk_bf16_f32 v53, v54, v55
v_smfmac_f32_16x16x64_bf16 v[56:59], v[24:27], v[176:183], v1
ds_write_b64 v2, v[52:53] offset:2048
v_smfmac_f32_16x16x64_bf16 v[56:59], v[28:31], v[184:191], v1
v_smfmac_f32_16x16x64_bf16 v[56:59], v[32:35], v[192:199], v1
v_smfmac_f32_16x16x64_bf16 v[60:63], v[16:19], v[216:223], v1
v_smfmac_f32_16x16x64_bf16 v[60:63], v[20:23], v[224:231], v1
s_nop 5
v_cvt_pk_bf16_f32 v56, v56, v57
v_cvt_pk_bf16_f32 v57, v58, v59
v_smfmac_f32_16x16x64_bf16 v[60:63], v[24:27], v[232:239], v1
ds_write_b64 v2, v[56:57] offset:2560
v_smfmac_f32_16x16x64_bf16 v[60:63], v[28:31], v[240:247], v1
v_smfmac_f32_16x16x64_bf16 v[60:63], v[32:35], v[248:255], v1
s_nop 7
v_cvt_pk_bf16_f32 v60, v60, v61
v_cvt_pk_bf16_f32 v61, v62, v63
ds_write_b64 v2, v[60:61] offset:3072
ds_read_b128 v[16:19], v4 offset:0
ds_read_b128 v[20:23], v4 offset:256
ds_read_b128 v[24:27], v4 offset:1792
ds_read_b128 v[28:31], v4 offset:2048
ds_read_b128 v[32:35], v4 offset:3584
ds_read_b128 v[36:39], v4 offset:3840
ds_read_b128 v[40:43], v4 offset:5376
ds_read_b128 v[44:47], v4 offset:5632
ds_read_b128 v[48:51], v3 offset:0
ds_read_b128 v[52:55], v3 offset:512
ds_read_b128 v[56:59], v3 offset:1792
ds_read_b128 v[60:63], v3 offset:2304
s_mov_b32 s75, s24
s_sub_u32 s32, s25, 40960
s_add_u32 s33, s32, 2560
s_add_u32 s30, s32, 5120
s_add_u32 s23, s32, 7680
s_mov_b32 s76, s27
s_sub_u32 s77, s28, 28672
s_add_u32 s78, s26, 917504
s_add_u32 s31, s29, 512
s_mul_i32 s74, s18, 7168
RV_LOOP:
s_mov_b32 s34, s75
s_cmp_eq_u32 s21, 0
s_cbranch_scc1 RV_PMPOLL
s_waitcnt vmcnt(0)
v_max3_u32 v100, v96, v64, v68
v_cmp_eq_u32 vcc, -1, v100
s_nop 0
s_cbranch_vccz RV_PMOK
RV_PMPOLL:
s_cmp_eq_u32 s40, 0
s_cselect_b32 s41, 20000, 0
POLL_25:
buffer_load_dwordx4 v[96:99], v5, s[4:7], s34 offen sc1
buffer_load_dwordx4 v[64:67], v5, s[4:7], s34 offen offset:1280 sc1
buffer_load_dwordx4 v[68:71], v6, s[4:7], s34 offen sc1
s_waitcnt vmcnt(0)
v_max3_u32 v100, v96, v64, v68
v_cmp_eq_u32 vcc, -1, v100
s_nop 0
s_cbranch_vccz PDONE_26
s_sub_u32 s41, s41, 1
s_cbranch_scc0 POLL_25
s_or_b32 s40, s40, 32
PDONE_26:
RV_PMOK:
s_waitcnt lgkmcnt(0)
v_mfma_f32_16x16x32_bf16 v[104:107], v[16:19], v[96:99], 0
v_mfma_f32_16x16x32_bf16 v[108:111], v[20:23], v[96:99], 0
v_mfma_f32_16x16x32_bf16 v[112:115], v[24:27], v[96:99], 0
v_mfma_f32_16x16x32_bf16 v[116:119], v[28:31], v[96:99], 0
v_mfma_f32_16x16x32_bf16 v[104:107], v[32:35], v[64:67], v[104:107]
v_mfma_f32_16x16x32_bf16 v[108:111], v[36:39], v[64:67], v[108:111]
v_mfma_f32_16x16x32_bf16 v[112:115], v[40:43], v[64:67], v[112:115]
v_mfma_f32_16x16x32_bf16 v[116:119], v[44:47], v[64:67], v[116:119]
v_mfma_f32_16x16x32_bf16 v[104:107], v[48:51], v[68:71], v[104:107]
v_mfma_f32_16x16x32_bf16 v[108:111], v[52:55], v[68:71], v[108:111]
v_mfma_f32_16x16x32_bf16 v[112:115], v[56:59], v[68:71], v[112:115]
v_mfma_f32_16x16x32_bf16 v[116:119], v[60:63], v[68:71], v[116:119]
s_add_u32 s36, s63, 28672
s_cmp_ge_u32 s36, 86016
s_cselect_b32 s36, 0, s36
s_add_u32 s37, s21, 2
s_sub_u32 s35, s63, 28672
s_cmp_eq_u32 s63, 0
s_cselect_b32 s35, 57344, s35
v_add_f32_dpp v104, v112, v104 row_shl:8 row_mask:0xf bank_mask:0x3
v_add_f32_dpp v105, v113, v105 row_shl:8 row_mask:0xf bank_mask:0x3
v_add_f32_dpp v106, v114, v106 row_shl:8 row_mask:0xf bank_mask:0x3
v_add_f32_dpp v107, v115, v107 row_shl:8 row_mask:0xf bank_mask:0x3
v_add_f32_dpp v104, v108, v116 row_shr:8 row_mask:0xf bank_mask:0xc
v_add_f32_dpp v105, v109, v117 row_shr:8 row_mask:0xf bank_mask:0xc
v_add_f32_dpp v106, v110, v118 row_shr:8 row_mask:0xf bank_mask:0xc
v_add_f32_dpp v107, v111, v119 row_shr:8 row_mask:0xf bank_mask:0xc
ds_write_b128 v7, v[104:107]
s_add_u32 s34, s22, 7168
s_add_u32 s48, s74, s35
s_mov_b32 s49, s78
s_waitcnt lgkmcnt(0)
s_barrier
s_cmp_eq_u32 s18, 0
s_cbranch_scc0 RV_X
ds_read_b128 v[16:19], v0 offset:7168
ds_read_b128 v[20:23], v0 offset:8192
ds_read_b128 v[24:27], v0 offset:9216
ds_read_b128 v[28:31], v0 offset:10240
s_waitcnt lgkmcnt(2)
v_pk_add_f32 v[16:17], v[16:17], v[20:21]
v_pk_add_f32 v[18:19], v[18:19], v[22:23]
s_waitcnt lgkmcnt(0)
v_pk_add_f32 v[24:25], v[24:25], v[28:29]
v_pk_add_f32 v[26:27], v[26:27], v[30:31]
v_pk_add_f32 v[16:17], v[16:17], v[24:25]
v_pk_add_f32 v[18:19], v[18:19], v[26:27]
v_cvt_pk_bf16_f32 v20, v16, v17
v_cvt_pk_bf16_f32 v21, v18, v19
s_mov_b64 exec, s[52:53]
buffer_store_dword v20, v8, s[4:7], s34 offen
buffer_store_dword v21, v8, s[4:7], s34 offen offset:128
s_mov_b64 exec, -1
RV_X:
s_barrier
s_add_u32 s22, s22, 7168
s_add_u32 s34, s22, s56
s_add_u32 s35, s22, s57
s_cmp_eq_u32 s21, 0
s_cbranch_scc1 RV_FIRST
buffer_load_dwordx4 v[32:35], v14, s[4:7], s23 offen sc1
buffer_load_dwordx4 v[36:39], v14, s[4:7], s23 offen offset:512 sc1
buffer_load_dwordx4 v[40:43], v9, s[4:7], s32 offen sc1
buffer_load_dwordx4 v[44:47], v9, s[4:7], s30 offen sc1
ds_read_b128 v[48:51], v12 offset:0
ds_read_b128 v[52:55], v12 offset:896
ds_read_b128 v[56:59], v12 offset:1792
ds_read_b128 v[60:63], v12 offset:2688
ds_read_b128 v[96:99], v12 offset:3584
ds_read_b128 v[104:107], v12 offset:4480
v_max3_u32 v116, v72, v76, v80
v_max3_u32 v117, v84, v88, v92
s_waitcnt lgkmcnt(5)
v_mfma_f32_32x32x16_bf16 v[16:31], v[48:51], v[72:75], 0
ds_read_b128 v[108:111], v12 offset:5376
s_waitcnt lgkmcnt(5)
v_mfma_f32_32x32x16_bf16 v[16:31], v[52:55], v[76:79], v[16:31]
ds_read_b128 v[112:115], v12 offset:6272
s_waitcnt lgkmcnt(5)
v_mfma_f32_32x32x16_bf16 v[16:31], v[56:59], v[80:83], v[16:31]
ds_read_b128 v[48:51], v13 offset:0
s_waitcnt lgkmcnt(5)
v_mfma_f32_32x32x16_bf16 v[16:31], v[60:63], v[84:87], v[16:31]
ds_read_b128 v[52:55], v13 offset:16
s_waitcnt lgkmcnt(5)
v_mfma_f32_32x32x16_bf16 v[16:31], v[96:99], v[88:91], v[16:31]
ds_read_b128 v[56:59], v13 offset:1792
s_waitcnt lgkmcnt(5)
v_mfma_f32_32x32x16_bf16 v[16:31], v[104:107], v[92:95], v[16:31]
ds_read_b128 v[60:63], v13 offset:1808
buffer_load_dwordx4 v[64:67], v0, s[4:7], s34 offen sc1
s_waitcnt vmcnt(4)
v_max_u32 v116, v116, v32
s_waitcnt lgkmcnt(5)
v_mfma_f32_32x32x16_bf16 v[16:31], v[108:111], v[32:35], v[16:31]
s_waitcnt vmcnt(3)
v_max_u32 v116, v116, v36
s_waitcnt lgkmcnt(4)
v_mfma_f32_32x32x16_bf16 v[16:31], v[112:115], v[36:39], v[16:31]
buffer_load_dwordx4 v[68:71], v0, s[4:7], s35 offen sc1
s_waitcnt vmcnt(3)
v_max_u32 v116, v116, v40
s_waitcnt lgkmcnt(3)
v_mfma_f32_32x32x16_bf16 v[16:31], v[48:51], v[40:43], v[16:31]
s_waitcnt lgkmcnt(2)
v_mfma_f32_32x32x16_bf16 v[16:31], v[52:55], v[40:43], v[16:31]
s_waitcnt vmcnt(2)
v_max_u32 v116, v116, v44
s_waitcnt lgkmcnt(1)
v_mfma_f32_32x32x16_bf16 v[16:31], v[56:59], v[44:47], v[16:31]
s_waitcnt lgkmcnt(0)
v_mfma_f32_32x32x16_bf16 v[16:31], v[60:63], v[44:47], v[16:31]
v_max_u32 v116, v116, v117
v_cmp_eq_u32 vcc, -1, v116
s_nop 0
s_cbranch_vccz RV_PXOK
s_cmp_eq_u32 s40, 0
s_cselect_b32 s41, 20000, 0
POLL_27:
buffer_load_dwordx4 v[72:75], v14, s[4:7], s32 offen sc1
buffer_load_dwordx4 v[76:79], v14, s[4:7], s32 offen offset:512 sc1
buffer_load_dwordx4 v[80:83], v14, s[4:7], s33 offen sc1
buffer_load_dwordx4 v[84:87], v14, s[4:7], s33 offen offset:512 sc1
buffer_load_dwordx4 v[88:91], v14, s[4:7], s30 offen sc1
buffer_load_dwordx4 v[92:95], v14, s[4:7], s30 offen offset:512 sc1
buffer_load_dwordx4 v[32:35], v14, s[4:7], s23 offen sc1
buffer_load_dwordx4 v[36:39], v14, s[4:7], s23 offen offset:512 sc1
buffer_load_dwordx4 v[40:43], v9, s[4:7], s32 offen sc1
buffer_load_dwordx4 v[44:47], v9, s[4:7], s30 offen sc1
s_waitcnt vmcnt(0)
v_max3_u32 v116, v72, v80, v88
v_max3_u32 v117, v76, v84, v92
v_max3_u32 v116, v116, v32, v40
v_max3_u32 v117, v117, v36, v44
v_max_u32 v116, v116, v117
v_cmp_eq_u32 vcc, -1, v116
s_nop 0
s_cbranch_vccz PDONE_28
s_sub_u32 s41, s41, 1
s_cbranch_scc0 POLL_27
s_or_b32 s40, s40, 64
PDONE_28:
ds_read_b128 v[48:51], v12 offset:0
s_waitcnt lgkmcnt(0)
v_mfma_f32_32x32x16_bf16 v[16:31], v[48:51], v[72:75], 0
s_nop 3
ds_read_b128 v[48:51], v12 offset:896
s_waitcnt lgkmcnt(0)
v_mfma_f32_32x32x16_bf16 v[16:31], v[48:51], v[76:79], v[16:31]
s_nop 3
ds_read_b128 v[48:51], v12 offset:1792
s_waitcnt lgkmcnt(0)
v_mfma_f32_32x32x16_bf16 v[16:31], v[48:51], v[80:83], v[16:31]
s_nop 3
ds_read_b128 v[48:51], v12 offset:2688
s_waitcnt lgkmcnt(0)
v_mfma_f32_32x32x16_bf16 v[16:31], v[48:51], v[84:87], v[16:31]
s_nop 3
ds_read_b128 v[48:51], v12 offset:3584
s_waitcnt lgkmcnt(0)
v_mfma_f32_32x32x16_bf16 v[16:31], v[48:51], v[88:91], v[16:31]
s_nop 3
ds_read_b128 v[48:51], v12 offset:4480
s_waitcnt lgkmcnt(0)
v_mfma_f32_32x32x16_bf16 v[16:31], v[48:51], v[92:95], v[16:31]
s_nop 3
ds_read_b128 v[48:51], v12 offset:5376
s_waitcnt lgkmcnt(0)
v_mfma_f32_32x32x16_bf16 v[16:31], v[48:51], v[32:35], v[16:31]
s_nop 3
ds_read_b128 v[48:51], v12 offset:6272
s_waitcnt lgkmcnt(0)
v_mfma_f32_32x32x16_bf16 v[16:31], v[48:51], v[36:39], v[16:31]
s_nop 3
ds_read_b128 v[48:51], v13 offset:0
s_waitcnt lgkmcnt(0)
v_mfma_f32_32x32x16_bf16 v[16:31], v[48:51], v[40:43], v[16:31]
s_nop 3
ds_read_b128 v[48:51], v13 offset:16
s_waitcnt lgkmcnt(0)
v_mfma_f32_32x32x16_bf16 v[16:31], v[48:51], v[40:43], v[16:31]
s_nop 3
ds_read_b128 v[48:51], v13 offset:1792
s_waitcnt lgkmcnt(0)
v_mfma_f32_32x32x16_bf16 v[16:31], v[48:51], v[44:47], v[16:31]
s_nop 3
ds_read_b128 v[48:51], v13 offset:1808
s_waitcnt lgkmcnt(0)
v_mfma_f32_32x32x16_bf16 v[16:31], v[48:51], v[44:47], v[16:31]
s_nop 3
RV_PXOK:
s_nop 7
ds_write_b128 v10, v[16:19] offset:0
ds_write_b128 v10, v[20:23] offset:512
ds_write_b128 v10, v[24:27] offset:1024
ds_write_b128 v10, v[28:31] offset:1536
s_mov_b32 s38, s77
s_branch RV_XDONE
RV_FIRST:
buffer_load_dwordx4 v[64:67], v0, s[4:7], s34 offen sc1
buffer_load_dwordx4 v[68:71], v0, s[4:7], s35 offen sc1
s_add_u32 s38, s29, 256
s_cmp_eq_u32 s40, 0
s_cselect_b32 s41, 20000, 0
FW_29:
v_lshrrev_b32 v15, 2, v0
buffer_load_dword v15, v15, s[4:7], s38 offen sc1
s_waitcnt vmcnt(0)
s_mov_b64 exec, s[52:53]
v_cmp_eq_u32 vcc, 0, v15
s_mov_b64 exec, -1
s_cbranch_vccz FWD_30
s_sub_u32 s41, s41, 1
s_cbranch_scc0 FW_29
s_or_b32 s40, s40, 8
FWD_30:
s_mul_i32 s72, s18, 7168
s_add_u32 s72, s72, 28672
s_add_u32 s73, s26, 458752
s_add_u32 m0, s72, 65536
s_nop 0
buffer_load_dwordx4 v0, s[4:7], s73 offen sc1 lds
buffer_load_dwordx4 v0, s[4:7], s73 offen offset:1024 sc1 lds
buffer_load_dwordx4 v0, s[4:7], s73 offen offset:2048 sc1 lds
buffer_load_dwordx4 v0, s[4:7], s73 offen offset:3072 sc1 lds
s_add_u32 s72, s72, 4096
s_add_u32 s73, s73, 4096
s_add_u32 m0, s72, 65536
s_nop 0
buffer_load_dwordx4 v0, s[4:7], s73 offen sc1 lds
buffer_load_dwordx4 v0, s[4:7], s73 offen offset:1024 sc1 lds
buffer_load_dwordx4 v0, s[4:7], s73 offen offset:2048 sc1 lds
v_lshrrev_b32 v15, 2, v0
buffer_load_dword v15, v15, s[4:7], s31 offen sc1
s_waitcnt vmcnt(0)
s_mov_b32 s38, 162258944
RV_XDONE:
s_sub_u32 s39, s36, s63
v_add_u32 v4, s39, v4
s_sub_u32 s39, s63, s50
v_add_u32 v12, s39, v12
s_mov_b32 s50, s63
s_mov_b32 s63, s36
v_xor_b32 v2, 0xC000, v2
v_xor_b32 v3, 0xC000, v3
v_xor_b32 v13, 0xC000, v13
s_cmp_eq_u32 s21, 63
s_cbranch_scc1 RV_LAST
s_add_u32 s32, s32, 40960
s_add_u32 s33, s33, 40960
s_add_u32 s30, s30, 40960
s_add_u32 s23, s23, 40960
s_mov_b32 s51, s76
s_add_u32 s76, s76, 28672
s_add_u32 s77, s77, 28672
s_waitcnt vmcnt(0)
v_max3_u32 v116, v64, v66, v68
v_max3_u32 v117, v65, v67, v69
v_max_u32 v116, v116, v70
v_max_u32 v117, v117, v71
v_max_u32 v116, v116, v117
v_cmp_eq_u32 vcc, -1, v116
s_nop 0
s_cbranch_vccz RV_MEMOK
s_add_u32 s34, s22, s56
s_add_u32 s35, s22, s57
s_cmp_eq_u32 s40, 0
s_cselect_b32 s41, 20000, 0
POLL_31:
buffer_load_dwordx4 v[64:67], v0, s[4:7], s34 offen sc1
buffer_load_dwordx4 v[68:71], v0, s[4:7], s35 offen sc1
s_waitcnt vmcnt(0)
v_max3_u32 v116, v64, v66, v68
v_max3_u32 v117, v65, v67, v69
v_max_u32 v116, v116, v70
v_max_u32 v117, v117, v71
v_max_u32 v116, v116, v117
v_cmp_eq_u32 vcc, -1, v116
s_nop 0
s_cbranch_vccz PDONE_32
s_sub_u32 s41, s41, 1
s_cbranch_scc0 POLL_31
s_or_b32 s40, s40, 16
PDONE_32:
RV_MEMOK:
s_cmp_ge_u32 s37, 64
s_cbranch_scc1 RV_CNTOK
s_mov_b64 exec, s[52:53]
v_cmp_eq_u32 vcc, 0, v15
s_mov_b64 exec, -1
s_cbranch_vccz FC_33
s_cmp_eq_u32 s40, 0
s_cselect_b32 s41, 20000, 0
FW_34:
v_lshrrev_b32 v15, 2, v0
buffer_load_dword v15, v15, s[4:7], s31 offen sc1
s_waitcnt vmcnt(0)
s_mov_b64 exec, s[52:53]
v_cmp_eq_u32 vcc, 0, v15
s_mov_b64 exec, -1
s_cbranch_vccz FWD_35
s_sub_u32 s41, s41, 1
s_cbranch_scc0 FW_34
s_or_b32 s40, s40, 8
FWD_35:
FC_33:
RV_CNTOK:
s_add_u32 s31, s31, 256
s_add_u32 s75, s75, 10240
s_mov_b32 s39, s75
s_add_u32 s78, s78, 458752
v_add_u32 v116, s56, v0
v_add_u32 v117, s57, v0
ds_write_b128 v116, v[64:67]
ds_write_b128 v117, v[68:71]
v_mov_b64 v[36:37], 0
v_mov_b64 v[38:39], 0
v_mov_b64 v[40:41], 0
v_mov_b64 v[42:43], 0
v_mov_b64 v[44:45], 0
v_mov_b64 v[46:47], 0
v_mov_b64 v[48:49], 0
v_mov_b64 v[50:51], 0
v_mov_b64 v[52:53], 0
v_mov_b64 v[54:55], 0
v_mov_b64 v[56:57], 0
v_mov_b64 v[58:59], 0
v_mov_b64 v[60:61], 0
v_mov_b64 v[62:63], 0
v_smfmac_f32_16x16x64_bf16 v[36:39], v[64:67], a[0:7], v1
v_add_u32 v16, s58, v0
v_smfmac_f32_16x16x64_bf16 v[40:43], v[64:67], a[56:63], v1
v_add_u32 v20, s59, v0
v_smfmac_f32_16x16x64_bf16 v[44:47], v[64:67], a[112:119], v1
v_add_u32 v24, s60, v0
v_smfmac_f32_16x16x64_bf16 v[48:51], v[64:67], a[168:175], v1
v_add_u32 v28, s61, v0
v_smfmac_f32_16x16x64_bf16 v[52:55], v[64:67], a[224:231], v1
v_add_u32 v32, s62, v0
v_smfmac_f32_16x16x64_bf16 v[56:59], v[64:67], v[144:151], v1
v_smfmac_f32_16x16x64_bf16 v[60:63], v[64:67], v[200:207], v1
s_waitcnt lgkmcnt(0)
s_barrier
v_smfmac_f32_16x16x64_bf16 v[36:39], v[68:71], a[8:15], v1
ds_read_b128 v[16:19], v16
v_lshrrev_b32 v15, 2, v0
buffer_load_dword v15, v15, s[4:7], s31 offen sc1
v_smfmac_f32_16x16x64_bf16 v[40:43], v[68:71], a[64:71], v1
ds_read_b128 v[20:23], v20
s_add_u32 m0, s48, 65536
s_nop 0
buffer_load_dwordx4 v0, s[4:7], s49 offen sc1 lds
v_smfmac_f32_16x16x64_bf16 v[44:47], v[68:71], a[120:127], v1
ds_read_b128 v[24:27], v24
buffer_load_dwordx4 v0, s[4:7], s49 offen offset:1024 sc1 lds
v_smfmac_f32_16x16x64_bf16 v[48:51], v[68:71], a[176:183], v1
ds_read_b128 v[28:31], v28
ds_read_b128 v[104:107], v7 offset:41984
buffer_load_dwordx4 v0, s[4:7], s49 offen offset:2048 sc1 lds
v_smfmac_f32_16x16x64_bf16 v[52:55], v[68:71], a[232:239], v1
ds_read_b128 v[32:35], v32
ds_read_b128 v[108:111], v7 offset:46080
v_smfmac_f32_16x16x64_bf16 v[56:59], v[68:71], v[152:159], v1
ds_read_b128 v[112:115], v7 offset:50176
buffer_load_dwordx4 v0, s[4:7], s49 offen offset:3072 sc1 lds
v_smfmac_f32_16x16x64_bf16 v[60:63], v[68:71], v[208:215], v1
ds_read_b128 v[116:119], v7 offset:54272
s_waitcnt lgkmcnt(8)
v_smfmac_f32_16x16x64_bf16 v[36:39], v[16:19], a[16:23], v1
s_add_u32 s48, s48, 4096
s_add_u32 s49, s49, 4096
s_add_u32 m0, s48, 65536
s_nop 0
buffer_load_dwordx4 v0, s[4:7], s49 offen sc1 lds
s_waitcnt lgkmcnt(7)
v_smfmac_f32_16x16x64_bf16 v[36:39], v[20:23], a[24:31], v1
s_waitcnt lgkmcnt(0)
v_add_f32 v104, v104, v108
s_waitcnt lgkmcnt(6)
v_smfmac_f32_16x16x64_bf16 v[36:39], v[24:27], a[32:39], v1
v_add_f32 v105, v105, v109
v_add_f32 v106, v106, v110
buffer_load_dwordx4 v0, s[4:7], s49 offen offset:1024 sc1 lds
s_waitcnt lgkmcnt(5)
v_smfmac_f32_16x16x64_bf16 v[36:39], v[28:31], a[40:47], v1
v_add_f32 v107, v107, v111
v_add_f32 v112, v112, v116
s_waitcnt lgkmcnt(3)
v_smfmac_f32_16x16x64_bf16 v[36:39], v[32:35], a[48:55], v1
v_add_f32 v113, v113, v117
v_add_f32 v114, v114, v118
buffer_load_dwordx4 v0, s[4:7], s49 offen offset:2048 sc1 lds
v_smfmac_f32_16x16x64_bf16 v[40:43], v[16:19], a[72:79], v1
v_add_f32 v115, v115, v119
v_lshlrev_b32 v108, 16, v102
v_and_b32 v109, 0xffff0000, v102
v_smfmac_f32_16x16x64_bf16 v[40:43], v[20:23], a[80:87], v1
v_lshlrev_b32 v110, 16, v103
v_and_b32 v111, 0xffff0000, v103
v_cvt_pk_bf16_f32 v36, v36, v37
v_cvt_pk_bf16_f32 v37, v38, v39
v_smfmac_f32_16x16x64_bf16 v[40:43], v[24:27], a[88:95], v1
v_add_f32 v104, v104, v112
v_add_f32 v105, v105, v113
buffer_load_dwordx2 v[102:103], v11, s[4:7], s51 offen sc1
ds_write_b64 v2, v[36:37] offset:0
v_smfmac_f32_16x16x64_bf16 v[40:43], v[28:31], a[96:103], v1
v_add_f32 v106, v106, v114
v_add_f32 v107, v107, v115
v_smfmac_f32_16x16x64_bf16 v[40:43], v[32:35], a[104:111], v1
v_add_f32 v104, v104, v108
v_add_f32 v105, v105, v109
v_add_f32 v106, v106, v110
v_smfmac_f32_16x16x64_bf16 v[44:47], v[16:19], a[128:135], v1
v_add_f32 v107, v107, v111
v_cvt_pk_bf16_f32 v108, v104, v105
v_cvt_pk_bf16_f32 v109, v106, v107
v_smfmac_f32_16x16x64_bf16 v[44:47], v[20:23], a[136:143], v1
s_mov_b64 exec, s[54:55]
buffer_store_dwordx2 v[108:109], v11, s[4:7], s38 offen sc1
s_mov_b64 exec, -1
v_cvt_pk_bf16_f32 v40, v40, v41
v_cvt_pk_bf16_f32 v41, v42, v43
v_smfmac_f32_16x16x64_bf16 v[44:47], v[24:27], a[144:151], v1
ds_write_b64 v2, v[40:41] offset:512
v_smfmac_f32_16x16x64_bf16 v[44:47], v[28:31], a[152:159], v1
buffer_load_dwordx4 v[72:75], v14, s[4:7], s32 offen sc1
v_smfmac_f32_16x16x64_bf16 v[44:47], v[32:35], a[160:167], v1
v_smfmac_f32_16x16x64_bf16 v[48:51], v[16:19], a[184:191], v1
buffer_load_dwordx4 v[76:79], v14, s[4:7], s32 offen offset:512 sc1
v_smfmac_f32_16x16x64_bf16 v[48:51], v[20:23], a[192:199], v1
s_nop 4
v_cvt_pk_bf16_f32 v44, v44, v45
v_cvt_pk_bf16_f32 v45, v46, v47
v_smfmac_f32_16x16x64_bf16 v[48:51], v[24:27], a[200:207], v1
buffer_load_dwordx4 v[80:83], v14, s[4:7], s33 offen sc1
ds_write_b64 v2, v[44:45] offset:1024
v_smfmac_f32_16x16x64_bf16 v[48:51], v[28:31], a[208:215], v1
v_smfmac_f32_16x16x64_bf16 v[48:51], v[32:35], a[216:223], v1
buffer_load_dwordx4 v[84:87], v14, s[4:7], s33 offen offset:512 sc1
v_smfmac_f32_16x16x64_bf16 v[52:55], v[16:19], a[240:247], v1
v_smfmac_f32_16x16x64_bf16 v[52:55], v[20:23], a[248:255], v1
buffer_load_dwordx4 v[88:91], v14, s[4:7], s30 offen sc1
s_nop 3
v_cvt_pk_bf16_f32 v48, v48, v49
v_cvt_pk_bf16_f32 v49, v50, v51
v_smfmac_f32_16x16x64_bf16 v[52:55], v[24:27], v[120:127], v1
ds_write_b64 v2, v[48:49] offset:1536
v_smfmac_f32_16x16x64_bf16 v[52:55], v[28:31], v[128:135], v1
buffer_load_dwordx4 v[92:95], v14, s[4:7], s30 offen offset:512 sc1
v_smfmac_f32_16x16x64_bf16 v[52:55], v[32:35], v[136:143], v1
v_smfmac_f32_16x16x64_bf16 v[56:59], v[16:19], v[160:167], v1
v_smfmac_f32_16x16x64_bf16 v[56:59], v[20:23], v[168:175], v1
buffer_load_dwordx4 v[96:99], v5, s[4:7], s39 offen sc1
s_nop 4
v_cvt_pk_bf16_f32 v52, v52, v53
v_cvt_pk_bf16_f32 v53, v54, v55
v_smfmac_f32_16x16x64_bf16 v[56:59], v[24:27], v[176:183], v1
ds_write_b64 v2, v[52:53] offset:2048
v_smfmac_f32_16x16x64_bf16 v[56:59], v[28:31], v[184:191], v1
v_smfmac_f32_16x16x64_bf16 v[56:59], v[32:35], v[192:199], v1
buffer_load_dwordx4 v[64:67], v5, s[4:7], s39 offen offset:1280 sc1
v_smfmac_f32_16x16x64_bf16 v[60:63], v[16:19], v[216:223], v1
v_smfmac_f32_16x16x64_bf16 v[60:63], v[20:23], v[224:231], v1
s_nop 4
v_cvt_pk_bf16_f32 v56, v56, v57
v_cvt_pk_bf16_f32 v57, v58, v59
v_smfmac_f32_16x16x64_bf16 v[60:63], v[24:27], v[232:239], v1
buffer_load_dwordx4 v[68:71], v6, s[4:7], s39 offen sc1
ds_write_b64 v2, v[56:57] offset:2560
v_smfmac_f32_16x16x64_bf16 v[60:63], v[28:31], v[240:247], v1
v_smfmac_f32_16x16x64_bf16 v[60:63], v[32:35], v[248:255], v1
s_cmp_lg_u32 s21, 0
s_cbranch_scc1 RV_NOLB
s_barrier
RV_NOLB:
s_nop 0
s_nop 4
v_cvt_pk_bf16_f32 v60, v60, v61
v_cvt_pk_bf16_f32 v61, v62, v63
ds_write_b64 v2, v[60:61] offset:3072
ds_read_b128 v[16:19], v4 offset:0
ds_read_b128 v[20:23], v4 offset:256
ds_read_b128 v[24:27], v4 offset:1792
ds_read_b128 v[28:31], v4 offset:2048
ds_read_b128 v[32:35], v4 offset:3584
ds_read_b128 v[36:39], v4 offset:3840
ds_read_b128 v[40:43], v4 offset:5376
ds_read_b128 v[44:47], v4 offset:5632
ds_read_b128 v[48:51], v3 offset:0
ds_read_b128 v[52:55], v3 offset:512
ds_read_b128 v[56:59], v3 offset:1792
ds_read_b128 v[60:63], v3 offset:2304
s_add_u32 s21, s21, 1
s_cmp_lt_u32 s21, 64
s_cbranch_scc1 RV_LOOP
s_branch L_ROLE_END
RV_LAST:
s_waitcnt vmcnt(0) lgkmcnt(0)
s_barrier
ds_read_b128 v[104:107], v7 offset:41984
ds_read_b128 v[108:111], v7 offset:46080
ds_read_b128 v[112:115], v7 offset:50176
ds_read_b128 v[116:119], v7 offset:54272
s_waitcnt lgkmcnt(0)
v_add_f32 v104, v104, v108
v_add_f32 v105, v105, v109
v_add_f32 v106, v106, v110
v_add_f32 v107, v107, v111
v_add_f32 v112, v112, v116
v_add_f32 v113, v113, v117
v_add_f32 v114, v114, v118
v_add_f32 v115, v115, v119
v_lshlrev_b32 v108, 16, v102
v_and_b32 v109, 0xffff0000, v102
v_lshlrev_b32 v110, 16, v103
v_and_b32 v111, 0xffff0000, v103
v_add_f32 v104, v104, v112
v_add_f32 v105, v105, v113
v_add_f32 v106, v106, v114
v_add_f32 v107, v107, v115
v_add_f32 v104, v104, v108
v_add_f32 v105, v105, v109
v_add_f32 v106, v106, v110
v_add_f32 v107, v107, v111
v_cvt_pk_bf16_f32 v108, v104, v105
v_cvt_pk_bf16_f32 v109, v106, v107
s_mov_b64 exec, s[54:55]
buffer_store_dwordx2 v[108:109], v11, s[4:7], s38 offen sc1
s_mov_b64 exec, -1
s_mov_b32 s39, 63
s_mul_i32 s32, s39, 40960
s_add_u32 s32, s32, s25
s_add_u32 s33, s32, 2560
s_add_u32 s30, s32, 5120
s_add_u32 s23, s32, 7680
s_mul_i32 s38, s39, 28672
s_add_u32 s38, s38, s27
s_mov_b64 exec, s[54:55]
buffer_load_dwordx2 v[102:103], v11, s[4:7], s38 offen sc1
s_mov_b64 exec, -1
s_barrier
ds_read_b128 v[48:51], v12 offset:0
ds_read_b128 v[52:55], v12 offset:896
ds_read_b128 v[56:59], v12 offset:1792
ds_read_b128 v[60:63], v12 offset:2688
ds_read_b128 v[96:99], v12 offset:3584
ds_read_b128 v[104:107], v12 offset:4480
ds_read_b128 v[108:111], v12 offset:5376
ds_read_b128 v[112:115], v12 offset:6272
s_cmp_eq_u32 s40, 0
s_cselect_b32 s41, 20000, 0
POLL_36:
buffer_load_dwordx4 v[72:75], v14, s[4:7], s32 offen sc1
buffer_load_dwordx4 v[76:79], v14, s[4:7], s32 offen offset:512 sc1
buffer_load_dwordx4 v[80:83], v14, s[4:7], s33 offen sc1
buffer_load_dwordx4 v[84:87], v14, s[4:7], s33 offen offset:512 sc1
buffer_load_dwordx4 v[88:91], v14, s[4:7], s30 offen sc1
buffer_load_dwordx4 v[92:95], v14, s[4:7], s30 offen offset:512 sc1
buffer_load_dwordx4 v[32:35], v14, s[4:7], s23 offen sc1
buffer_load_dwordx4 v[36:39], v14, s[4:7], s23 offen offset:512 sc1
buffer_load_dwordx4 v[40:43], v9, s[4:7], s32 offen sc1
buffer_load_dwordx4 v[44:47], v9, s[4:7], s30 offen sc1
s_waitcnt vmcnt(0)
v_max3_u32 v116, v72, v80, v88
v_max3_u32 v117, v76, v84, v92
v_max3_u32 v116, v116, v32, v40
v_max3_u32 v117, v117, v36, v44
v_max_u32 v116, v116, v117
v_cmp_eq_u32 vcc, -1, v116
s_nop 0
s_cbranch_vccz PDONE_37
s_sub_u32 s41, s41, 1
s_cbranch_scc0 POLL_36
s_or_b32 s40, s40, 64
PDONE_37:
s_waitcnt lgkmcnt(0)
v_mfma_f32_32x32x16_bf16 v[16:31], v[48:51], v[72:75], 0
v_mfma_f32_32x32x16_bf16 v[16:31], v[52:55], v[76:79], v[16:31]
v_mfma_f32_32x32x16_bf16 v[16:31], v[56:59], v[80:83], v[16:31]
v_mfma_f32_32x32x16_bf16 v[16:31], v[60:63], v[84:87], v[16:31]
v_mfma_f32_32x32x16_bf16 v[16:31], v[96:99], v[88:91], v[16:31]
v_mfma_f32_32x32x16_bf16 v[16:31], v[104:107], v[92:95], v[16:31]
v_mfma_f32_32x32x16_bf16 v[16:31], v[108:111], v[32:35], v[16:31]
v_mfma_f32_32x32x16_bf16 v[16:31], v[112:115], v[36:39], v[16:31]
ds_read_b128 v[48:51], v13 offset:0
ds_read_b128 v[52:55], v13 offset:16
ds_read_b128 v[56:59], v13 offset:1792
ds_read_b128 v[60:63], v13 offset:1808
s_waitcnt lgkmcnt(0)
v_mfma_f32_32x32x16_bf16 v[16:31], v[48:51], v[40:43], v[16:31]
v_mfma_f32_32x32x16_bf16 v[16:31], v[52:55], v[40:43], v[16:31]
v_mfma_f32_32x32x16_bf16 v[16:31], v[56:59], v[44:47], v[16:31]
v_mfma_f32_32x32x16_bf16 v[16:31], v[60:63], v[44:47], v[16:31]
s_nop 11
ds_write_b128 v10, v[16:19] offset:0
ds_write_b128 v10, v[20:23] offset:512
ds_write_b128 v10, v[24:27] offset:1024
ds_write_b128 v10, v[28:31] offset:1536
s_mov_b32 s38, 1806336
s_add_u32 s38, s38, s28
s_waitcnt vmcnt(0) lgkmcnt(0)
s_barrier
ds_read_b128 v[104:107], v7 offset:41984
ds_read_b128 v[108:111], v7 offset:46080
ds_read_b128 v[112:115], v7 offset:50176
ds_read_b128 v[116:119], v7 offset:54272
s_waitcnt lgkmcnt(0)
v_add_f32 v104, v104, v108
v_add_f32 v105, v105, v109
v_add_f32 v106, v106, v110
v_add_f32 v107, v107, v111
v_add_f32 v112, v112, v116
v_add_f32 v113, v113, v117
v_add_f32 v114, v114, v118
v_add_f32 v115, v115, v119
v_lshlrev_b32 v108, 16, v102
v_and_b32 v109, 0xffff0000, v102
v_lshlrev_b32 v110, 16, v103
v_and_b32 v111, 0xffff0000, v103
v_add_f32 v104, v104, v112
v_add_f32 v105, v105, v113
v_add_f32 v106, v106, v114
v_add_f32 v107, v107, v115
v_add_f32 v104, v104, v108
v_add_f32 v105, v105, v109
v_add_f32 v106, v106, v110
v_add_f32 v107, v107, v111
v_cvt_pk_bf16_f32 v108, v104, v105
v_cvt_pk_bf16_f32 v109, v106, v107
s_mov_b64 exec, s[54:55]
buffer_store_dwordx2 v[108:109], v11, s[4:7], s38 offen sc1
s_mov_b64 exec, -1
s_branch L_ROLE_END
BH_START:
v_and_b32 v16, 63, v0
v_and_b32 v17, 31, v0
v_lshrrev_b32 v18, 5, v0
v_lshrrev_b32 v19, 5, v16
v_lshlrev_b32 v20, 4, v0
v_lshlrev_b32 v0, 4, v16
v_lshlrev_b32 v1, 9, v18
v_lshl_add_u32 v1, v17, 4, v1
s_cmp_ge_u32 s18, 3
s_cbranch_scc1 BH_NOW
s_mul_i32 s32, s20, 3
s_add_u32 s32, s32, s18
s_mul_i32 s32, s32, 28672
s_add_u32 s32, s32, 12910592
s_add_u32 s33, s32, 0
buffer_load_dwordx4 a[0:3], v0, s[4:7], s33 offen
buffer_load_dwordx4 a[4:7], v0, s[4:7], s33 offen offset:1024
buffer_load_dwordx4 a[8:11], v0, s[4:7], s33 offen offset:2048
buffer_load_dwordx4 a[12:15], v0, s[4:7], s33 offen offset:3072
s_add_u32 s33, s32, 4096
buffer_load_dwordx4 a[16:19], v0, s[4:7], s33 offen
buffer_load_dwordx4 a[20:23], v0, s[4:7], s33 offen offset:1024
buffer_load_dwordx4 a[24:27], v0, s[4:7], s33 offen offset:2048
buffer_load_dwordx4 a[28:31], v0, s[4:7], s33 offen offset:3072
s_add_u32 s33, s32, 8192
buffer_load_dwordx4 a[32:35], v0, s[4:7], s33 offen
buffer_load_dwordx4 a[36:39], v0, s[4:7], s33 offen offset:1024
buffer_load_dwordx4 a[40:43], v0, s[4:7], s33 offen offset:2048
buffer_load_dwordx4 a[44:47], v0, s[4:7], s33 offen offset:3072
s_add_u32 s33, s32, 12288
buffer_load_dwordx4 a[48:51], v0, s[4:7], s33 offen
buffer_load_dwordx4 a[52:55], v0, s[4:7], s33 offen offset:1024
buffer_load_dwordx4 a[56:59], v0, s[4:7], s33 offen offset:2048
buffer_load_dwordx4 a[60:63], v0, s[4:7], s33 offen offset:3072
s_add_u32 s33, s32, 16384
buffer_load_dwordx4 a[64:67], v0, s[4:7], s33 offen
buffer_load_dwordx4 a[68:71], v0, s[4:7], s33 offen offset:1024
buffer_load_dwordx4 a[72:75], v0, s[4:7], s33 offen offset:2048
buffer_load_dwordx4 a[76:79], v0, s[4:7], s33 offen offset:3072
s_add_u32 s33, s32, 20480
buffer_load_dwordx4 a[80:83], v0, s[4:7], s33 offen
buffer_load_dwordx4 a[84:87], v0, s[4:7], s33 offen offset:1024
buffer_load_dwordx4 a[88:91], v0, s[4:7], s33 offen offset:2048
buffer_load_dwordx4 a[92:95], v0, s[4:7], s33 offen offset:3072
s_add_u32 s33, s32, 24576
buffer_load_dwordx4 a[96:99], v0, s[4:7], s33 offen
buffer_load_dwordx4 a[100:103], v0, s[4:7], s33 offen offset:1024
buffer_load_dwordx4 a[104:107], v0, s[4:7], s33 offen offset:2048
buffer_load_dwordx4 a[108:111], v0, s[4:7], s33 offen offset:3072
v_mov_b32 v24, 0x3f803f80
v_mov_b32 v25, 0x3f803f80
v_mov_b32 v26, 0x3f803f80
v_mov_b32 v27, 0x3f803f80
s_waitcnt vmcnt(0)
s_cmp_eq_u32 s18, 2
s_cbranch_scc1 BH_CSV
v_mfma_f32_32x32x16_bf16 v[140:155], a[0:3], v[24:27], 0
v_mfma_f32_32x32x16_bf16 v[140:155], a[4:7], v[24:27], v[140:155]
v_mfma_f32_32x32x16_bf16 v[140:155], a[8:11], v[24:27], v[140:155]
v_mfma_f32_32x32x16_bf16 v[140:155], a[12:15], v[24:27], v[140:155]
v_mfma_f32_32x32x16_bf16 v[140:155], a[16:19], v[24:27], v[140:155]
v_mfma_f32_32x32x16_bf16 v[140:155], a[20:23], v[24:27], v[140:155]
v_mfma_f32_32x32x16_bf16 v[140:155], a[24:27], v[24:27], v[140:155]
v_mfma_f32_32x32x16_bf16 v[140:155], a[28:31], v[24:27], v[140:155]
v_mfma_f32_32x32x16_bf16 v[140:155], a[32:35], v[24:27], v[140:155]
v_mfma_f32_32x32x16_bf16 v[140:155], a[36:39], v[24:27], v[140:155]
v_mfma_f32_32x32x16_bf16 v[140:155], a[40:43], v[24:27], v[140:155]
v_mfma_f32_32x32x16_bf16 v[140:155], a[44:47], v[24:27], v[140:155]
v_mfma_f32_32x32x16_bf16 v[140:155], a[48:51], v[24:27], v[140:155]
v_mfma_f32_32x32x16_bf16 v[140:155], a[52:55], v[24:27], v[140:155]
v_mfma_f32_32x32x16_bf16 v[140:155], a[56:59], v[24:27], v[140:155]
v_mfma_f32_32x32x16_bf16 v[140:155], a[60:63], v[24:27], v[140:155]
v_mfma_f32_32x32x16_bf16 v[140:155], a[64:67], v[24:27], v[140:155]
v_mfma_f32_32x32x16_bf16 v[140:155], a[68:71], v[24:27], v[140:155]
v_mfma_f32_32x32x16_bf16 v[140:155], a[72:75], v[24:27], v[140:155]
v_mfma_f32_32x32x16_bf16 v[140:155], a[76:79], v[24:27], v[140:155]
v_mfma_f32_32x32x16_bf16 v[140:155], a[80:83], v[24:27], v[140:155]
v_mfma_f32_32x32x16_bf16 v[140:155], a[84:87], v[24:27], v[140:155]
v_mfma_f32_32x32x16_bf16 v[140:155], a[88:91], v[24:27], v[140:155]
v_mfma_f32_32x32x16_bf16 v[140:155], a[92:95], v[24:27], v[140:155]
v_mfma_f32_32x32x16_bf16 v[140:155], a[96:99], v[24:27], v[140:155]
v_mfma_f32_32x32x16_bf16 v[140:155], a[100:103], v[24:27], v[140:155]
v_mfma_f32_32x32x16_bf16 v[140:155], a[104:107], v[24:27], v[140:155]
v_mfma_f32_32x32x16_bf16 v[140:155], a[108:111], v[24:27], v[140:155]
s_branch BH_NOW
BH_CSV:
v_mfma_f32_32x32x16_bf16 v[140:155], v[24:27], a[0:3], 0
v_mfma_f32_32x32x16_bf16 v[140:155], v[24:27], a[4:7], v[140:155]
v_mfma_f32_32x32x16_bf16 v[140:155], v[24:27], a[8:11], v[140:155]
v_mfma_f32_32x32x16_bf16 v[140:155], v[24:27], a[12:15], v[140:155]
v_mfma_f32_32x32x16_bf16 v[140:155], v[24:27], a[16:19], v[140:155]
v_mfma_f32_32x32x16_bf16 v[140:155], v[24:27], a[20:23], v[140:155]
v_mfma_f32_32x32x16_bf16 v[140:155], v[24:27], a[24:27], v[140:155]
v_mfma_f32_32x32x16_bf16 v[140:155], v[24:27], a[28:31], v[140:155]
v_mfma_f32_32x32x16_bf16 v[140:155], v[24:27], a[32:35], v[140:155]
v_mfma_f32_32x32x16_bf16 v[140:155], v[24:27], a[36:39], v[140:155]
v_mfma_f32_32x32x16_bf16 v[140:155], v[24:27], a[40:43], v[140:155]
v_mfma_f32_32x32x16_bf16 v[140:155], v[24:27], a[44:47], v[140:155]
v_mfma_f32_32x32x16_bf16 v[140:155], v[24:27], a[48:51], v[140:155]
v_mfma_f32_32x32x16_bf16 v[140:155], v[24:27], a[52:55], v[140:155]
v_mfma_f32_32x32x16_bf16 v[140:155], v[24:27], a[56:59], v[140:155]
v_mfma_f32_32x32x16_bf16 v[140:155], v[24:27], a[60:63], v[140:155]
v_mfma_f32_32x32x16_bf16 v[140:155], v[24:27], a[64:67], v[140:155]
v_mfma_f32_32x32x16_bf16 v[140:155], v[24:27], a[68:71], v[140:155]
v_mfma_f32_32x32x16_bf16 v[140:155], v[24:27], a[72:75], v[140:155]
v_mfma_f32_32x32x16_bf16 v[140:155], v[24:27], a[76:79], v[140:155]
v_mfma_f32_32x32x16_bf16 v[140:155], v[24:27], a[80:83], v[140:155]
v_mfma_f32_32x32x16_bf16 v[140:155], v[24:27], a[84:87], v[140:155]
v_mfma_f32_32x32x16_bf16 v[140:155], v[24:27], a[88:91], v[140:155]
v_mfma_f32_32x32x16_bf16 v[140:155], v[24:27], a[92:95], v[140:155]
v_mfma_f32_32x32x16_bf16 v[140:155], v[24:27], a[96:99], v[140:155]
v_mfma_f32_32x32x16_bf16 v[140:155], v[24:27], a[100:103], v[140:155]
v_mfma_f32_32x32x16_bf16 v[140:155], v[24:27], a[104:107], v[140:155]
v_mfma_f32_32x32x16_bf16 v[140:155], v[24:27], a[108:111], v[140:155]
BH_NOW:
v_mov_b32 v8, 0
v_mov_b32 v9, 0
v_mov_b32 v10, 0
v_mov_b32 v11, 0
v_add_u32 v21, 59392, v20
ds_write_b128 v21, v[8:11] offset:0
ds_write_b128 v21, v[8:11] offset:4096
ds_write_b128 v21, v[8:11] offset:8192
ds_write_b128 v21, v[8:11] offset:12288
ds_write_b128 v21, v[8:11] offset:16384
ds_write_b128 v21, v[8:11] offset:20480
ds_write_b128 v21, v[8:11] offset:24576
ds_write_b128 v21, v[8:11] offset:28672
ds_write_b128 v21, v[8:11] offset:32768
s_waitcnt lgkmcnt(0)
s_barrier
v_mov_b32 v8, 0x3f803f80
v_mov_b32 v9, 0x3f803f80
v_mov_b32 v10, 0x3f803f80
v_mov_b32 v11, 0x3f803f80
v_lshrrev_b32 v23, 4, v20
v_lshrrev_b32 v21, 1, v23
v_lshlrev_b32 v21, 10, v21
v_and_b32 v22, 1, v23
v_lshl_add_u32 v21, v22, 9, v21
v_add_u32 v21, 78272, v21
v_cmp_gt_u32 vcc, 36, v23
s_nop 0
s_and_saveexec_b64 s[36:37], vcc
s_cbranch_execz BH_NOONE
ds_write_b128 v21, v[8:11]
BH_NOONE:
s_mov_b64 exec, s[36:37]
s_mul_i32 s33, s20, 28
v_lshl_add_u32 v21, v18, 2, s33
v_lshrrev_b32 v22, 3, v21
v_lshlrev_b32 v22, 9, v22
v_and_b32 v21, 4, v21
v_lshl_add_u32 v22, v21, 1, v22
v_lshl_add_u32 v3, v17, 4, v22
v_cmp_gt_u32 s[54:55], 7, v18
v_add_u32 v4, 96256, v20
v_lshlrev_b32 v5, 2, v17
v_add_u32 v5, 112640, v5
v_lshlrev_b32 v7, 3, v17
v_add_u32 v7, 113152, v7
s_lshl_b32 s33, s18, 8
v_add_u32 v6, s33, v7
v_cmp_eq_u32 s[52:53], 28, v17
s_mul_i32 s22, s19, 3670016
s_add_u32 s22, s22, 23863296
s_mul_i32 s23, s19, 1835008
s_add_u32 s23, s23, 29368320
s_mov_b32 s21, 0
s_mov_b32 s24, 0
s_mov_b32 s29, 0
s_mov_b32 s62, 0
s_mov_b32 s51, 0
s_lshl_b32 s63, s19, 14
s_add_u32 s63, s63, 158031872
v_lshlrev_b32 v28, 2, v17
v_lshlrev_b32 v27, 4, v19
v_lshrrev_b32 v21, 2, v16
v_and_b32 v22, 3, v16
v_mul_u32_u24 v21, 28, v21
v_and_b32 v23, 1, v22
v_lshl_add_u32 v21, v23, 4, v21
v_lshrrev_b32 v23, 3, v21
v_lshlrev_b32 v23, 9, v23
v_and_b32 v21, 4, v21
v_lshl_add_u32 v23, v21, 1, v23
v_lshrrev_b32 v22, 1, v22
v_lshl_add_u32 v23, v22, 8, v23
v_add_u32 v30, 2048, v23
v_lshlrev_b32 v21, 2, v19
v_add_u32 v22, 0, v21
v_cmp_le_u32 s[64:65], v22, v17
v_add_u32 v22, 1, v21
v_cmp_le_u32 s[66:67], v22, v17
v_add_u32 v22, 2, v21
v_cmp_le_u32 s[68:69], v22, v17
v_add_u32 v22, 3, v21
v_cmp_le_u32 s[70:71], v22, v17
v_add_u32 v22, 8, v21
v_cmp_le_u32 s[72:73], v22, v17
v_add_u32 v22, 9, v21
v_cmp_le_u32 s[74:75], v22, v17
v_add_u32 v22, 10, v21
v_cmp_le_u32 s[76:77], v22, v17
v_add_u32 v22, 11, v21
v_cmp_le_u32 s[78:79], v22, v17
v_add_u32 v22, 16, v21
v_cmp_le_u32 s[80:81], v22, v17
v_add_u32 v22, 17, v21
v_cmp_le_u32 s[82:83], v22, v17
v_add_u32 v22, 18, v21
v_cmp_le_u32 s[84:85], v22, v17
v_add_u32 v22, 19, v21
v_cmp_le_u32 s[86:87], v22, v17
v_add_u32 v22, 24, v21
v_cmp_le_u32 s[88:89], v22, v17
v_add_u32 v22, 25, v21
v_cmp_le_u32 s[90:91], v22, v17
v_add_u32 v22, 26, v21
v_cmp_le_u32 s[92:93], v22, v17
v_add_u32 v22, 27, v21
v_cmp_le_u32 s[94:95], v22, v17
v_add_u32 v22, 0, v21
v_cmp_eq_u32 vcc, v22, v17
s_nop 1
v_cndmask_b32 v196, 0, 1.0, vcc
v_add_u32 v22, 1, v21
v_cmp_eq_u32 vcc, v22, v17
s_nop 1
v_cndmask_b32 v197, 0, 1.0, vcc
v_add_u32 v22, 2, v21
v_cmp_eq_u32 vcc, v22, v17
s_nop 1
v_cndmask_b32 v198, 0, 1.0, vcc
v_add_u32 v22, 3, v21
v_cmp_eq_u32 vcc, v22, v17
s_nop 1
v_cndmask_b32 v199, 0, 1.0, vcc
v_add_u32 v22, 8, v21
v_cmp_eq_u32 vcc, v22, v17
s_nop 1
v_cndmask_b32 v200, 0, 1.0, vcc
v_add_u32 v22, 9, v21
v_cmp_eq_u32 vcc, v22, v17
s_nop 1
v_cndmask_b32 v201, 0, 1.0, vcc
v_add_u32 v22, 10, v21
v_cmp_eq_u32 vcc, v22, v17
s_nop 1
v_cndmask_b32 v202, 0, 1.0, vcc
v_add_u32 v22, 11, v21
v_cmp_eq_u32 vcc, v22, v17
s_nop 1
v_cndmask_b32 v203, 0, 1.0, vcc
v_add_u32 v22, 16, v21
v_cmp_eq_u32 vcc, v22, v17
s_nop 1
v_cndmask_b32 v204, 0, 1.0, vcc
v_add_u32 v22, 17, v21
v_cmp_eq_u32 vcc, v22, v17
s_nop 1
v_cndmask_b32 v205, 0, 1.0, vcc
v_add_u32 v22, 18, v21
v_cmp_eq_u32 vcc, v22, v17
s_nop 1
v_cndmask_b32 v206, 0, 1.0, vcc
v_add_u32 v22, 19, v21
v_cmp_eq_u32 vcc, v22, v17
s_nop 1
v_cndmask_b32 v207, 0, 1.0, vcc
v_add_u32 v22, 24, v21
v_cmp_eq_u32 vcc, v22, v17
s_nop 1
v_cndmask_b32 v208, 0, 1.0, vcc
v_add_u32 v22, 25, v21
v_cmp_eq_u32 vcc, v22, v17
s_nop 1
v_cndmask_b32 v209, 0, 1.0, vcc
v_add_u32 v22, 26, v21
v_cmp_eq_u32 vcc, v22, v17
s_nop 1
v_cndmask_b32 v210, 0, 1.0, vcc
v_add_u32 v22, 27, v21
v_cmp_eq_u32 vcc, v22, v17
s_nop 1
v_cndmask_b32 v211, 0, 1.0, vcc
s_mov_b32 s60, 0
s_mov_b32 s61, -1
v_mov_b32 v22, 0xffff
v_mov_b32 v23, 0xffff0000
v_cndmask_b32 v24, 0, v22, s[64:65]
v_cndmask_b32 v25, 0, v23, s[66:67]
v_or_b32 v188, v24, v25
v_cndmask_b32 v24, 0, v22, s[68:69]
v_cndmask_b32 v25, 0, v23, s[70:71]
v_or_b32 v189, v24, v25
v_cndmask_b32 v24, 0, v22, s[72:73]
v_cndmask_b32 v25, 0, v23, s[74:75]
v_or_b32 v190, v24, v25
v_cndmask_b32 v24, 0, v22, s[76:77]
v_cndmask_b32 v25, 0, v23, s[78:79]
v_or_b32 v191, v24, v25
v_cndmask_b32 v24, 0, v22, s[80:81]
v_cndmask_b32 v25, 0, v23, s[82:83]
v_or_b32 v192, v24, v25
v_cndmask_b32 v24, 0, v22, s[84:85]
v_cndmask_b32 v25, 0, v23, s[86:87]
v_or_b32 v193, v24, v25
v_cndmask_b32 v24, 0, v22, s[88:89]
v_cndmask_b32 v25, 0, v23, s[90:91]
v_or_b32 v194, v24, v25
v_cndmask_b32 v24, 0, v22, s[92:93]
v_cndmask_b32 v25, 0, v23, s[94:95]
v_or_b32 v195, v24, v25
s_waitcnt vmcnt(0) lgkmcnt(0)
s_barrier
BH_LOOP:
v_add_u32 v31, s29, v0
s_cmp_eq_u32 s62, 1
s_cbranch_scc0 BH_POLL
s_waitcnt vmcnt(0)
s_barrier
v_add_u32 v8, s29, v30
ds_read_b32 v8, v8
s_waitcnt lgkmcnt(0)
v_cmp_eq_u32 vcc, -1, v8
s_nop 0
s_cbranch_vccz BH_GO
BH_POLL:
s_add_u32 s32, s22, 0
s_add_u32 s33, s22, 4096
s_add_u32 s34, s22, 8192
s_add_u32 s35, s22, 12288
s_add_u32 s36, s22, 16384
s_add_u32 s37, s22, 20480
s_add_u32 s38, s22, 24576
s_cmp_eq_u32 s40, 0
s_cselect_b32 s41, 20000, 0
POLL_38:
buffer_load_dwordx4 v[32:35], v1, s[4:7], s32 offen sc1
buffer_load_dwordx4 v[36:39], v1, s[4:7], s33 offen sc1
buffer_load_dwordx4 v[40:43], v1, s[4:7], s34 offen sc1
buffer_load_dwordx4 v[44:47], v1, s[4:7], s35 offen sc1
buffer_load_dwordx4 v[48:51], v1, s[4:7], s36 offen sc1
buffer_load_dwordx4 v[52:55], v1, s[4:7], s37 offen sc1
buffer_load_dwordx4 v[56:59], v1, s[4:7], s38 offen sc1
s_waitcnt vmcnt(0)
v_max3_u32 v8, v32, v36, v40
v_max3_u32 v9, v34, v38, v42
v_max3_u32 v8, v8, v44, v48
v_max3_u32 v9, v9, v46, v50
v_max3_u32 v8, v8, v52, v56
v_max3_u32 v9, v9, v54, v58
v_max_u32 v8, v8, v9
v_cmp_eq_u32 vcc, -1, v8
s_nop 0
s_cbranch_vccz PDONE_39
s_sub_u32 s41, s41, 1
s_cbranch_scc0 POLL_38
s_or_b32 s40, s40, 512
PDONE_39:
v_add_u32 v8, s29, v1
s_barrier
ds_write_b128 v8, v[32:35] offset:2048
ds_write_b128 v8, v[36:39] offset:6144
ds_write_b128 v8, v[40:43] offset:10240
ds_write_b128 v8, v[44:47] offset:14336
ds_write_b128 v8, v[48:51] offset:18432
ds_write_b128 v8, v[52:55] offset:22528
ds_write_b128 v8, v[56:59] offset:26624
s_waitcnt lgkmcnt(0)
s_barrier
BH_GO:
v_mov_b32 v29, 0
s_cmp_ge_u32 s18, 3
s_cbranch_scc1 BH_W3
s_cmp_eq_u32 s18, 2
s_cbranch_scc1 BH_V
buffer_load_dword v14, v28, s[4:7], s63 offen sc1
buffer_load_dword v13, v28, s[4:7], s63 offen offset:128 sc1
ds_read_b128 v[80:83], v31 offset:2048
ds_read_b128 v[84:87], v31 offset:3072
ds_read_b128 v[88:91], v31 offset:4096
ds_read_b128 v[92:95], v31 offset:5120
ds_read_b128 v[96:99], v31 offset:6144
s_waitcnt lgkmcnt(4)
v_mfma_f32_32x32x16_bf16 v[64:79], a[0:3], v[80:83], 0
v_max3_u32 v29, v29, v80, v82
ds_read_b128 v[100:103], v31 offset:7168
s_waitcnt lgkmcnt(4)
v_mfma_f32_32x32x16_bf16 v[64:79], a[4:7], v[84:87], v[64:79]
v_max3_u32 v29, v29, v84, v86
ds_read_b128 v[80:83], v31 offset:8192
s_waitcnt lgkmcnt(4)
v_mfma_f32_32x32x16_bf16 v[64:79], a[8:11], v[88:91], v[64:79]
v_max3_u32 v29, v29, v88, v90
ds_read_b128 v[84:87], v31 offset:9216
s_waitcnt lgkmcnt(4)
v_mfma_f32_32x32x16_bf16 v[64:79], a[12:15], v[92:95], v[64:79]
v_max3_u32 v29, v29, v92, v94
ds_read_b128 v[88:91], v31 offset:10240
s_waitcnt lgkmcnt(4)
v_mfma_f32_32x32x16_bf16 v[64:79], a[16:19], v[96:99], v[64:79]
v_max3_u32 v29, v29, v96, v98
ds_read_b128 v[92:95], v31 offset:11264
s_waitcnt lgkmcnt(4)
v_mfma_f32_32x32x16_bf16 v[64:79], a[20:23], v[100:103], v[64:79]
v_max3_u32 v29, v29, v100, v102
ds_read_b128 v[96:99], v31 offset:12288
s_waitcnt lgkmcnt(4)
v_mfma_f32_32x32x16_bf16 v[64:79], a[24:27], v[80:83], v[64:79]
v_max3_u32 v29, v29, v80, v82
ds_read_b128 v[100:103], v31 offset:13312
s_waitcnt lgkmcnt(4)
v_mfma_f32_32x32x16_bf16 v[64:79], a[28:31], v[84:87], v[64:79]
v_max3_u32 v29, v29, v84, v86
ds_read_b128 v[80:83], v31 offset:14336
s_waitcnt lgkmcnt(4)
v_mfma_f32_32x32x16_bf16 v[64:79], a[32:35], v[88:91], v[64:79]
v_max3_u32 v29, v29, v88, v90
ds_read_b128 v[84:87], v31 offset:15360
s_waitcnt lgkmcnt(4)
v_mfma_f32_32x32x16_bf16 v[64:79], a[36:39], v[92:95], v[64:79]
v_max3_u32 v29, v29, v92, v94
ds_read_b128 v[88:91], v31 offset:16384
s_waitcnt lgkmcnt(4)
v_mfma_f32_32x32x16_bf16 v[64:79], a[40:43], v[96:99], v[64:79]
v_max3_u32 v29, v29, v96, v98
ds_read_b128 v[92:95], v31 offset:17408
s_waitcnt lgkmcnt(4)
v_mfma_f32_32x32x16_bf16 v[64:79], a[44:47], v[100:103], v[64:79]
v_max3_u32 v29, v29, v100, v102
ds_read_b128 v[96:99], v31 offset:18432
s_waitcnt lgkmcnt(4)
v_mfma_f32_32x32x16_bf16 v[64:79], a[48:51], v[80:83], v[64:79]
v_max3_u32 v29, v29, v80, v82
ds_read_b128 v[100:103], v31 offset:19456
s_waitcnt lgkmcnt(4)
v_mfma_f32_32x32x16_bf16 v[64:79], a[52:55], v[84:87], v[64:79]
v_max3_u32 v29, v29, v84, v86
ds_read_b128 v[80:83], v31 offset:20480
s_waitcnt lgkmcnt(4)
v_mfma_f32_32x32x16_bf16 v[64:79], a[56:59], v[88:91], v[64:79]
v_max3_u32 v29, v29, v88, v90
ds_read_b128 v[84:87], v31 offset:21504
s_waitcnt lgkmcnt(4)
v_mfma_f32_32x32x16_bf16 v[64:79], a[60:63], v[92:95], v[64:79]
v_max3_u32 v29, v29, v92, v94
ds_read_b128 v[88:91], v31 offset:22528
s_waitcnt lgkmcnt(4)
v_mfma_f32_32x32x16_bf16 v[64:79], a[64:67], v[96:99], v[64:79]
v_max3_u32 v29, v29, v96, v98
ds_read_b128 v[92:95], v31 offset:23552
s_waitcnt lgkmcnt(4)
v_mfma_f32_32x32x16_bf16 v[64:79], a[68:71], v[100:103], v[64:79]
v_max3_u32 v29, v29, v100, v102
ds_read_b128 v[96:99], v31 offset:24576
s_waitcnt lgkmcnt(4)
v_mfma_f32_32x32x16_bf16 v[64:79], a[72:75], v[80:83], v[64:79]
v_max3_u32 v29, v29, v80, v82
ds_read_b128 v[100:103], v31 offset:25600
s_waitcnt lgkmcnt(4)
v_mfma_f32_32x32x16_bf16 v[64:79], a[76:79], v[84:87], v[64:79]
v_max3_u32 v29, v29, v84, v86
ds_read_b128 v[80:83], v31 offset:26624
s_waitcnt lgkmcnt(4)
v_mfma_f32_32x32x16_bf16 v[64:79], a[80:83], v[88:91], v[64:79]
v_max3_u32 v29, v29, v88, v90
ds_read_b128 v[84:87], v31 offset:27648
s_waitcnt lgkmcnt(4)
v_mfma_f32_32x32x16_bf16 v[64:79], a[84:87], v[92:95], v[64:79]
v_max3_u32 v29, v29, v92, v94
ds_read_b128 v[88:91], v31 offset:28672
s_waitcnt lgkmcnt(4)
v_mfma_f32_32x32x16_bf16 v[64:79], a[88:91], v[96:99], v[64:79]
v_max3_u32 v29, v29, v96, v98
ds_read_b128 v[92:95], v31 offset:29696
s_waitcnt lgkmcnt(4)
v_mfma_f32_32x32x16_bf16 v[64:79], a[92:95], v[100:103], v[64:79]
v_max3_u32 v29, v29, v100, v102
s_waitcnt lgkmcnt(3)
v_mfma_f32_32x32x16_bf16 v[64:79], a[96:99], v[80:83], v[64:79]
v_max3_u32 v29, v29, v80, v82
s_waitcnt lgkmcnt(2)
v_mfma_f32_32x32x16_bf16 v[64:79], a[100:103], v[84:87], v[64:79]
v_max3_u32 v29, v29, v84, v86
s_waitcnt lgkmcnt(1)
v_mfma_f32_32x32x16_bf16 v[64:79], a[104:107], v[88:91], v[64:79]
v_max3_u32 v29, v29, v88, v90
s_waitcnt lgkmcnt(0)
v_mfma_f32_32x32x16_bf16 v[64:79], a[108:111], v[92:95], v[64:79]
v_max3_u32 v29, v29, v92, v94
s_cmp_ge_u32 s51, 3
s_cbranch_scc1 NR_40
v_cmp_eq_u32 vcc, -1, v29
s_nop 0
s_cbranch_vccnz BH_REDO
NR_40:
s_waitcnt vmcnt(0)
v_max_u32 v8, v13, v14
v_cmp_eq_u32 vcc, -1, v8
s_nop 0
s_cbranch_vccz SP_41
s_cmp_eq_u32 s40, 0
s_cselect_b32 s41, 20000, 0
POLL_42:
buffer_load_dword v14, v28, s[4:7], s63 offen sc1
buffer_load_dword v13, v28, s[4:7], s63 offen offset:128 sc1
s_waitcnt vmcnt(0)
v_max_u32 v8, v13, v14
v_cmp_eq_u32 vcc, -1, v8
s_nop 0
s_cbranch_vccz PDONE_43
s_sub_u32 s41, s41, 1
s_cbranch_scc0 POLL_42
s_or_b32 s40, s40, 4096
PDONE_43:
SP_41:
s_cmp_eq_u32 s18, 0
s_cselect_b32 s34, 1049335798, 1.0
s_lshl_b32 s33, s24, 11
s_add_u32 s33, s33, 59392
s_cmp_eq_u32 s18, 0
s_cselect_b32 s33, 0, s33
v_mul_f32 v14, s34, v14
v_fma_f32 v64, -v13, v140, v64
v_fma_f32 v65, -v13, v141, v65
v_fma_f32 v66, -v13, v142, v66
v_fma_f32 v67, -v13, v143, v67
v_fma_f32 v68, -v13, v144, v68
v_fma_f32 v69, -v13, v145, v69
v_fma_f32 v70, -v13, v146, v70
v_fma_f32 v71, -v13, v147, v71
v_fma_f32 v72, -v13, v148, v72
v_fma_f32 v73, -v13, v149, v73
v_fma_f32 v74, -v13, v150, v74
v_fma_f32 v75, -v13, v151, v75
v_fma_f32 v76, -v13, v152, v76
v_fma_f32 v77, -v13, v153, v77
v_fma_f32 v78, -v13, v154, v78
v_fma_f32 v79, -v13, v155, v79
v_mul_f32 v64, v14, v64
v_mul_f32 v65, v14, v65
v_mul_f32 v66, v14, v66
v_mul_f32 v67, v14, v67
v_mul_f32 v68, v14, v68
v_mul_f32 v69, v14, v69
v_mul_f32 v70, v14, v70
v_mul_f32 v71, v14, v71
v_mul_f32 v72, v14, v72
v_mul_f32 v73, v14, v73
v_mul_f32 v74, v14, v74
v_mul_f32 v75, v14, v75
v_mul_f32 v76, v14, v76
v_mul_f32 v77, v14, v77
v_mul_f32 v78, v14, v78
v_mul_f32 v79, v14, v79
s_branch BH_PACK
BH_V:
buffer_load_dwordx4 v[104:107], v27, s[4:7], s63 offen sc1
buffer_load_dwordx4 v[108:111], v27, s[4:7], s63 offen offset:32 sc1
buffer_load_dwordx4 v[112:115], v27, s[4:7], s63 offen offset:64 sc1
buffer_load_dwordx4 v[116:119], v27, s[4:7], s63 offen offset:96 sc1
buffer_load_dwordx4 v[120:123], v27, s[4:7], s63 offen offset:128 sc1
buffer_load_dwordx4 v[124:127], v27, s[4:7], s63 offen offset:160 sc1
buffer_load_dwordx4 v[128:131], v27, s[4:7], s63 offen offset:192 sc1
buffer_load_dwordx4 v[132:135], v27, s[4:7], s63 offen offset:224 sc1
ds_read_b128 v[80:83], v31 offset:2048
ds_read_b128 v[84:87], v31 offset:3072
ds_read_b128 v[88:91], v31 offset:4096
ds_read_b128 v[92:95], v31 offset:5120
ds_read_b128 v[96:99], v31 offset:6144
s_waitcnt lgkmcnt(4)
v_mfma_f32_32x32x16_bf16 v[64:79], v[80:83], a[0:3], 0
v_max3_u32 v29, v29, v80, v82
ds_read_b128 v[100:103], v31 offset:7168
s_waitcnt lgkmcnt(4)
v_mfma_f32_32x32x16_bf16 v[64:79], v[84:87], a[4:7], v[64:79]
v_max3_u32 v29, v29, v84, v86
ds_read_b128 v[80:83], v31 offset:8192
s_waitcnt lgkmcnt(4)
v_mfma_f32_32x32x16_bf16 v[64:79], v[88:91], a[8:11], v[64:79]
v_max3_u32 v29, v29, v88, v90
ds_read_b128 v[84:87], v31 offset:9216
s_waitcnt lgkmcnt(4)
v_mfma_f32_32x32x16_bf16 v[64:79], v[92:95], a[12:15], v[64:79]
v_max3_u32 v29, v29, v92, v94
ds_read_b128 v[88:91], v31 offset:10240
s_waitcnt lgkmcnt(4)
v_mfma_f32_32x32x16_bf16 v[64:79], v[96:99], a[16:19], v[64:79]
v_max3_u32 v29, v29, v96, v98
ds_read_b128 v[92:95], v31 offset:11264
s_waitcnt lgkmcnt(4)
v_mfma_f32_32x32x16_bf16 v[64:79], v[100:103], a[20:23], v[64:79]
v_max3_u32 v29, v29, v100, v102
ds_read_b128 v[96:99], v31 offset:12288
s_waitcnt lgkmcnt(4)
v_mfma_f32_32x32x16_bf16 v[64:79], v[80:83], a[24:27], v[64:79]
v_max3_u32 v29, v29, v80, v82
ds_read_b128 v[100:103], v31 offset:13312
s_waitcnt lgkmcnt(4)
v_mfma_f32_32x32x16_bf16 v[64:79], v[84:87], a[28:31], v[64:79]
v_max3_u32 v29, v29, v84, v86
ds_read_b128 v[80:83], v31 offset:14336
s_waitcnt lgkmcnt(4)
v_mfma_f32_32x32x16_bf16 v[64:79], v[88:91], a[32:35], v[64:79]
v_max3_u32 v29, v29, v88, v90
ds_read_b128 v[84:87], v31 offset:15360
s_waitcnt lgkmcnt(4)
v_mfma_f32_32x32x16_bf16 v[64:79], v[92:95], a[36:39], v[64:79]
v_max3_u32 v29, v29, v92, v94
ds_read_b128 v[88:91], v31 offset:16384
s_waitcnt lgkmcnt(4)
v_mfma_f32_32x32x16_bf16 v[64:79], v[96:99], a[40:43], v[64:79]
v_max3_u32 v29, v29, v96, v98
ds_read_b128 v[92:95], v31 offset:17408
s_waitcnt lgkmcnt(4)
v_mfma_f32_32x32x16_bf16 v[64:79], v[100:103], a[44:47], v[64:79]
v_max3_u32 v29, v29, v100, v102
ds_read_b128 v[96:99], v31 offset:18432
s_waitcnt lgkmcnt(4)
v_mfma_f32_32x32x16_bf16 v[64:79], v[80:83], a[48:51], v[64:79]
v_max3_u32 v29, v29, v80, v82
ds_read_b128 v[100:103], v31 offset:19456
s_waitcnt lgkmcnt(4)
v_mfma_f32_32x32x16_bf16 v[64:79], v[84:87], a[52:55], v[64:79]
v_max3_u32 v29, v29, v84, v86
ds_read_b128 v[80:83], v31 offset:20480
s_waitcnt lgkmcnt(4)
v_mfma_f32_32x32x16_bf16 v[64:79], v[88:91], a[56:59], v[64:79]
v_max3_u32 v29, v29, v88, v90
ds_read_b128 v[84:87], v31 offset:21504
s_waitcnt lgkmcnt(4)
v_mfma_f32_32x32x16_bf16 v[64:79], v[92:95], a[60:63], v[64:79]
v_max3_u32 v29, v29, v92, v94
ds_read_b128 v[88:91], v31 offset:22528
s_waitcnt lgkmcnt(4)
v_mfma_f32_32x32x16_bf16 v[64:79], v[96:99], a[64:67], v[64:79]
v_max3_u32 v29, v29, v96, v98
ds_read_b128 v[92:95], v31 offset:23552
s_waitcnt lgkmcnt(4)
v_mfma_f32_32x32x16_bf16 v[64:79], v[100:103], a[68:71], v[64:79]
v_max3_u32 v29, v29, v100, v102
ds_read_b128 v[96:99], v31 offset:24576
s_waitcnt lgkmcnt(4)
v_mfma_f32_32x32x16_bf16 v[64:79], v[80:83], a[72:75], v[64:79]
v_max3_u32 v29, v29, v80, v82
ds_read_b128 v[100:103], v31 offset:25600
s_waitcnt lgkmcnt(4)
v_mfma_f32_32x32x16_bf16 v[64:79], v[84:87], a[76:79], v[64:79]
v_max3_u32 v29, v29, v84, v86
ds_read_b128 v[80:83], v31 offset:26624
s_waitcnt lgkmcnt(4)
v_mfma_f32_32x32x16_bf16 v[64:79], v[88:91], a[80:83], v[64:79]
v_max3_u32 v29, v29, v88, v90
ds_read_b128 v[84:87], v31 offset:27648
s_waitcnt lgkmcnt(4)
v_mfma_f32_32x32x16_bf16 v[64:79], v[92:95], a[84:87], v[64:79]
v_max3_u32 v29, v29, v92, v94
ds_read_b128 v[88:91], v31 offset:28672
s_waitcnt lgkmcnt(4)
v_mfma_f32_32x32x16_bf16 v[64:79], v[96:99], a[88:91], v[64:79]
v_max3_u32 v29, v29, v96, v98
ds_read_b128 v[92:95], v31 offset:29696
s_waitcnt lgkmcnt(4)
v_mfma_f32_32x32x16_bf16 v[64:79], v[100:103], a[92:95], v[64:79]
v_max3_u32 v29, v29, v100, v102
s_waitcnt lgkmcnt(3)
v_mfma_f32_32x32x16_bf16 v[64:79], v[80:83], a[96:99], v[64:79]
v_max3_u32 v29, v29, v80, v82
s_waitcnt lgkmcnt(2)
v_mfma_f32_32x32x16_bf16 v[64:79], v[84:87], a[100:103], v[64:79]
v_max3_u32 v29, v29, v84, v86
s_waitcnt lgkmcnt(1)
v_mfma_f32_32x32x16_bf16 v[64:79], v[88:91], a[104:107], v[64:79]
v_max3_u32 v29, v29, v88, v90
s_waitcnt lgkmcnt(0)
v_mfma_f32_32x32x16_bf16 v[64:79], v[92:95], a[108:111], v[64:79]
v_max3_u32 v29, v29, v92, v94
s_cmp_ge_u32 s51, 3
s_cbranch_scc1 NR_44
v_cmp_eq_u32 vcc, -1, v29
s_nop 0
s_cbranch_vccnz BH_REDO
NR_44:
s_waitcnt vmcnt(0)
v_max3_u32 v8, v104, v106, v108
v_max3_u32 v9, v105, v107, v109
v_max3_u32 v8, v8, v110, v112
v_max3_u32 v9, v9, v111, v113
v_max3_u32 v8, v8, v114, v116
v_max3_u32 v9, v9, v115, v117
v_max3_u32 v8, v8, v118, v120
v_max3_u32 v9, v9, v119, v121
v_max3_u32 v8, v8, v122, v124
v_max3_u32 v9, v9, v123, v125
v_max3_u32 v8, v8, v126, v128
v_max3_u32 v9, v9, v127, v129
v_max3_u32 v8, v8, v130, v132
v_max3_u32 v9, v9, v131, v133
v_max_u32 v8, v8, v134
v_max_u32 v9, v9, v135
v_max_u32 v8, v8, v9
v_cmp_eq_u32 vcc, -1, v8
s_nop 0
s_cbranch_vccz SP_45
s_cmp_eq_u32 s40, 0
s_cselect_b32 s41, 20000, 0
POLL_46:
buffer_load_dwordx4 v[104:107], v27, s[4:7], s63 offen sc1
buffer_load_dwordx4 v[108:111], v27, s[4:7], s63 offen offset:32 sc1
buffer_load_dwordx4 v[112:115], v27, s[4:7], s63 offen offset:64 sc1
buffer_load_dwordx4 v[116:119], v27, s[4:7], s63 offen offset:96 sc1
buffer_load_dwordx4 v[120:123], v27, s[4:7], s63 offen offset:128 sc1
buffer_load_dwordx4 v[124:127], v27, s[4:7], s63 offen offset:160 sc1
buffer_load_dwordx4 v[128:131], v27, s[4:7], s63 offen offset:192 sc1
buffer_load_dwordx4 v[132:135], v27, s[4:7], s63 offen offset:224 sc1
s_waitcnt vmcnt(0)
v_max3_u32 v8, v104, v106, v108
v_max3_u32 v9, v105, v107, v109
v_max3_u32 v8, v8, v110, v112
v_max3_u32 v9, v9, v111, v113
v_max3_u32 v8, v8, v114, v116
v_max3_u32 v9, v9, v115, v117
v_max3_u32 v8, v8, v118, v120
v_max3_u32 v9, v9, v119, v121
v_max3_u32 v8, v8, v122, v124
v_max3_u32 v9, v9, v123, v125
v_max3_u32 v8, v8, v126, v128
v_max3_u32 v9, v9, v127, v129
v_max3_u32 v8, v8, v130, v132
v_max3_u32 v9, v9, v131, v133
v_max_u32 v8, v8, v134
v_max_u32 v9, v9, v135
v_max_u32 v8, v8, v9
v_cmp_eq_u32 vcc, -1, v8
s_nop 0
s_cbranch_vccz PDONE_47
s_sub_u32 s41, s41, 1
s_cbranch_scc0 POLL_46
s_or_b32 s40, s40, 4096
PDONE_47:
SP_45:
s_lshl_b32 s33, s24, 11
s_add_u32 s33, s33, 77824
v_mov_b32 v8, 1.0
v_fma_f32 v64, -v120, v140, v64
v_fma_f32 v65, -v121, v140, v65
v_fma_f32 v66, -v122, v140, v66
v_fma_f32 v67, -v123, v140, v67
v_fma_f32 v68, -v124, v140, v68
v_fma_f32 v69, -v125, v140, v69
v_fma_f32 v70, -v126, v140, v70
v_fma_f32 v71, -v127, v140, v71
v_fma_f32 v72, -v128, v140, v72
v_fma_f32 v73, -v129, v140, v73
v_fma_f32 v74, -v130, v140, v74
v_fma_f32 v75, -v131, v140, v75
v_fma_f32 v76, -v132, v140, v76
v_fma_f32 v77, -v133, v140, v77
v_fma_f32 v78, -v134, v140, v78
v_fma_f32 v79, -v135, v140, v79
v_mul_f32 v64, v104, v64
v_mul_f32 v65, v105, v65
v_mul_f32 v66, v106, v66
v_mul_f32 v67, v107, v67
v_mul_f32 v68, v108, v68
v_mul_f32 v69, v109, v69
v_mul_f32 v70, v110, v70
v_mul_f32 v71, v111, v71
v_mul_f32 v72, v112, v72
v_mul_f32 v73, v113, v73
v_mul_f32 v74, v114, v74
v_mul_f32 v75, v115, v75
v_mul_f32 v76, v116, v76
v_mul_f32 v77, v117, v77
v_mul_f32 v78, v118, v78
v_mul_f32 v79, v119, v79
s_not_b64 s[36:37], s[52:53]
s_mov_b64 exec, s[36:37]
BH_PACK:
v_cvt_pk_bf16_f32 v32, v64, v65
v_cvt_pk_bf16_f32 v33, v66, v67
v_cvt_pk_bf16_f32 v34, v68, v69
v_cvt_pk_bf16_f32 v35, v70, v71
v_cvt_pk_bf16_f32 v36, v72, v73
v_cvt_pk_bf16_f32 v37, v74, v75
v_cvt_pk_bf16_f32 v38, v76, v77
v_cvt_pk_bf16_f32 v39, v78, v79
v_add_u32 v8, s33, v0
ds_write_b128 v8, v[32:35]
ds_write_b128 v8, v[36:39] offset:1024
s_mov_b64 exec, -1
s_waitcnt lgkmcnt(0)
s_branch BH_QKVD
BH_W3:
ds_read_b128 v[64:67], v31 offset:2048
ds_read_b128 v[68:71], v31 offset:3072
ds_read_b128 v[72:75], v31 offset:4096
ds_read_b128 v[76:79], v31 offset:5120
ds_read_b128 v[80:83], v31 offset:6144
ds_read_b128 v[84:87], v31 offset:7168
ds_read_b128 v[88:91], v31 offset:8192
s_waitcnt lgkmcnt(0)
v_max3_u32 v29, v29, v64, v66
v_max3_u32 v29, v29, v68, v70
v_max3_u32 v29, v29, v72, v74
v_max3_u32 v29, v29, v76, v78
v_max3_u32 v29, v29, v80, v82
v_max3_u32 v29, v29, v84, v86
v_max3_u32 v29, v29, v88, v90
ds_read_b128 v[64:67], v31 offset:9216
ds_read_b128 v[68:71], v31 offset:10240
ds_read_b128 v[72:75], v31 offset:11264
ds_read_b128 v[76:79], v31 offset:12288
ds_read_b128 v[80:83], v31 offset:13312
ds_read_b128 v[84:87], v31 offset:14336
ds_read_b128 v[88:91], v31 offset:15360
s_waitcnt lgkmcnt(0)
v_max3_u32 v29, v29, v64, v66
v_max3_u32 v29, v29, v68, v70
v_max3_u32 v29, v29, v72, v74
v_max3_u32 v29, v29, v76, v78
v_max3_u32 v29, v29, v80, v82
v_max3_u32 v29, v29, v84, v86
v_max3_u32 v29, v29, v88, v90
ds_read_b128 v[64:67], v31 offset:16384
ds_read_b128 v[68:71], v31 offset:17408
ds_read_b128 v[72:75], v31 offset:18432
ds_read_b128 v[76:79], v31 offset:19456
ds_read_b128 v[80:83], v31 offset:20480
ds_read_b128 v[84:87], v31 offset:21504
ds_read_b128 v[88:91], v31 offset:22528
s_waitcnt lgkmcnt(0)
v_max3_u32 v29, v29, v64, v66
v_max3_u32 v29, v29, v68, v70
v_max3_u32 v29, v29, v72, v74
v_max3_u32 v29, v29, v76, v78
v_max3_u32 v29, v29, v80, v82
v_max3_u32 v29, v29, v84, v86
v_max3_u32 v29, v29, v88, v90
ds_read_b128 v[64:67], v31 offset:23552
ds_read_b128 v[68:71], v31 offset:24576
ds_read_b128 v[72:75], v31 offset:25600
ds_read_b128 v[76:79], v31 offset:26624
ds_read_b128 v[80:83], v31 offset:27648
ds_read_b128 v[84:87], v31 offset:28672
ds_read_b128 v[88:91], v31 offset:29696
s_waitcnt lgkmcnt(0)
v_max3_u32 v29, v29, v64, v66
v_max3_u32 v29, v29, v68, v70
v_max3_u32 v29, v29, v72, v74
v_max3_u32 v29, v29, v76, v78
v_max3_u32 v29, v29, v80, v82
v_max3_u32 v29, v29, v84, v86
v_max3_u32 v29, v29, v88, v90
s_cmp_ge_u32 s51, 3
s_cbranch_scc1 NR_48
v_cmp_eq_u32 vcc, -1, v29
s_nop 0
s_cbranch_vccnz BH_REDO
NR_48:
s_add_u32 s38, s21, 1
s_cmp_ge_u32 s38, 64
s_cbranch_scc1 BH_QKVD
s_sub_u32 s36, 28672, s29
s_add_u32 s37, s22, 28672
s_add_u32 m0, s36, 2048
s_nop 0
buffer_load_dwordx4 v0, s[4:7], s37 offen sc1 lds
buffer_load_dwordx4 v0, s[4:7], s37 offen offset:1024 sc1 lds
buffer_load_dwordx4 v0, s[4:7], s37 offen offset:2048 sc1 lds
buffer_load_dwordx4 v0, s[4:7], s37 offen offset:3072 sc1 lds
s_add_u32 s36, s36, 4096
s_add_u32 s37, s37, 4096
s_add_u32 m0, s36, 2048
s_nop 0
buffer_load_dwordx4 v0, s[4:7], s37 offen sc1 lds
buffer_load_dwordx4 v0, s[4:7], s37 offen offset:1024 sc1 lds
buffer_load_dwordx4 v0, s[4:7], s37 offen offset:2048 sc1 lds
buffer_load_dwordx4 v0, s[4:7], s37 offen offset:3072 sc1 lds
s_add_u32 s36, s36, 4096
s_add_u32 s37, s37, 4096
s_add_u32 m0, s36, 2048
s_nop 0
buffer_load_dwordx4 v0, s[4:7], s37 offen sc1 lds
buffer_load_dwordx4 v0, s[4:7], s37 offen offset:1024 sc1 lds
buffer_load_dwordx4 v0, s[4:7], s37 offen offset:2048 sc1 lds
buffer_load_dwordx4 v0, s[4:7], s37 offen offset:3072 sc1 lds
s_add_u32 s36, s36, 4096
s_add_u32 s37, s37, 4096
s_add_u32 m0, s36, 2048
s_nop 0
buffer_load_dwordx4 v0, s[4:7], s37 offen sc1 lds
buffer_load_dwordx4 v0, s[4:7], s37 offen offset:1024 sc1 lds
buffer_load_dwordx4 v0, s[4:7], s37 offen offset:2048 sc1 lds
buffer_load_dwordx4 v0, s[4:7], s37 offen offset:3072 sc1 lds
s_add_u32 s36, s36, 4096
s_add_u32 s37, s37, 4096
s_add_u32 m0, s36, 2048
s_nop 0
buffer_load_dwordx4 v0, s[4:7], s37 offen sc1 lds
buffer_load_dwordx4 v0, s[4:7], s37 offen offset:1024 sc1 lds
buffer_load_dwordx4 v0, s[4:7], s37 offen offset:2048 sc1 lds
buffer_load_dwordx4 v0, s[4:7], s37 offen offset:3072 sc1 lds
s_add_u32 s36, s36, 4096
s_add_u32 s37, s37, 4096
s_add_u32 m0, s36, 2048
s_nop 0
buffer_load_dwordx4 v0, s[4:7], s37 offen sc1 lds
buffer_load_dwordx4 v0, s[4:7], s37 offen offset:1024 sc1 lds
buffer_load_dwordx4 v0, s[4:7], s37 offen offset:2048 sc1 lds
buffer_load_dwordx4 v0, s[4:7], s37 offen offset:3072 sc1 lds
s_add_u32 s36, s36, 4096
s_add_u32 s37, s37, 4096
s_add_u32 m0, s36, 2048
s_nop 0
buffer_load_dwordx4 v0, s[4:7], s37 offen sc1 lds
buffer_load_dwordx4 v0, s[4:7], s37 offen offset:1024 sc1 lds
buffer_load_dwordx4 v0, s[4:7], s37 offen offset:2048 sc1 lds
buffer_load_dwordx4 v0, s[4:7], s37 offen offset:3072 sc1 lds
BH_QKVD:
s_barrier
s_add_u32 s38, s21, 1
s_mov_b32 s62, 0
s_sub_u32 s29, 28672, s29
s_cmp_ge_u32 s38, 64
s_cselect_b32 s62, 0, 1
s_add_u32 s25, s18, 4
s_add_u32 s26, s24, s18
s_add_u32 s26, s26, 1
s_cmp_ge_u32 s26, 9
s_cselect_b32 s39, 9, 0
s_sub_u32 s26, s26, s39
s_lshl_b32 s26, s26, 11
s_add_u32 s27, s24, s25
s_add_u32 s27, s27, 1
s_cmp_ge_u32 s27, 9
s_cselect_b32 s39, 9, 0
s_sub_u32 s27, s27, s39
s_lshl_b32 s27, s27, 11
s_lshl_b32 s28, s24, 11
ds_read_b128 v[32:35], v0 offset:0
ds_read_b128 v[36:39], v0 offset:1024
s_add_u32 s26, s26, 59392
s_add_u32 s27, s27, 59392
s_add_u32 s28, s28, 59392
v_add_u32 v10, s26, v0
v_add_u32 v11, s27, v0
v_add_u32 v12, s28, v0
ds_read_b128 v[40:43], v10
ds_read_b128 v[48:51], v11
ds_read_b128 v[44:47], v10 offset:1024
ds_read_b128 v[52:55], v11 offset:1024
s_cmp_eq_u32 s18, 0
s_cbranch_scc0 BH_S123
ds_read_b128 v[56:59], v12
ds_read_b128 v[60:63], v12 offset:1024
s_waitcnt lgkmcnt(0)
v_mfma_f32_32x32x16_bf16 v[96:111], v[56:59], v[32:35], 0
v_mfma_f32_32x32x16_bf16 v[96:111], v[60:63], v[36:39], v[96:111]
BH_S123:
s_waitcnt lgkmcnt(0)
v_mfma_f32_32x32x16_bf16 v[64:79], v[40:43], v[32:35], 0
v_mfma_f32_32x32x16_bf16 v[80:95], v[48:51], v[32:35], 0
v_mfma_f32_32x32x16_bf16 v[64:79], v[44:47], v[36:39], v[64:79]
v_mfma_f32_32x32x16_bf16 v[80:95], v[52:55], v[36:39], v[80:95]
ds_read_b128 v[40:43], v10 offset:18432
ds_read_b128 v[44:47], v10 offset:19456
ds_read_b128 v[48:51], v11 offset:18432
ds_read_b128 v[52:55], v11 offset:19456
ds_read_b128 v[56:59], v12 offset:18432
ds_read_b128 v[60:63], v12 offset:19456
v_mov_b32 v8, 4048155338
s_cmp_ge_u32 s21, 8
s_cbranch_scc1 BH_ALLV
s_add_u32 s30, s21, s18
s_cmp_ge_u32 s30, 8
s_cselect_b32 s30, -1, 0
s_add_u32 s31, s21, s25
s_cmp_ge_u32 s31, 8
s_cselect_b32 s31, -1, 0
s_mov_b32 s56, s30
s_mov_b32 s57, s30
s_mov_b32 s58, s31
s_mov_b32 s59, s31
v_cndmask_b32 v64, v8, v64, s[56:57]
v_cndmask_b32 v65, v8, v65, s[56:57]
v_cndmask_b32 v66, v8, v66, s[56:57]
v_cndmask_b32 v67, v8, v67, s[56:57]
v_cndmask_b32 v68, v8, v68, s[56:57]
v_cndmask_b32 v69, v8, v69, s[56:57]
v_cndmask_b32 v70, v8, v70, s[56:57]
v_cndmask_b32 v71, v8, v71, s[56:57]
v_cndmask_b32 v72, v8, v72, s[56:57]
v_cndmask_b32 v73, v8, v73, s[56:57]
v_cndmask_b32 v74, v8, v74, s[56:57]
v_cndmask_b32 v75, v8, v75, s[56:57]
v_cndmask_b32 v76, v8, v76, s[56:57]
v_cndmask_b32 v77, v8, v77, s[56:57]
v_cndmask_b32 v78, v8, v78, s[56:57]
v_cndmask_b32 v79, v8, v79, s[56:57]
v_cndmask_b32 v80, v8, v80, s[58:59]
v_cndmask_b32 v81, v8, v81, s[58:59]
v_cndmask_b32 v82, v8, v82, s[58:59]
v_cndmask_b32 v83, v8, v83, s[58:59]
v_cndmask_b32 v84, v8, v84, s[58:59]
v_cndmask_b32 v85, v8, v85, s[58:59]
v_cndmask_b32 v86, v8, v86, s[58:59]
v_cndmask_b32 v87, v8, v87, s[58:59]
v_cndmask_b32 v88, v8, v88, s[58:59]
v_cndmask_b32 v89, v8, v89, s[58:59]
v_cndmask_b32 v90, v8, v90, s[58:59]
v_cndmask_b32 v91, v8, v91, s[58:59]
v_cndmask_b32 v92, v8, v92, s[58:59]
v_cndmask_b32 v93, v8, v93, s[58:59]
v_cndmask_b32 v94, v8, v94, s[58:59]
v_cndmask_b32 v95, v8, v95, s[58:59]
BH_ALLV:
s_cmp_eq_u32 s18, 0
s_cbranch_scc0 BH_SM
v_cndmask_b32 v64, v64, v96, s[64:65]
v_cndmask_b32 v65, v65, v97, s[66:67]
v_cndmask_b32 v66, v66, v98, s[68:69]
v_cndmask_b32 v67, v67, v99, s[70:71]
v_cndmask_b32 v68, v68, v100, s[72:73]
v_cndmask_b32 v69, v69, v101, s[74:75]
v_cndmask_b32 v70, v70, v102, s[76:77]
v_cndmask_b32 v71, v71, v103, s[78:79]
v_cndmask_b32 v72, v72, v104, s[80:81]
v_cndmask_b32 v73, v73, v105, s[82:83]
v_cndmask_b32 v74, v74, v106, s[84:85]
v_cndmask_b32 v75, v75, v107, s[86:87]
v_cndmask_b32 v76, v76, v108, s[88:89]
v_cndmask_b32 v77, v77, v109, s[90:91]
v_cndmask_b32 v78, v78, v110, s[92:93]
v_cndmask_b32 v79, v79, v111, s[94:95]
BH_SM:
v_max3_f32 v9, v80, v81, v82
v_max3_f32 v13, v64, v65, v66
v_max3_f32 v9, v9, v83, v84
v_max3_f32 v13, v13, v67, v68
v_max3_f32 v9, v9, v85, v86
v_max3_f32 v13, v13, v69, v70
v_max3_f32 v9, v9, v87, v88
v_max3_f32 v13, v13, v71, v72
v_max3_f32 v9, v9, v89, v90
v_max3_f32 v13, v13, v73, v74
v_max3_f32 v9, v9, v91, v92
v_max3_f32 v13, v13, v75, v76
v_max3_f32 v9, v9, v93, v94
v_max3_f32 v13, v13, v77, v78
v_max3_f32 v9, v9, v79, v95
v_max_f32 v9, v9, v13
v_mov_b32 v13, v9
s_nop 1
v_permlane32_swap_b32 v9, v13
v_max_f32 v14, v9, v13
v_mov_b32 v9, v14
v_pk_add_f32 v[80:81], v[80:81], v[14:15] op_sel_hi:[1,0] neg_lo:[0,1] neg_hi:[0,1]
v_pk_add_f32 v[82:83], v[82:83], v[14:15] op_sel_hi:[1,0] neg_lo:[0,1] neg_hi:[0,1]
v_pk_add_f32 v[84:85], v[84:85], v[14:15] op_sel_hi:[1,0] neg_lo:[0,1] neg_hi:[0,1]
v_pk_add_f32 v[86:87], v[86:87], v[14:15] op_sel_hi:[1,0] neg_lo:[0,1] neg_hi:[0,1]
v_pk_add_f32 v[88:89], v[88:89], v[14:15] op_sel_hi:[1,0] neg_lo:[0,1] neg_hi:[0,1]
v_pk_add_f32 v[90:91], v[90:91], v[14:15] op_sel_hi:[1,0] neg_lo:[0,1] neg_hi:[0,1]
v_pk_add_f32 v[92:93], v[92:93], v[14:15] op_sel_hi:[1,0] neg_lo:[0,1] neg_hi:[0,1]
v_pk_add_f32 v[94:95], v[94:95], v[14:15] op_sel_hi:[1,0] neg_lo:[0,1] neg_hi:[0,1]
v_pk_add_f32 v[64:65], v[64:65], v[14:15] op_sel_hi:[1,0] neg_lo:[0,1] neg_hi:[0,1]
v_pk_add_f32 v[66:67], v[66:67], v[14:15] op_sel_hi:[1,0] neg_lo:[0,1] neg_hi:[0,1]
v_pk_add_f32 v[68:69], v[68:69], v[14:15] op_sel_hi:[1,0] neg_lo:[0,1] neg_hi:[0,1]
v_pk_add_f32 v[70:71], v[70:71], v[14:15] op_sel_hi:[1,0] neg_lo:[0,1] neg_hi:[0,1]
v_pk_add_f32 v[72:73], v[72:73], v[14:15] op_sel_hi:[1,0] neg_lo:[0,1] neg_hi:[0,1]
v_pk_add_f32 v[74:75], v[74:75], v[14:15] op_sel_hi:[1,0] neg_lo:[0,1] neg_hi:[0,1]
v_pk_add_f32 v[76:77], v[76:77], v[14:15] op_sel_hi:[1,0] neg_lo:[0,1] neg_hi:[0,1]
v_pk_add_f32 v[78:79], v[78:79], v[14:15] op_sel_hi:[1,0] neg_lo:[0,1] neg_hi:[0,1]
v_exp_f32 v80, v80
v_exp_f32 v81, v81
v_exp_f32 v82, v82
v_exp_f32 v83, v83
v_exp_f32 v84, v84
v_exp_f32 v85, v85
v_exp_f32 v86, v86
v_exp_f32 v87, v87
v_exp_f32 v88, v88
v_exp_f32 v89, v89
v_exp_f32 v90, v90
v_exp_f32 v91, v91
v_exp_f32 v92, v92
v_exp_f32 v93, v93
v_exp_f32 v94, v94
v_exp_f32 v95, v95
v_exp_f32 v64, v64
v_exp_f32 v65, v65
v_cvt_pk_bf16_f32 v120, v80, v81
v_exp_f32 v66, v66
v_exp_f32 v67, v67
v_cvt_pk_bf16_f32 v121, v82, v83
v_exp_f32 v68, v68
v_exp_f32 v69, v69
v_cvt_pk_bf16_f32 v122, v84, v85
v_exp_f32 v70, v70
v_exp_f32 v71, v71
v_cvt_pk_bf16_f32 v123, v86, v87
v_exp_f32 v72, v72
v_exp_f32 v73, v73
v_cvt_pk_bf16_f32 v124, v88, v89
v_exp_f32 v74, v74
v_exp_f32 v75, v75
v_cvt_pk_bf16_f32 v125, v90, v91
v_exp_f32 v76, v76
v_exp_f32 v77, v77
v_cvt_pk_bf16_f32 v126, v92, v93
v_exp_f32 v78, v78
v_exp_f32 v79, v79
v_cvt_pk_bf16_f32 v127, v94, v95
v_cvt_pk_bf16_f32 v112, v64, v65
v_cvt_pk_bf16_f32 v113, v66, v67
v_cvt_pk_bf16_f32 v114, v68, v69
v_cvt_pk_bf16_f32 v115, v70, v71
v_cvt_pk_bf16_f32 v116, v72, v73
v_cvt_pk_bf16_f32 v117, v74, v75
v_cvt_pk_bf16_f32 v118, v76, v77
v_cvt_pk_bf16_f32 v119, v78, v79
s_waitcnt lgkmcnt(0)
v_mfma_f32_32x32x16_bf16 v[64:79], v[48:51], v[120:123], 0
v_mfma_f32_32x32x16_bf16 v[64:79], v[52:55], v[124:127], v[64:79]
s_cmp_eq_u32 s18, 0
s_cbranch_scc0 BH_PV1
v_and_b32 v128, v188, v112
v_and_b32 v129, v189, v113
v_and_b32 v130, v190, v114
v_and_b32 v131, v191, v115
v_and_b32 v132, v192, v116
v_and_b32 v133, v193, v117
v_and_b32 v134, v194, v118
v_and_b32 v135, v195, v119
v_xor_b32 v112, v112, v128
v_xor_b32 v113, v113, v129
v_xor_b32 v114, v114, v130
v_xor_b32 v115, v115, v131
v_xor_b32 v116, v116, v132
v_xor_b32 v117, v117, v133
v_xor_b32 v118, v118, v134
v_xor_b32 v119, v119, v135
v_mfma_f32_32x32x16_bf16 v[64:79], v[56:59], v[128:131], v[64:79]
v_mfma_f32_32x32x16_bf16 v[64:79], v[60:63], v[132:135], v[64:79]
BH_PV1:
v_mfma_f32_32x32x16_bf16 v[64:79], v[40:43], v[112:115], v[64:79]
v_mfma_f32_32x32x16_bf16 v[64:79], v[44:47], v[116:119], v[64:79]
s_lshl_b32 s33, s18, 12
s_add_u32 s33, s33, 96256
v_add_u32 v10, s33, v0
s_lshl_b32 s33, s18, 7
v_add_u32 v11, s33, v5
ds_write_b32 v11, v9
s_nop 5
ds_write_b128 v10, v[64:67] offset:0
ds_write_b128 v10, v[68:71] offset:1024
ds_write_b128 v10, v[72:75] offset:2048
ds_write_b128 v10, v[76:79] offset:3072
s_waitcnt lgkmcnt(0)
s_barrier
ds_read_b32 v52, v5 offset:0
ds_read_b32 v53, v5 offset:128
ds_read_b32 v54, v5 offset:256
ds_read_b32 v55, v5 offset:384
v_subrev_u32 v10, 112640, v5
v_lshlrev_b32 v10, 2, v10
v_add_u32 v10, 99840, v10
ds_read_b32 v48, v10 offset:0
ds_read_b32 v49, v10 offset:4096
ds_read_b32 v50, v10 offset:8192
ds_read_b32 v51, v10 offset:12288
ds_read_b128 v[32:35], v4 offset:0
ds_read_b128 v[36:39], v4 offset:4096
ds_read_b128 v[40:43], v4 offset:8192
ds_read_b128 v[44:47], v4 offset:12288
s_waitcnt lgkmcnt(8)
v_max3_f32 v8, v52, v53, v54
v_max_f32 v8, v8, v55
v_sub_f32 v52, v52, v8
v_sub_f32 v53, v53, v8
v_sub_f32 v54, v54, v8
v_sub_f32 v55, v55, v8
v_exp_f32 v52, v52
v_exp_f32 v53, v53
v_exp_f32 v54, v54
v_exp_f32 v55, v55
s_waitcnt lgkmcnt(4)
v_mul_f32 v9, v48, v52
v_fma_f32 v9, v49, v53, v9
v_fma_f32 v9, v50, v54, v9
v_fma_f32 v9, v51, v55, v9
v_rcp_f32 v9, v9
s_waitcnt lgkmcnt(0)
v_mul_f32 v56, v32, v52
v_mul_f32 v57, v33, v52
v_mul_f32 v58, v34, v52
v_mul_f32 v59, v35, v52
v_fma_f32 v56, v36, v53, v56
v_fma_f32 v57, v37, v53, v57
v_fma_f32 v58, v38, v53, v58
v_fma_f32 v59, v39, v53, v59
v_fma_f32 v56, v40, v54, v56
v_fma_f32 v57, v41, v54, v57
v_fma_f32 v58, v42, v54, v58
v_fma_f32 v59, v43, v54, v59
v_fma_f32 v56, v44, v55, v56
v_fma_f32 v57, v45, v55, v57
v_fma_f32 v58, v46, v55, v58
v_fma_f32 v59, v47, v55, v59
v_mul_f32 v56, v56, v9
v_mul_f32 v57, v57, v9
v_mul_f32 v58, v58, v9
v_mul_f32 v59, v59, v9
v_cvt_pk_bf16_f32 v60, v56, v57
v_cvt_pk_bf16_f32 v61, v58, v59
s_mov_b64 exec, s[54:55]
buffer_store_dwordx2 v[60:61], v3, s[4:7], s23 offen
s_mov_b64 exec, -1
s_add_u32 s22, s22, 28672
s_add_u32 s23, s23, 28672
s_add_u32 s63, s63, 256
s_mov_b32 s51, 0
s_add_u32 s24, s24, 1
s_cmp_ge_u32 s24, 9
s_cselect_b32 s24, 0, s24
s_add_u32 s21, s21, 1
s_cmp_lt_u32 s21, 64
s_cbranch_scc1 BH_LOOP
s_branch L_ROLE_END
BH_REDO:
s_add_u32 s51, s51, 1
s_mov_b32 s62, 0
s_barrier
s_branch BH_LOOP
WO_START:
v_and_b32 v16, 63, v0
v_and_b32 v17, 31, v0
v_lshrrev_b32 v18, 5, v0
v_and_b32 v19, 15, v16
v_lshrrev_b32 v20, 4, v16
v_lshlrev_b32 v0, 4, v16
v_lshlrev_b32 v1, 9, v18
v_lshl_add_u32 v1, v17, 4, v1
v_lshlrev_b32 v2, 9, v20
v_lshl_add_u32 v2, v19, 4, v2
s_lshl_b32 s32, s20, 2
s_add_u32 s32, s32, s18
s_mul_i32 s33, s32, 14336
s_add_u32 s33, s33, 14286848
s_add_u32 s34, s33, 0
buffer_load_dwordx4 a[0:3], v0, s[4:7], s34 offen
buffer_load_dwordx4 a[4:7], v0, s[4:7], s34 offen offset:1024
buffer_load_dwordx4 a[8:11], v0, s[4:7], s34 offen offset:2048
buffer_load_dwordx4 a[12:15], v0, s[4:7], s34 offen offset:3072
s_add_u32 s34, s33, 4096
buffer_load_dwordx4 a[16:19], v0, s[4:7], s34 offen
buffer_load_dwordx4 a[20:23], v0, s[4:7], s34 offen offset:1024
buffer_load_dwordx4 a[24:27], v0, s[4:7], s34 offen offset:2048
buffer_load_dwordx4 a[28:31], v0, s[4:7], s34 offen offset:3072
s_add_u32 s34, s33, 8192
buffer_load_dwordx4 a[32:35], v0, s[4:7], s34 offen
buffer_load_dwordx4 a[36:39], v0, s[4:7], s34 offen offset:1024
buffer_load_dwordx4 a[40:43], v0, s[4:7], s34 offen offset:2048
buffer_load_dwordx4 a[44:47], v0, s[4:7], s34 offen offset:3072
s_add_u32 s34, s33, 12288
buffer_load_dwordx4 a[48:51], v0, s[4:7], s34 offen
buffer_load_dwordx4 a[52:55], v0, s[4:7], s34 offen offset:1024
s_lshl_b32 s34, s32, 4
v_lshl_add_u32 v21, v20, 2, s34
v_lshrrev_b32 v22, 3, v21
v_lshlrev_b32 v22, 9, v22
v_and_b32 v23, 4, v21
v_lshl_add_u32 v22, v23, 1, v22
v_lshl_add_u32 v3, v19, 4, v22
v_mul_u32_u24 v22, 896, v19
v_lshl_add_u32 v22, v21, 1, v22
v_lshrrev_b32 v24, 2, v16
v_and_b32 v25, 3, v16
v_mul_u32_u24 v24, 28, v24
v_lshl_add_u32 v24, v25, 3, v24
v_lshrrev_b32 v25, 3, v24
v_lshlrev_b32 v25, 9, v25
v_and_b32 v24, 4, v24
v_lshl_add_u32 v5, v24, 1, v25
s_cmp_eq_u32 s19, 0
s_cbranch_scc0 WO_L1
v_mov_b32 v4, v3
s_branch WO_L2
WO_L1:
v_mov_b32 v4, v22
WO_L2:
s_mul_i32 s22, s19, 1835008
s_add_u32 s22, s22, 29368320
s_mul_i32 s23, s19, 3670016
s_add_u32 s23, s23, 23863296
s_mov_b32 s24, 25698304
s_mov_b32 s25, 0
s_mov_b32 s21, 0
s_waitcnt vmcnt(0)
WO_LOOP:
s_add_u32 s32, s22, 0
s_add_u32 s33, s22, 4096
s_add_u32 s34, s22, 8192
s_add_u32 s35, s22, 12288
s_add_u32 s36, s22, 16384
s_add_u32 s37, s22, 20480
s_add_u32 s38, s22, 24576
s_cmp_eq_u32 s40, 0
s_cselect_b32 s41, 20000, 0
POLL_49:
buffer_load_dwordx4 v[32:35], v1, s[4:7], s32 offen sc1
buffer_load_dwordx4 v[36:39], v1, s[4:7], s33 offen sc1
buffer_load_dwordx4 v[40:43], v1, s[4:7], s34 offen sc1
buffer_load_dwordx4 v[44:47], v1, s[4:7], s35 offen sc1
buffer_load_dwordx4 v[48:51], v1, s[4:7], s36 offen sc1
buffer_load_dwordx4 v[52:55], v1, s[4:7], s37 offen sc1
buffer_load_dwordx4 v[56:59], v1, s[4:7], s38 offen sc1
s_waitcnt vmcnt(0)
v_max3_u32 v8, v32, v36, v40
v_max3_u32 v9, v34, v38, v42
v_max3_u32 v8, v8, v44, v48
v_max3_u32 v9, v9, v46, v50
v_max3_u32 v8, v8, v52, v56
v_max3_u32 v9, v9, v54, v58
v_max_u32 v8, v8, v9
v_cmp_eq_u32 vcc, -1, v8
s_nop 0
s_cbranch_vccz PDONE_50
s_sub_u32 s41, s41, 1
s_cbranch_scc0 POLL_49
s_or_b32 s40, s40, 1024
PDONE_50:
ds_write_b128 v1, v[32:35] offset:0
ds_write_b128 v1, v[36:39] offset:4096
ds_write_b128 v1, v[40:43] offset:8192
ds_write_b128 v1, v[44:47] offset:12288
ds_write_b128 v1, v[48:51] offset:16384
ds_write_b128 v1, v[52:55] offset:20480
ds_write_b128 v1, v[56:59] offset:24576
buffer_load_dwordx2 v[72:73], v3, s[4:7], s23 offen sc1
buffer_load_dwordx2 v[74:75], v3, s[4:7], s23 offen offset:256 sc1
s_waitcnt lgkmcnt(0)
s_barrier
ds_read_b128 v[80:83], v2 offset:0
ds_read_b128 v[84:87], v2 offset:256
ds_read_b128 v[88:91], v2 offset:2048
ds_read_b128 v[92:95], v2 offset:2304
ds_read_b128 v[96:99], v2 offset:4096
ds_read_b128 v[100:103], v2 offset:4352
s_waitcnt lgkmcnt(4)
v_mfma_f32_16x16x32_bf16 v[64:67], a[0:3], v[80:83], 0
v_mfma_f32_16x16x32_bf16 v[68:71], a[0:3], v[84:87], 0
ds_read_b128 v[104:107], v2 offset:6144
ds_read_b128 v[108:111], v2 offset:6400
s_waitcnt lgkmcnt(4)
v_mfma_f32_16x16x32_bf16 v[64:67], a[4:7], v[88:91], v[64:67]
v_mfma_f32_16x16x32_bf16 v[68:71], a[4:7], v[92:95], v[68:71]
ds_read_b128 v[80:83], v2 offset:8192
ds_read_b128 v[84:87], v2 offset:8448
s_waitcnt lgkmcnt(4)
v_mfma_f32_16x16x32_bf16 v[64:67], a[8:11], v[96:99], v[64:67]
v_mfma_f32_16x16x32_bf16 v[68:71], a[8:11], v[100:103], v[68:71]
ds_read_b128 v[88:91], v2 offset:10240
ds_read_b128 v[92:95], v2 offset:10496
s_waitcnt lgkmcnt(4)
v_mfma_f32_16x16x32_bf16 v[64:67], a[12:15], v[104:107], v[64:67]
v_mfma_f32_16x16x32_bf16 v[68:71], a[12:15], v[108:111], v[68:71]
ds_read_b128 v[96:99], v2 offset:12288
ds_read_b128 v[100:103], v2 offset:12544
s_waitcnt lgkmcnt(4)
v_mfma_f32_16x16x32_bf16 v[64:67], a[16:19], v[80:83], v[64:67]
v_mfma_f32_16x16x32_bf16 v[68:71], a[16:19], v[84:87], v[68:71]
ds_read_b128 v[104:107], v2 offset:14336
ds_read_b128 v[108:111], v2 offset:14592
s_waitcnt lgkmcnt(4)
v_mfma_f32_16x16x32_bf16 v[64:67], a[20:23], v[88:91], v[64:67]
v_mfma_f32_16x16x32_bf16 v[68:71], a[20:23], v[92:95], v[68:71]
ds_read_b128 v[80:83], v2 offset:16384
ds_read_b128 v[84:87], v2 offset:16640
s_waitcnt lgkmcnt(4)
v_mfma_f32_16x16x32_bf16 v[64:67], a[24:27], v[96:99], v[64:67]
v_mfma_f32_16x16x32_bf16 v[68:71], a[24:27], v[100:103], v[68:71]
ds_read_b128 v[88:91], v2 offset:18432
ds_read_b128 v[92:95], v2 offset:18688
s_waitcnt lgkmcnt(4)
v_mfma_f32_16x16x32_bf16 v[64:67], a[28:31], v[104:107], v[64:67]
v_mfma_f32_16x16x32_bf16 v[68:71], a[28:31], v[108:111], v[68:71]
ds_read_b128 v[96:99], v2 offset:20480
ds_read_b128 v[100:103], v2 offset:20736
s_waitcnt lgkmcnt(4)
v_mfma_f32_16x16x32_bf16 v[64:67], a[32:35], v[80:83], v[64:67]
v_mfma_f32_16x16x32_bf16 v[68:71], a[32:35], v[84:87], v[68:71]
ds_read_b128 v[104:107], v2 offset:22528
ds_read_b128 v[108:111], v2 offset:22784
s_waitcnt lgkmcnt(4)
v_mfma_f32_16x16x32_bf16 v[64:67], a[36:39], v[88:91], v[64:67]
v_mfma_f32_16x16x32_bf16 v[68:71], a[36:39], v[92:95], v[68:71]
ds_read_b128 v[80:83], v2 offset:24576
ds_read_b128 v[84:87], v2 offset:24832
s_waitcnt lgkmcnt(4)
v_mfma_f32_16x16x32_bf16 v[64:67], a[40:43], v[96:99], v[64:67]
v_mfma_f32_16x16x32_bf16 v[68:71], a[40:43], v[100:103], v[68:71]
ds_read_b128 v[88:91], v2 offset:26624
ds_read_b128 v[92:95], v2 offset:26880
s_waitcnt lgkmcnt(4)
v_mfma_f32_16x16x32_bf16 v[64:67], a[44:47], v[104:107], v[64:67]
v_mfma_f32_16x16x32_bf16 v[68:71], a[44:47], v[108:111], v[68:71]
s_waitcnt lgkmcnt(2)
v_mfma_f32_16x16x32_bf16 v[64:67], a[48:51], v[80:83], v[64:67]
v_mfma_f32_16x16x32_bf16 v[68:71], a[48:51], v[84:87], v[68:71]
s_waitcnt lgkmcnt(0)
v_mfma_f32_16x16x32_bf16 v[64:67], a[52:55], v[88:91], v[64:67]
v_mfma_f32_16x16x32_bf16 v[68:71], a[52:55], v[92:95], v[68:71]
s_waitcnt vmcnt(0)
v_lshlrev_b32 v8, 16, v72
v_and_b32 v9, 0xffff0000, v72
v_lshlrev_b32 v10, 16, v73
v_and_b32 v11, 0xffff0000, v73
s_nop 1
v_add_f32 v8, v8, v64
v_add_f32 v9, v9, v65
v_add_f32 v10, v10, v66
v_add_f32 v11, v11, v67
v_cvt_pk_bf16_f32 v12, v8, v9
v_cvt_pk_bf16_f32 v13, v10, v11
v_lshlrev_b32 v8, 16, v74
v_and_b32 v9, 0xffff0000, v74
v_lshlrev_b32 v10, 16, v75
v_and_b32 v11, 0xffff0000, v75
v_add_f32 v8, v8, v68
v_add_f32 v9, v9, v69
v_add_f32 v10, v10, v70
v_add_f32 v11, v11, v71
v_cvt_pk_bf16_f32 v14, v8, v9
v_cvt_pk_bf16_f32 v15, v10, v11
s_cmp_eq_u32 s19, 0
s_cbranch_scc0 WO_FIN
buffer_store_dwordx2 v[12:13], v4, s[4:7], s24 offen sc1
buffer_store_dwordx2 v[14:15], v4, s[4:7], s24 offen offset:256 sc1
s_branch WO_NX
WO_FIN:
s_add_u32 s26, s25, 14336
buffer_store_dwordx2 v[12:13], v4, s[12:15], s25 offen
buffer_store_dwordx2 v[14:15], v4, s[12:15], s26 offen
WO_NX:
s_barrier
s_add_u32 s22, s22, 28672
s_add_u32 s23, s23, 28672
s_add_u32 s24, s24, 28672
s_add_u32 s25, s25, 28672
s_add_u32 s21, s21, 1
s_cmp_lt_u32 s21, 64
s_cbranch_scc1 WO_LOOP
s_branch L_ROLE_END
LNO_START:
v_and_b32 v16, 7, v0
v_lshrrev_b32 v17, 3, v0
s_lshl_b32 s33, s20, 3
v_add_u32 v18, s33, v16
v_lshlrev_b32 v2, 9, v17
v_lshl_add_u32 v2, v18, 4, v2
v_lshlrev_b32 v3, 3, v16
s_lshl_b32 s33, s18, 6
v_add_u32 v4, s33, v3
v_lshlrev_b32 v6, 2, v18
v_cmp_gt_u32 s[54:55], 24, v17
s_lshl_b32 s24, s20, 2
s_add_u32 s24, s24, 1536
s_mov_b32 s21, 0
s_mov_b32 s22, 25698304
s_mov_b32 s23, 18358272
LNO_LOOP:
s_add_u32 s32, s22, 16384
v_mov_b64 v[36:37], 0
v_mov_b64 v[38:39], 0
s_cmp_eq_u32 s40, 0
s_cselect_b32 s41, 20000, 0
LNO_POLL:
buffer_load_dwordx4 v[32:35], v2, s[4:7], s22 offen sc1
s_mov_b64 exec, s[54:55]
buffer_load_dwordx4 v[36:39], v2, s[4:7], s32 offen sc1
s_mov_b64 exec, -1
s_waitcnt vmcnt(0)
v_max3_u32 v8, v32, v34, v36
v_max_u32 v8, v8, v38
v_cmp_eq_u32 vcc, -1, v8
s_nop 0
s_cbranch_vccz LNO_GOT
s_sub_u32 s41, s41, 1
s_cbranch_scc0 LNO_POLL
s_or_b32 s40, s40, 256
LNO_GOT:
v_lshlrev_b32 v64, 16, v32
v_and_b32 v65, 0xffff0000, v32
v_lshlrev_b32 v66, 16, v33
v_and_b32 v67, 0xffff0000, v33
v_lshlrev_b32 v68, 16, v34
v_and_b32 v69, 0xffff0000, v34
v_lshlrev_b32 v70, 16, v35
v_and_b32 v71, 0xffff0000, v35
v_lshlrev_b32 v72, 16, v36
v_and_b32 v73, 0xffff0000, v36
v_lshlrev_b32 v74, 16, v37
v_and_b32 v75, 0xffff0000, v37
v_lshlrev_b32 v76, 16, v38
v_and_b32 v77, 0xffff0000, v38
v_lshlrev_b32 v78, 16, v39
v_and_b32 v79, 0xffff0000, v39
v_pk_add_f32 v[20:21], v[64:65], v[66:67]
v_pk_mul_f32 v[22:23], v[64:65], v[64:65]
v_pk_fma_f32 v[22:23], v[66:67], v[66:67], v[22:23]
v_pk_add_f32 v[20:21], v[20:21], v[68:69]
v_pk_fma_f32 v[22:23], v[68:69], v[68:69], v[22:23]
v_pk_add_f32 v[20:21], v[20:21], v[70:71]
v_pk_fma_f32 v[22:23], v[70:71], v[70:71], v[22:23]
v_pk_add_f32 v[20:21], v[20:21], v[72:73]
v_pk_fma_f32 v[22:23], v[72:73], v[72:73], v[22:23]
v_pk_add_f32 v[20:21], v[20:21], v[74:75]
v_pk_fma_f32 v[22:23], v[74:75], v[74:75], v[22:23]
v_pk_add_f32 v[20:21], v[20:21], v[76:77]
v_pk_fma_f32 v[22:23], v[76:77], v[76:77], v[22:23]
v_pk_add_f32 v[20:21], v[20:21], v[78:79]
v_pk_fma_f32 v[22:23], v[78:79], v[78:79], v[22:23]
v_add_f32 v13, v20, v21
v_add_f32 v14, v22, v23
s_nop 0
v_add_f32_dpp v13, v13, v13 row_ror:8 row_mask:0xf bank_mask:0xf
v_add_f32_dpp v14, v14, v14 row_ror:8 row_mask:0xf bank_mask:0xf
v_mov_b32 v15, v13
v_mov_b32 v16, v14
s_nop 0
v_permlane16_swap_b32 v13, v15
v_permlane16_swap_b32 v14, v16
v_add_f32 v13, v13, v15
v_add_f32 v14, v14, v16
v_mov_b32 v15, v13
v_mov_b32 v16, v14
s_nop 0
v_permlane32_swap_b32 v13, v15
v_permlane32_swap_b32 v14, v16
v_add_f32 v13, v13, v15
v_add_f32 v14, v14, v16
v_mov_b32 v28, v13
v_mov_b32 v29, v14
ds_write_b64 v4, v[28:29]
s_waitcnt lgkmcnt(0)
s_barrier
ds_read_b64 v[40:41], v3
ds_read_b64 v[42:43], v3 offset:64
ds_read_b64 v[44:45], v3 offset:128
ds_read_b64 v[46:47], v3 offset:192
s_waitcnt lgkmcnt(0)
v_add_f32 v40, v40, v42
v_add_f32 v41, v41, v43
v_add_f32 v44, v44, v46
v_add_f32 v45, v45, v47
v_add_f32 v40, v40, v44
v_add_f32 v41, v41, v45
v_mul_f32 v40, 0x3b124925, v40
v_mul_f32 v41, 0x3b124925, v41
v_fma_f32 v41, -v40, v40, v41
v_max_f32 v41, 0, v41
v_add_f32 v41, 0x3727c5ac, v41
v_rsq_f32 v41, v41
s_nop 0
v_mul_f32 v40, v40, v41
v_fma_f32 v64, v64, v41, -v40
v_fma_f32 v65, v65, v41, -v40
v_fma_f32 v66, v66, v41, -v40
v_fma_f32 v67, v67, v41, -v40
v_fma_f32 v68, v68, v41, -v40
v_fma_f32 v69, v69, v41, -v40
v_fma_f32 v70, v70, v41, -v40
v_fma_f32 v71, v71, v41, -v40
v_fma_f32 v72, v72, v41, -v40
v_fma_f32 v73, v73, v41, -v40
v_fma_f32 v74, v74, v41, -v40
v_fma_f32 v75, v75, v41, -v40
v_fma_f32 v76, v76, v41, -v40
v_fma_f32 v77, v77, v41, -v40
v_fma_f32 v78, v78, v41, -v40
v_fma_f32 v79, v79, v41, -v40
v_cvt_pk_bf16_f32 v48, v64, v65
v_cvt_pk_bf16_f32 v49, v66, v67
v_cvt_pk_bf16_f32 v50, v68, v69
v_cvt_pk_bf16_f32 v51, v70, v71
v_cvt_pk_bf16_f32 v52, v72, v73
v_cvt_pk_bf16_f32 v53, v74, v75
v_cvt_pk_bf16_f32 v54, v76, v77
v_cvt_pk_bf16_f32 v55, v78, v79
s_add_u32 s32, s23, 16384
buffer_store_dwordx4 v[48:51], v2, s[4:7], s23 offen sc1
s_mov_b64 exec, s[54:55]
buffer_store_dwordx4 v[52:55], v2, s[4:7], s32 offen sc1
s_mov_b64 exec, -1
s_waitcnt vmcnt(0)
s_barrier
s_cmp_lg_u32 s18, 0
s_cbranch_scc1 LNO_NOF
v_mov_b32 v5, 1
s_mov_b64 exec, 1
buffer_store_dword v5, off, s[4:7], s24 sc1
s_mov_b64 exec, -1
LNO_NOF:
s_add_u32 s22, s22, 28672
s_add_u32 s23, s23, 28672
s_add_u32 s24, s24, 16
s_add_u32 s21, s21, 1
s_cmp_lt_u32 s21, 64
s_cbranch_scc1 LNO_LOOP
s_branch L_ROLE_END
STA_START:
v_and_b32 v16, 7, v0
v_lshrrev_b32 v17, 3, v0
s_lshl_b32 s33, s20, 3
v_add_u32 v18, s33, v16
v_lshlrev_b32 v2, 9, v17
v_lshl_add_u32 v2, v18, 4, v2
v_lshlrev_b32 v3, 3, v16
s_lshl_b32 s33, s18, 6
v_add_u32 v4, s33, v3
v_lshlrev_b32 v6, 2, v18
v_cmp_gt_u32 s[54:55], 24, v17
s_lshl_b32 s24, s20, 2
s_add_u32 s24, s24, 1536
s_mov_b32 s21, 0
s_mul_i32 s22, s19, 3670016
s_add_u32 s22, s22, 23863296
s_lshl_b32 s23, s19, 14
s_add_u32 s23, s23, 158031872
STA_LOOP:
s_add_u32 s32, s22, 16384
v_mov_b64 v[36:37], 0
v_mov_b64 v[38:39], 0
s_cmp_eq_u32 s40, 0
s_cselect_b32 s41, 20000, 0
STA_POLL:
buffer_load_dwordx4 v[32:35], v2, s[4:7], s22 offen sc1
s_mov_b64 exec, s[54:55]
buffer_load_dwordx4 v[36:39], v2, s[4:7], s32 offen sc1
s_mov_b64 exec, -1
s_waitcnt vmcnt(0)
v_max3_u32 v8, v32, v34, v36
v_max_u32 v8, v8, v38
v_cmp_eq_u32 vcc, -1, v8
s_nop 0
s_cbranch_vccz STA_GOT
s_sub_u32 s41, s41, 1
s_cbranch_scc0 STA_POLL
s_or_b32 s40, s40, 256
STA_GOT:
v_lshlrev_b32 v64, 16, v32
v_and_b32 v65, 0xffff0000, v32
v_lshlrev_b32 v66, 16, v33
v_and_b32 v67, 0xffff0000, v33
v_lshlrev_b32 v68, 16, v34
v_and_b32 v69, 0xffff0000, v34
v_lshlrev_b32 v70, 16, v35
v_and_b32 v71, 0xffff0000, v35
v_lshlrev_b32 v72, 16, v36
v_and_b32 v73, 0xffff0000, v36
v_lshlrev_b32 v74, 16, v37
v_and_b32 v75, 0xffff0000, v37
v_lshlrev_b32 v76, 16, v38
v_and_b32 v77, 0xffff0000, v38
v_lshlrev_b32 v78, 16, v39
v_and_b32 v79, 0xffff0000, v39
v_pk_add_f32 v[20:21], v[64:65], v[66:67]
v_pk_mul_f32 v[22:23], v[64:65], v[64:65]
v_pk_fma_f32 v[22:23], v[66:67], v[66:67], v[22:23]
v_pk_add_f32 v[20:21], v[20:21], v[68:69]
v_pk_fma_f32 v[22:23], v[68:69], v[68:69], v[22:23]
v_pk_add_f32 v[20:21], v[20:21], v[70:71]
v_pk_fma_f32 v[22:23], v[70:71], v[70:71], v[22:23]
v_pk_add_f32 v[20:21], v[20:21], v[72:73]
v_pk_fma_f32 v[22:23], v[72:73], v[72:73], v[22:23]
v_pk_add_f32 v[20:21], v[20:21], v[74:75]
v_pk_fma_f32 v[22:23], v[74:75], v[74:75], v[22:23]
v_pk_add_f32 v[20:21], v[20:21], v[76:77]
v_pk_fma_f32 v[22:23], v[76:77], v[76:77], v[22:23]
v_pk_add_f32 v[20:21], v[20:21], v[78:79]
v_pk_fma_f32 v[22:23], v[78:79], v[78:79], v[22:23]
v_add_f32 v13, v20, v21
v_add_f32 v14, v22, v23
s_nop 0
v_add_f32_dpp v13, v13, v13 row_ror:8 row_mask:0xf bank_mask:0xf
v_add_f32_dpp v14, v14, v14 row_ror:8 row_mask:0xf bank_mask:0xf
v_mov_b32 v15, v13
v_mov_b32 v16, v14
s_nop 0
v_permlane16_swap_b32 v13, v15
v_permlane16_swap_b32 v14, v16
v_add_f32 v13, v13, v15
v_add_f32 v14, v14, v16
v_mov_b32 v15, v13
v_mov_b32 v16, v14
s_nop 0
v_permlane32_swap_b32 v13, v15
v_permlane32_swap_b32 v14, v16
v_add_f32 v13, v13, v15
v_add_f32 v14, v14, v16
v_mov_b32 v28, v13
v_mov_b32 v29, v14
ds_write_b64 v4, v[28:29]
s_waitcnt lgkmcnt(0)
s_barrier
ds_read_b64 v[40:41], v3
ds_read_b64 v[42:43], v3 offset:64
ds_read_b64 v[44:45], v3 offset:128
ds_read_b64 v[46:47], v3 offset:192
s_waitcnt lgkmcnt(0)
v_add_f32 v40, v40, v42
v_add_f32 v41, v41, v43
v_add_f32 v44, v44, v46
v_add_f32 v45, v45, v47
v_add_f32 v40, v40, v44
v_add_f32 v41, v41, v45
v_mul_f32 v40, 0x3b124925, v40
v_mul_f32 v41, 0x3b124925, v41
v_fma_f32 v41, -v40, v40, v41
v_max_f32 v41, 0, v41
v_add_f32 v41, 0x3727c5ac, v41
v_rsq_f32 v41, v41
s_cmp_lg_u32 s18, 0
s_cbranch_scc1 STA_NOS
s_mov_b64 exec, 0xff
buffer_store_dword v41, v6, s[4:7], s23 offen
buffer_store_dword v40, v6, s[4:7], s23 offen offset:128
s_mov_b64 exec, -1
STA_NOS:
s_barrier
s_add_u32 s22, s22, 28672
s_add_u32 s23, s23, 256
s_add_u32 s24, s24, 16
s_add_u32 s21, s21, 1
s_cmp_lt_u32 s21, 64
s_cbranch_scc1 STA_LOOP
s_branch L_ROLE_END
L_ROLE_END:
s_cmp_eq_u32 s40, 0
s_cbranch_scc1 RE_51
v_mov_b32 v1, 32
v_mov_b32 v2, s40
buffer_atomic_or v2, v1, s[8:11], 0 offen
s_waitcnt vmcnt(0)
RE_51:
L_END:
s_endpgm
.section .rodata,"a"
.p2align 6
.amdhsa_kernel prep_kernel
  .amdhsa_next_free_vgpr 512
  .amdhsa_next_free_sgpr 100
  .amdhsa_accum_offset 256
  .amdhsa_group_segment_fixed_size 0
  .amdhsa_kernarg_size 104
  .amdhsa_user_sgpr_count 2
  .amdhsa_user_sgpr_kernarg_segment_ptr 1
  .amdhsa_system_sgpr_workgroup_id_x 1
.end_amdhsa_kernel
.p2align 6
.amdhsa_kernel interleave_layers__memory_aug_recurrent_mem_tr__sliding_block__prompt_kernel
  .amdhsa_next_free_vgpr 512
  .amdhsa_next_free_sgpr 100
  .amdhsa_accum_offset 256
  .amdhsa_group_segment_fixed_size 0
  .amdhsa_kernarg_size 104
  .amdhsa_user_sgpr_count 2
  .amdhsa_user_sgpr_kernarg_segment_ptr 1
  .amdhsa_system_sgpr_workgroup_id_x 1
.end_amdhsa_kernel
```
